```python
import torch

def _softmax(x, axis=-1):
    return torch.softmax(x, dim=axis)
def _gelu(x):
    return torch.nn.functional.gelu(x, approximate="tanh")
def _silu(x):
    return torch.nn.functional.silu(x)
def _sigmoid(x):
    return torch.sigmoid(x)
def _layernorm(x, axis=-1, eps=1e-5):
    m = x.mean(dim=axis, keepdim=True)
    v = x.var(dim=axis, keepdim=True, unbiased=False)
    return (x - m) / torch.sqrt(v + eps)
def _scatter_add(tgt, idx, src, axis=0):
    return tgt.clone().index_add_(axis, idx, src)
def _segment_sum(src, seg, n):
    out = torch.zeros((n,) + src.shape[1:], dtype=src.dtype)
    return out.index_add_(0, seg, src)
def _pad(x, pw):
    flat = tuple(v for pair in reversed(pw) for v in pair)
    return torch.nn.functional.pad(x, flat)

kernel_name = 'sequential_preLN__ssm_conv_h3__glu_gated_bilinear__prompt'

def setup_inputs():

    _w = (lambda a: (lambda t: t.to(torch.bfloat16) if t.is_floating_point() else t)(torch.as_tensor(a)))
    def _A_setup():
        B, S, D = 1, 2048, 1024
        ks = 4
        return {
            "q": _w((lambda *s: torch.randn(*s, dtype=torch.bfloat16) * 0.05)(B, S, D)),
            "k": _w((lambda *s: torch.randn(*s, dtype=torch.bfloat16) * 0.2)(B, S, D)),
            "v": _w((lambda *s: torch.randn(*s, dtype=torch.bfloat16) * 0.2)(B, S, D)),
            "shift_k": _w((lambda *s: torch.randn(*s, dtype=torch.bfloat16) * 0.2)(D, ks) * 0.5),
            "ssm_k": _w((lambda *s: torch.randn(*s, dtype=torch.bfloat16) * 0.4)(D, S) * (1.0 / S ** 0.5)),
            "ssm_D": _w((lambda *s: torch.randn(*s, dtype=torch.bfloat16) * 0.2)(D)),
        }
    _A_in = _A_setup()

    def _B_setup():
        B, S, D, F = 1, 2048, 1024, 3584
        return {
            "x": _w((lambda *s: torch.randn(*s, dtype=torch.bfloat16) * 0.05)(B, S, D)),
            "w_gate": _w((lambda *s: torch.randn(*s, dtype=torch.bfloat16) * 0.2)(D, F) * (D ** -0.5)),
            "w_up": _w((lambda *s: torch.randn(*s, dtype=torch.bfloat16) * 0.2)(D, F) * (D ** -0.5)),
            "w_down": _w((lambda *s: torch.randn(*s, dtype=torch.bfloat16) * 0.2)(F, D) * (F ** -0.5)),
        }
    _B_in = _B_setup()

    return {
        "A_q": _A_in["q"],
        "A_k": _A_in["k"],
        "A_v": _A_in["v"],
        "A_shift_k": _A_in["shift_k"],
        "A_ssm_k": _A_in["ssm_k"],
        "A_ssm_D": _A_in["ssm_D"],
        "B_x": _B_in["x"],
        "B_w_gate": _B_in["w_gate"],
        "B_w_up": _B_in["w_up"],
        "B_w_down": _B_in["w_down"],
    }

def reference(A_q, A_k, A_v, A_shift_k, A_ssm_k, A_ssm_D, B_x, B_w_gate, B_w_up, B_w_down):
    def _A_ref(q, k, v, shift_k, ssm_k, ssm_D):
        B, S, D = q.shape
        ks = shift_k.shape[-1]
        k_pad = _pad(k, ((0, 0), (ks - 1, 0), (0, 0)))
        k_shift = torch.zeros_like(k)
        for t in range(ks):
            k_shift = k_shift + k_pad[:, t:t + S, :] * shift_k[:, ks - 1 - t][None, None, :]
        kv = k_shift * v
        L = 2 * S
        kv_pad = _pad(kv, ((0, 0), (0, S), (0, 0)))
        kf_pad = _pad(ssm_k, ((0, 0), (0, S)))
        kv_f = (lambda x, axes=(-2,-1): torch.fft.rfft2(x.float(), dim=axes))(kv_pad[:, None, :, :], axes=(1, 2))
        kf_f = (lambda x, axes=(-2,-1): torch.fft.rfft2(x.float(), dim=axes))(kf_pad[:, None, :], axes=(1, 2))
        kf_f = (lambda x, *d: x.permute(*d))(kf_f, 1, 2, 0)
        y_f = kv_f * kf_f[None, :, :, :]
        y = (lambda x, s, axes=(-2,-1): torch.fft.irfft2(x, s=s, dim=axes).to(torch.bfloat16))(y_f, (1, L), axes=(1, 2))[:, 0, :S, :]
        y = y + kv * ssm_D[None, None, :]
        return q * y

    def _B_ref(x, w_gate, w_up, w_down):
        g = torch.einsum("bsd,df->bsf", x, w_gate)
        u = torch.einsum("bsd,df->bsf", x, w_up)
        h = g * u
        return torch.einsum("bsf,fd->bsd", h, w_down)

    x = A_q
    h = x + _A_ref(_layernorm(x, axis=-1), A_k, A_v, A_shift_k, A_ssm_k, A_ssm_D)
    h2 = h + _B_ref(_layernorm(h, axis=-1), B_w_gate, B_w_up, B_w_down)
    return h2
```

```asm
; @launch kernel=fused_kernel grid=(256,1,1) block=(256,1,1) lds=163840
.amdgcn_target "amdgcn-amd-amdhsa--gfx950"
.text
.p2align 12
.globl fused_kernel
.p2align 12
.type fused_kernel,@function
fused_kernel:
    s_cmp_ge_u32 s2, 256
    s_cbranch_scc1 L_fused_kernel_end
    s_load_dwordx16 s[4:19], s[0:1], 0
    s_load_dwordx8 s[20:27], s[0:1], 64
    s_load_dwordx2 s[28:29], s[0:1], 96
    v_lshrrev_b32 v1, 6, v0
    v_and_b32 v0, 63, v0
    v_readfirstlane_b32 s32, v1
    s_and_b32 s33, s2, 7
    s_lshr_b32 s34, s2, 3
    s_getpc_b64 s[62:63]
L_fused_kernel_pc_2:
    s_and_b32 s62, s62, 0xfffff000
    s_lshl_b32 s3, s34, 2
    s_add_u32 s3, s3, s32
    s_lshl_b32 s3, s3, 10
    s_cmp_ge_u32 s3, L_fused_kernel_end - fused_kernel
    s_cbranch_scc1 L_fused_kernel_cpf_1
    v_lshl_add_u32 v2, v0, 4, s3
    v_min_u32 v2, L_fused_kernel_end - fused_kernel - 16, v2
    v_mov_b32 v3, s63
    v_add_co_u32 v2, vcc, s62, v2
    v_addc_co_u32 v3, vcc, 0, v3, vcc
    global_load_dwordx4 v[252:255], v[2:3], off
L_fused_kernel_cpf_1:
    s_lshr_b32 s61, s32, 1
    s_lshl_b32 s60, s33, 1
    s_add_u32 s60, s60, s61
    v_lshrrev_b32 v10, 3, v0
    v_lshlrev_b32 v1, 11, v10
    v_and_b32 v10, 7, v0
    v_lshl_add_u32 v1, v10, 4, v1
    s_lshl_b32 s3, s60, 7
    v_add_u32 v1, s3, v1
    s_lshl_b32 s62, s34, 17
    s_sub_u32 s63, s62, 16384
    v_add_u32 v2, s63, v1
    v_mov_b32 v12, 0x80000000
    s_cmp_eq_u32 s34, 0
    s_cselect_b64 vcc, -1, 0
    s_and_b32 s3, s32, 1
    s_lshl_b32 s63, s3, 16
    s_add_u32 s62, s62, s63
    v_cndmask_b32 v2, v2, v12, vcc
    v_add_u32 v1, s62, v1
    s_lshl_b32 s3, s3, 2
    s_mul_i32 s61, s61, 9
    s_add_u32 s3, s3, s61
    s_mul_i32 s3, s3, 1056
    s_waitcnt lgkmcnt(0)
    s_mov_b32 s40, s6
    s_mov_b32 s41, s7
    s_mov_b32 s42, 4194304
    s_mov_b32 s43, 0x20000
    s_mov_b32 s44, s8
    s_mov_b32 s45, s9
    s_mov_b32 s46, 4194304
    s_mov_b32 s47, 0x20000
    s_add_u32 m0, s3, 109088
    s_mov_b32 s16, 0
    buffer_load_dwordx4 v1, s[40:43], s16 offen lds
    s_add_u32 m0, s3, 127040
    s_nop 0
    buffer_load_dwordx4 v1, s[44:47], s16 offen lds
    s_add_u32 m0, s3, 110144
    s_mov_b32 s16, 16384
    buffer_load_dwordx4 v1, s[40:43], s16 offen lds
    s_add_u32 m0, s3, 128096
    s_nop 0
    buffer_load_dwordx4 v1, s[44:47], s16 offen lds
    s_add_u32 m0, s3, 111200
    s_mov_b32 s16, 32768
    buffer_load_dwordx4 v1, s[40:43], s16 offen lds
    s_add_u32 m0, s3, 129152
    s_nop 0
    buffer_load_dwordx4 v1, s[44:47], s16 offen lds
    s_add_u32 m0, s3, 112256
    s_mov_b32 s16, 49152
    buffer_load_dwordx4 v1, s[40:43], s16 offen lds
    s_add_u32 m0, s3, 130208
    s_nop 0
    buffer_load_dwordx4 v1, s[44:47], s16 offen lds
    s_bitcmp1_b32 s32, 0
    s_cbranch_scc1 L_fused_kernel_halo_3
    s_add_u32 m0, s3, 108032
    s_nop 0
    buffer_load_dwordx4 v2, s[40:43], 0 offen lds
L_fused_kernel_halo_3:
    s_lshl_b32 s3, s60, 6
    s_and_b32 s62, s32, 1
    s_lshl_b32 s62, s62, 5
    s_add_u32 s3, s3, s62
    s_lshl_b32 s62, s34, 6
    v_and_b32 v10, 7, v0
    v_lshl_add_u32 v13, v10, 3, s62
    v_lshrrev_b32 v11, 3, v0
    v_lshl_add_u32 v14, v11, 2, s3
    v_lshlrev_b32 v7, 3, v14
    v_mov_b32 v9, 0
    s_mov_b32 s48, s10
    s_mov_b32 s49, s11
    s_mov_b32 s50, 8192
    s_mov_b32 s51, 0x20000
    s_add_u32 s36, s28, 33554432
    s_addc_u32 s37, s29, 0
    s_mov_b32 s38, 294912
    s_mov_b32 s39, 0x20000
    buffer_load_dwordx4 v[48:51], v7, s[48:51], 0 offen
    buffer_load_dwordx4 v[52:55], v7, s[48:51], 0 offen offset:16
    buffer_load_dwordx2 v[132:133], v9, s[36:39], 0 offen offset:0 sc1
    v_mul_u32_u24 v8, 4096, v14
    v_lshlrev_b32 v13, 1, v13
    v_sub_u32 v8, v8, v13
    v_add_u32 v8, 4080, v8
    s_lshr_b32 s63, s32, 1
    s_mul_i32 s63, s63, 9
    v_add_u32 v10, s63, v10
    v_mul_u32_u24 v10, 1056, v10
    v_lshl_add_u32 v10, v11, 3, v10
    s_and_b32 s62, s32, 1
    s_lshl_b32 s62, s62, 6
    s_add_u32 s62, s62, 108032
    v_add_u32 v3, s62, v10
    s_lshl_b32 s60, s33, 5
    s_add_u32 s60, s60, s34
    s_lshl_b32 s60, s60, 2
    s_add_u32 s60, s60, s32
    s_mul_i32 s61, s32, 27008
    v_lshlrev_b32 v136, 4, v0
    v_and_b32 v12, 15, v0
    v_lshrrev_b32 v13, 4, v0
    v_lshlrev_b32 v14, 2, v12
    v_lshlrev_b32 v15, 4, v13
    v_sub_u32 v14, v14, v15
    v_subrev_u32 v14, 12, v14
    v_mov_b32 v16, 0x80000000
    v_add_u32 v15, 0, v14
    v_cmp_gt_i32 vcc, 0, v15
    s_nop 1
    v_cndmask_b32 v140, v15, v16, vcc
    v_add_u32 v15, 4, v14
    v_cmp_gt_i32 vcc, 0, v15
    s_nop 1
    v_cndmask_b32 v141, v15, v16, vcc
    v_add_u32 v15, 8, v14
    v_cmp_gt_i32 vcc, 0, v15
    s_nop 1
    v_cndmask_b32 v142, v15, v16, vcc
    v_add_u32 v15, 12, v14
    v_cmp_gt_i32 vcc, 0, v15
    s_nop 1
    v_cndmask_b32 v143, v15, v16, vcc
    s_mov_b32 s52, s12
    s_mov_b32 s53, s13
    s_mov_b32 s54, 4194304
    s_mov_b32 s55, 0x20000
    s_lshl_b32 s3, s60, 12
    s_add_u32 m0, s61, 10368
    s_add_u32 s16, s3, 0
    buffer_load_dwordx4 v136, s[52:55], s16 offen offset:0 lds
    buffer_load_dwordx4 v136, s[52:55], s16 offen offset:1024 lds
    buffer_load_dwordx4 v136, s[52:55], s16 offen offset:2048 lds
    buffer_load_dwordx4 v136, s[52:55], s16 offen offset:3072 lds
    buffer_load_dword a0, v140, s[52:55], s3 offen
    buffer_load_dword a1, v141, s[52:55], s3 offen
    buffer_load_dword a2, v142, s[52:55], s3 offen
    buffer_load_dword a3, v143, s[52:55], s3 offen
    s_and_b32 s16, s60, 0xfffffffe
    s_lshl_b32 s16, s16, 1
    s_load_dword s17, s[14:15], s16
    s_add_u32 s3, s61, 10368
    v_add_u32 v14, 1, v12
    v_and_b32 v15, 3, v14
    v_lshrrev_b32 v14, 2, v14
    v_sub_u32 v14, v14, v13
    v_lshlrev_b32 v14, 4, v14
    v_lshlrev_b32 v16, 12, v15
    v_add_u32 v14, v14, v16
    v_cmp_lt_u32 vcc, 0, v15
    v_lshlrev_b32 v16, 6, v15
    v_add_u32 v16, 16, v16
    v_cndmask_b32 v16, 0, v16, vcc
    v_add_u32 v14, v14, v16
    v_add_u32 v137, s3, v14
    v_mul_u32_u24 v14, 1280, v13
    v_lshrrev_b32 v16, 1, v13
    v_lshl_add_u32 v14, v16, 6, v14
    v_lshl_add_u32 v14, v12, 4, v14
    v_add_u32 v138, s61, v14
    v_sub_u32 v14, 255, v0
    v_and_b32 v15, 3, v14
    v_lshrrev_b32 v16, 1, v15
    v_mul_u32_u24 v15, 1280, v15
    v_lshl_add_u32 v15, v16, 6, v15
    v_lshrrev_b32 v14, 2, v14
    v_lshl_add_u32 v15, v14, 4, v15
    v_subrev_u32 v15, 528, v15
    v_add_u32 v139, s61, v15
    v_mul_u32_u24 v14, 1280, v13
    v_lshrrev_b32 v16, 1, v13
    v_lshl_add_u32 v14, v16, 6, v14
    v_cmp_eq_u32 vcc, 15, v12
    v_mov_b32 v15, 79
    v_mov_b32 v18, 0
    v_cndmask_b32 v15, v12, v15, vcc
    v_lshl_add_u32 v14, v15, 4, v14
    v_add_u32 v17, s61, v14
    v_mov_b32 v19, 0
    v_mov_b32 v20, 0
    v_mov_b32 v21, 0
    ds_write_b128 v17, v[18:21]
    ds_write_b128 v17, v[18:21] offset:5184
    v_and_b32 v22, 7, v0
    v_lshrrev_b32 v23, 3, v0
    s_lshl_b32 s3, s2, 3
    v_add_u32 v24, s3, v22
    v_lshlrev_b32 v134, 11, v24
    v_lshl_add_u32 v134, v23, 4, v134
    s_lshl_b32 s3, s32, 9
    v_add_u32 v134, s3, v134
    v_lshrrev_b32 v24, 2, v23
    s_lshl_b32 s3, s32, 3
    v_add_u32 v24, s3, v24
    v_mul_u32_u24 v135, 131072, v24
    v_and_b32 v23, 3, v23
    v_lshl_add_u32 v135, v23, 8, v135
    v_lshl_add_u32 v135, v22, 4, v135
    s_lshr_b32 s3, s2, 1
    s_lshl_b32 s3, s3, 10
    s_and_b32 s62, s2, 1
    s_lshl_b32 s62, s62, 7
    s_add_u32 s3, s3, s62
    v_add_u32 v135, s3, v135
    s_mov_b32 s48, s28
    s_mov_b32 s49, s29
    s_mov_b32 s50, 4194304
    s_mov_b32 s51, 0x20000
    s_waitcnt vmcnt(19)
    s_cmp_ge_u32 s32, 2
    s_cbranch_scc1 L_fused_kernel_wt_4
    s_cmp_ge_u32 s32, 1
    s_cbranch_scc1 L_fused_kernel_isl0_1
    s_branch L_fused_kernel_isl0_0
L_fused_kernel_wt_4:
    s_cmp_ge_u32 s32, 3
    s_cbranch_scc1 L_fused_kernel_isl0_3
    s_branch L_fused_kernel_isl0_2
L_fused_kernel_warmback0:
    s_branch L_fused_kernel_pc0
    .p2align 12
L_fused_kernel_isl0_0:
    s_branch L_fused_kernel_isl0_4
L_fused_kernel_pc0:
    s_waitcnt vmcnt(8)
    s_barrier
    ds_read_b64 v[10:11], v3 offset:640
    ds_read_b64 v[12:13], v3 offset:768
    ds_read_b64 v[14:15], v3 offset:896
    ds_read_b64 v[16:17], v3 offset:1056
    ds_read_b64 v[18:19], v3 offset:1184
    ds_read_b64 v[20:21], v3 offset:1312
    ds_read_b64 v[22:23], v3 offset:1440
    ds_read_b64 v[24:25], v3 offset:1568
    ds_read_b64 v[26:27], v3 offset:1696
    ds_read_b64 v[28:29], v3 offset:1824
    ds_read_b64 v[30:31], v3 offset:1952
    v_readfirstlane_b32 s30, v132
    v_readfirstlane_b32 s31, v133
    s_waitcnt lgkmcnt(4)
    ds_read_b64 v[32:33], v3 offset:19008
    ds_read_b64 v[34:35], v3 offset:19136
    ds_read_b64 v[36:37], v3 offset:19264
    ds_read_b64 v[38:39], v3 offset:19392
    ds_read_b64 v[40:41], v3 offset:19520
    ds_read_b64 v[42:43], v3 offset:19648
    ds_read_b64 v[44:45], v3 offset:19776
    ds_read_b64 v[46:47], v3 offset:19904
    s_waitcnt lgkmcnt(0)
    v_lshlrev_b32 v94, 16, v48
    v_and_b32 v96, 0xffff0000, v48
    v_lshlrev_b32 v98, 16, v49
    v_and_b32 v100, 0xffff0000, v49
    v_lshlrev_b32 v95, 16, v50
    v_and_b32 v97, 0xffff0000, v50
    v_lshlrev_b32 v99, 16, v51
    v_and_b32 v101, 0xffff0000, v51
    v_lshlrev_b32 v56, 16, v10
    v_and_b32 v57, 0xffff0000, v10
    v_lshlrev_b32 v58, 16, v12
    v_and_b32 v59, 0xffff0000, v12
    v_lshlrev_b32 v60, 16, v14
    v_and_b32 v61, 0xffff0000, v14
    v_lshlrev_b32 v62, 16, v16
    v_and_b32 v63, 0xffff0000, v16
    v_lshlrev_b32 v64, 16, v18
    v_and_b32 v65, 0xffff0000, v18
    v_lshlrev_b32 v66, 16, v20
    v_and_b32 v67, 0xffff0000, v20
    v_lshlrev_b32 v68, 16, v22
    v_and_b32 v69, 0xffff0000, v22
    v_lshlrev_b32 v70, 16, v24
    v_and_b32 v71, 0xffff0000, v24
    v_lshlrev_b32 v72, 16, v26
    v_and_b32 v73, 0xffff0000, v26
    v_lshlrev_b32 v74, 16, v28
    v_and_b32 v75, 0xffff0000, v28
    v_lshlrev_b32 v76, 16, v30
    v_and_b32 v77, 0xffff0000, v30
    v_lshlrev_b32 v78, 16, v32
    v_and_b32 v79, 0xffff0000, v32
    v_lshlrev_b32 v80, 16, v34
    v_and_b32 v81, 0xffff0000, v34
    v_lshlrev_b32 v82, 16, v36
    v_and_b32 v83, 0xffff0000, v36
    v_lshlrev_b32 v84, 16, v38
    v_and_b32 v85, 0xffff0000, v38
    v_lshlrev_b32 v86, 16, v40
    v_and_b32 v87, 0xffff0000, v40
    v_lshlrev_b32 v88, 16, v42
    v_and_b32 v89, 0xffff0000, v42
    v_lshlrev_b32 v90, 16, v44
    v_and_b32 v91, 0xffff0000, v44
    v_lshlrev_b32 v92, 16, v46
    v_and_b32 v93, 0xffff0000, v46
    v_pk_mul_f32 v[102:103], v[100:101], v[56:57]
    v_pk_mul_f32 v[104:105], v[100:101], v[58:59]
    v_pk_mul_f32 v[106:107], v[100:101], v[60:61]
    v_pk_mul_f32 v[108:109], v[100:101], v[62:63]
    v_pk_mul_f32 v[110:111], v[100:101], v[64:65]
    v_pk_mul_f32 v[112:113], v[100:101], v[66:67]
    v_pk_mul_f32 v[114:115], v[100:101], v[68:69]
    v_pk_mul_f32 v[116:117], v[100:101], v[70:71]
    v_pk_fma_f32 v[102:103], v[98:99], v[58:59], v[102:103]
    v_pk_fma_f32 v[104:105], v[98:99], v[60:61], v[104:105]
    v_pk_fma_f32 v[106:107], v[98:99], v[62:63], v[106:107]
    v_pk_fma_f32 v[108:109], v[98:99], v[64:65], v[108:109]
    v_pk_fma_f32 v[110:111], v[98:99], v[66:67], v[110:111]
    v_pk_fma_f32 v[112:113], v[98:99], v[68:69], v[112:113]
    v_pk_fma_f32 v[114:115], v[98:99], v[70:71], v[114:115]
    v_pk_fma_f32 v[116:117], v[98:99], v[72:73], v[116:117]
    v_pk_fma_f32 v[102:103], v[96:97], v[60:61], v[102:103]
    v_pk_fma_f32 v[104:105], v[96:97], v[62:63], v[104:105]
    v_pk_fma_f32 v[106:107], v[96:97], v[64:65], v[106:107]
    v_pk_fma_f32 v[108:109], v[96:97], v[66:67], v[108:109]
    v_pk_fma_f32 v[110:111], v[96:97], v[68:69], v[110:111]
    v_pk_fma_f32 v[112:113], v[96:97], v[70:71], v[112:113]
    v_pk_fma_f32 v[114:115], v[96:97], v[72:73], v[114:115]
    v_pk_fma_f32 v[116:117], v[96:97], v[74:75], v[116:117]
    v_pk_fma_f32 v[102:103], v[94:95], v[62:63], v[102:103]
    v_pk_fma_f32 v[104:105], v[94:95], v[64:65], v[104:105]
    v_pk_fma_f32 v[106:107], v[94:95], v[66:67], v[106:107]
    v_pk_fma_f32 v[108:109], v[94:95], v[68:69], v[108:109]
    v_pk_fma_f32 v[110:111], v[94:95], v[70:71], v[110:111]
    v_pk_fma_f32 v[112:113], v[94:95], v[72:73], v[112:113]
    v_pk_fma_f32 v[114:115], v[94:95], v[74:75], v[114:115]
    v_pk_fma_f32 v[116:117], v[94:95], v[76:77], v[116:117]
    v_pk_mul_f32 v[102:103], v[102:103], v[78:79]
    v_pk_mul_f32 v[104:105], v[104:105], v[80:81]
    v_pk_mul_f32 v[106:107], v[106:107], v[82:83]
    v_pk_mul_f32 v[108:109], v[108:109], v[84:85]
    v_pk_mul_f32 v[110:111], v[110:111], v[86:87]
    v_pk_mul_f32 v[112:113], v[112:113], v[88:89]
    v_pk_mul_f32 v[114:115], v[114:115], v[90:91]
    v_pk_mul_f32 v[116:117], v[116:117], v[92:93]
    v_cvt_pk_bf16_f32 v118, v116, v114
    v_cvt_pk_bf16_f32 v119, v112, v110
    v_cvt_pk_bf16_f32 v120, v108, v106
    v_cvt_pk_bf16_f32 v121, v104, v102
    s_mov_b32 s63, 0
    buffer_store_dwordx4 v[118:121], v8, s[48:51], s63 offen sc1
    v_cvt_pk_bf16_f32 v122, v117, v115
    v_cvt_pk_bf16_f32 v123, v113, v111
    v_cvt_pk_bf16_f32 v124, v109, v107
    v_cvt_pk_bf16_f32 v125, v105, v103
    s_mov_b32 s63, 4096
    buffer_store_dwordx4 v[122:125], v8, s[48:51], s63 offen sc1
    v_lshlrev_b32 v94, 16, v52
    v_and_b32 v96, 0xffff0000, v52
    v_lshlrev_b32 v98, 16, v53
    v_and_b32 v100, 0xffff0000, v53
    v_lshlrev_b32 v95, 16, v54
    v_and_b32 v97, 0xffff0000, v54
    v_lshlrev_b32 v99, 16, v55
    v_and_b32 v101, 0xffff0000, v55
    v_lshlrev_b32 v56, 16, v11
    v_and_b32 v57, 0xffff0000, v11
    v_lshlrev_b32 v58, 16, v13
    v_and_b32 v59, 0xffff0000, v13
    v_lshlrev_b32 v60, 16, v15
    v_and_b32 v61, 0xffff0000, v15
    v_lshlrev_b32 v62, 16, v17
    v_and_b32 v63, 0xffff0000, v17
    v_lshlrev_b32 v64, 16, v19
    v_and_b32 v65, 0xffff0000, v19
    v_lshlrev_b32 v66, 16, v21
    v_and_b32 v67, 0xffff0000, v21
    v_lshlrev_b32 v68, 16, v23
    v_and_b32 v69, 0xffff0000, v23
    v_lshlrev_b32 v70, 16, v25
    v_and_b32 v71, 0xffff0000, v25
    v_lshlrev_b32 v72, 16, v27
    v_and_b32 v73, 0xffff0000, v27
    v_lshlrev_b32 v74, 16, v29
    v_and_b32 v75, 0xffff0000, v29
    v_lshlrev_b32 v76, 16, v31
    v_and_b32 v77, 0xffff0000, v31
    v_lshlrev_b32 v78, 16, v33
    v_and_b32 v79, 0xffff0000, v33
    v_lshlrev_b32 v80, 16, v35
    v_and_b32 v81, 0xffff0000, v35
    v_lshlrev_b32 v82, 16, v37
    v_and_b32 v83, 0xffff0000, v37
    v_lshlrev_b32 v84, 16, v39
    v_and_b32 v85, 0xffff0000, v39
    v_lshlrev_b32 v86, 16, v41
    v_and_b32 v87, 0xffff0000, v41
    v_lshlrev_b32 v88, 16, v43
    v_and_b32 v89, 0xffff0000, v43
    v_lshlrev_b32 v90, 16, v45
    v_and_b32 v91, 0xffff0000, v45
    v_lshlrev_b32 v92, 16, v47
    v_and_b32 v93, 0xffff0000, v47
    v_pk_mul_f32 v[102:103], v[100:101], v[56:57]
    v_pk_mul_f32 v[104:105], v[100:101], v[58:59]
    v_pk_mul_f32 v[106:107], v[100:101], v[60:61]
    v_pk_mul_f32 v[108:109], v[100:101], v[62:63]
    v_pk_mul_f32 v[110:111], v[100:101], v[64:65]
    v_pk_mul_f32 v[112:113], v[100:101], v[66:67]
    v_pk_mul_f32 v[114:115], v[100:101], v[68:69]
    v_pk_mul_f32 v[116:117], v[100:101], v[70:71]
    v_pk_fma_f32 v[102:103], v[98:99], v[58:59], v[102:103]
    v_pk_fma_f32 v[104:105], v[98:99], v[60:61], v[104:105]
    v_pk_fma_f32 v[106:107], v[98:99], v[62:63], v[106:107]
    v_pk_fma_f32 v[108:109], v[98:99], v[64:65], v[108:109]
    v_pk_fma_f32 v[110:111], v[98:99], v[66:67], v[110:111]
    v_pk_fma_f32 v[112:113], v[98:99], v[68:69], v[112:113]
    v_pk_fma_f32 v[114:115], v[98:99], v[70:71], v[114:115]
    v_pk_fma_f32 v[116:117], v[98:99], v[72:73], v[116:117]
    v_pk_fma_f32 v[102:103], v[96:97], v[60:61], v[102:103]
    v_pk_fma_f32 v[104:105], v[96:97], v[62:63], v[104:105]
    v_pk_fma_f32 v[106:107], v[96:97], v[64:65], v[106:107]
    v_pk_fma_f32 v[108:109], v[96:97], v[66:67], v[108:109]
    v_pk_fma_f32 v[110:111], v[96:97], v[68:69], v[110:111]
    v_pk_fma_f32 v[112:113], v[96:97], v[70:71], v[112:113]
    v_pk_fma_f32 v[114:115], v[96:97], v[72:73], v[114:115]
    v_pk_fma_f32 v[116:117], v[96:97], v[74:75], v[116:117]
    v_pk_fma_f32 v[102:103], v[94:95], v[62:63], v[102:103]
    v_pk_fma_f32 v[104:105], v[94:95], v[64:65], v[104:105]
    v_pk_fma_f32 v[106:107], v[94:95], v[66:67], v[106:107]
    v_pk_fma_f32 v[108:109], v[94:95], v[68:69], v[108:109]
    v_pk_fma_f32 v[110:111], v[94:95], v[70:71], v[110:111]
    v_pk_fma_f32 v[112:113], v[94:95], v[72:73], v[112:113]
    v_pk_fma_f32 v[114:115], v[94:95], v[74:75], v[114:115]
    v_pk_fma_f32 v[116:117], v[94:95], v[76:77], v[116:117]
    v_pk_mul_f32 v[102:103], v[102:103], v[78:79]
    v_pk_mul_f32 v[104:105], v[104:105], v[80:81]
    v_pk_mul_f32 v[106:107], v[106:107], v[82:83]
    v_pk_mul_f32 v[108:109], v[108:109], v[84:85]
    v_pk_mul_f32 v[110:111], v[110:111], v[86:87]
    v_pk_mul_f32 v[112:113], v[112:113], v[88:89]
    v_pk_mul_f32 v[114:115], v[114:115], v[90:91]
    v_pk_mul_f32 v[116:117], v[116:117], v[92:93]
    v_cvt_pk_bf16_f32 v126, v116, v114
    v_cvt_pk_bf16_f32 v127, v112, v110
    v_cvt_pk_bf16_f32 v128, v108, v106
    v_cvt_pk_bf16_f32 v129, v104, v102
    s_mov_b32 s63, 8192
    buffer_store_dwordx4 v[126:129], v8, s[48:51], s63 offen sc1
    v_cvt_pk_bf16_f32 v118, v117, v115
    v_cvt_pk_bf16_f32 v119, v113, v111
    v_cvt_pk_bf16_f32 v120, v109, v107
    v_cvt_pk_bf16_f32 v121, v105, v103
    s_mov_b32 s63, 12288
    buffer_store_dwordx4 v[118:121], v8, s[48:51], s63 offen sc1
    s_lshl_b32 s63, s33, 12
    s_add_u32 s63, s63, 32768
    s_lshl_b32 s3, s34, 7
    s_add_u32 s3, s3, s63
    v_mbcnt_lo_u32_b32 v0, -1, 0
    v_mbcnt_hi_u32_b32 v0, -1, v0
    v_lshlrev_b32 v0, 7, v0
    v_add_u32 v0, s63, v0
    s_waitcnt vmcnt(0)
    s_barrier
    s_add_u32 s62, s30, 1
    s_addc_u32 s63, s31, 0
    s_cmp_lg_u32 s32, 0
    s_cbranch_scc1 L_fused_kernel_pub_7
    v_mov_b32 v2, s62
    v_mov_b32 v3, s63
    v_mov_b32 v4, 0x7ff00000
    v_writelane_b32 v4, 0, 0
    buffer_store_dwordx2 v[2:3], v4, s[36:39], s3 offen sc1
L_fused_kernel_pub_7:
    s_lshl_b32 s3, s60, 12
    s_add_u32 m0, s61, 14544
    s_add_u32 s16, s3, 4
    buffer_load_dwordx4 v136, s[52:55], s16 offen offset:0 lds
    buffer_load_dwordx4 v136, s[52:55], s16 offen offset:1024 lds
    buffer_load_dwordx4 v136, s[52:55], s16 offen offset:2048 lds
    buffer_load_dwordx4 v136, s[52:55], s16 offen offset:3072 lds
    s_add_u32 m0, s61, 18704
    s_add_u32 s16, s3, 8
    buffer_load_dwordx4 v136, s[52:55], s16 offen offset:0 lds
    buffer_load_dwordx4 v136, s[52:55], s16 offen offset:1024 lds
    buffer_load_dwordx4 v136, s[52:55], s16 offen offset:2048 lds
    buffer_load_dwordx4 v136, s[52:55], s16 offen offset:3072 lds
    s_add_u32 m0, s61, 22864
    s_add_u32 s16, s3, 12
    buffer_load_dwordx4 v136, s[52:55], s16 offen offset:0 lds
    buffer_load_dwordx4 v136, s[52:55], s16 offen offset:1024 lds
    buffer_load_dwordx4 v136, s[52:55], s16 offen offset:2048 lds
    buffer_load_dwordx4 v136, s[52:55], s16 offen offset:3072 lds
    s_cmp_lg_u32 s32, 0
    s_cbranch_scc1 L_fused_kernel_wo_11
    s_mov_b32 s35, 400000
    s_mov_b64 exec, 0xffffffff
L_fused_kernel_poll_9:
    buffer_load_dwordx2 v[2:3], v0, s[36:39], 0 offen sc1
    s_sub_u32 s35, s35, 1
    s_cbranch_scc1 L_fused_kernel_pd_10
    s_waitcnt vmcnt(0)
    v_cmp_ne_u64 vcc, s[62:63], v[2:3]
    s_nop 4
    s_and_b64 exec, exec, vcc
    s_cbranch_execnz L_fused_kernel_poll_9
L_fused_kernel_pd_10:
    s_mov_b64 exec, -1
    s_waitcnt vmcnt(0)
    s_branch L_fused_kernel_wf_8
L_fused_kernel_wo_11:
    s_waitcnt vmcnt(0)
    ds_read_b128 a[4:7], v137 offset:48
    ds_read_b128 a[8:11], v137 offset:112
    ds_read_b128 a[12:15], v137 offset:176
    ds_read_b128 a[16:19], v137 offset:240
    ds_read_b128 a[20:23], v137 offset:304
    ds_read_b128 a[24:27], v137 offset:368
    ds_read_b128 a[28:31], v137 offset:432
    ds_read_b128 a[32:35], v137 offset:496
    ds_read_b128 a[36:39], v137 offset:560
    ds_read_b128 a[40:43], v137 offset:624
    ds_read_b128 a[44:47], v137 offset:688
    ds_read_b128 a[48:51], v137 offset:752
    ds_read_b128 a[52:55], v137 offset:816
    ds_read_b128 a[56:59], v137 offset:880
    ds_read_b128 a[60:63], v137 offset:944
    ds_read_b128 a[64:67], v137 offset:1008
    ds_read_b128 a[68:71], v137 offset:1072
    ds_read_b128 a[72:75], v137 offset:1136
    ds_read_b128 a[76:79], v137 offset:1200
    ds_read_b128 a[80:83], v137 offset:1264
    ds_read_b128 a[84:87], v137 offset:1328
    ds_read_b128 a[88:91], v137 offset:1392
    ds_read_b128 a[92:95], v137 offset:1456
    ds_read_b128 a[96:99], v137 offset:1520
    ds_read_b128 a[100:103], v137 offset:1584
    ds_read_b128 a[104:107], v137 offset:1648
    ds_read_b128 a[108:111], v137 offset:1712
    ds_read_b128 a[112:115], v137 offset:1776
    ds_read_b128 a[116:119], v137 offset:1840
    ds_read_b128 a[120:123], v137 offset:1904
    ds_read_b128 a[124:127], v137 offset:1968
    ds_read_b128 a[128:131], v137 offset:2032
    ds_read_b128 a[132:135], v137 offset:2096
    ds_read_b128 a[136:139], v137 offset:2160
    ds_read_b128 a[140:143], v137 offset:2224
    ds_read_b128 a[144:147], v137 offset:2288
    ds_read_b128 a[148:151], v137 offset:2352
    ds_read_b128 a[152:155], v137 offset:2416
    ds_read_b128 a[156:159], v137 offset:2480
    ds_read_b128 a[160:163], v137 offset:2544
    ds_read_b128 a[164:167], v137 offset:2608
    ds_read_b128 a[168:171], v137 offset:2672
    ds_read_b128 a[172:175], v137 offset:2736
    ds_read_b128 a[176:179], v137 offset:2800
    ds_read_b128 a[180:183], v137 offset:2864
    ds_read_b128 a[184:187], v137 offset:2928
    ds_read_b128 a[188:191], v137 offset:2992
    ds_read_b128 a[192:195], v137 offset:3056
    ds_read_b128 a[196:199], v137 offset:3120
    ds_read_b128 a[200:203], v137 offset:3184
    ds_read_b128 a[204:207], v137 offset:3248
    ds_read_b128 a[208:211], v137 offset:3312
    ds_read_b128 a[212:215], v137 offset:3376
    ds_read_b128 a[216:219], v137 offset:3440
    ds_read_b128 a[220:223], v137 offset:3504
    ds_read_b128 a[224:227], v137 offset:3568
    ds_read_b128 a[228:231], v137 offset:3632
    ds_read_b128 a[232:235], v137 offset:3696
    ds_read_b128 a[236:239], v137 offset:3760
    ds_read_b128 a[240:243], v137 offset:3824
    ds_read_b128 a[244:247], v137 offset:3888
    ds_read_b128 a[248:251], v137 offset:3952
    ds_read_b128 a[252:255], v137 offset:4016
L_fused_kernel_wf_8:
    s_barrier
    s_mul_i32 s3, s60, 4096
    s_add_u32 s16, s3, 0
    buffer_load_dwordx4 v[32:35], v136, s[48:51], s16 offen sc1
    s_add_u32 s16, s3, 1024
    buffer_load_dwordx4 v[36:39], v136, s[48:51], s16 offen sc1
    s_add_u32 s16, s3, 2048
    buffer_load_dwordx4 v[40:43], v136, s[48:51], s16 offen sc1
    s_add_u32 s16, s3, 3072
    buffer_load_dwordx4 v[44:47], v136, s[48:51], s16 offen sc1
    s_cmp_lg_u32 s32, 0
    s_cbranch_scc1 L_fused_kernel_w0_12
    ds_read_b128 a[4:7], v137 offset:48
    ds_read_b128 a[8:11], v137 offset:112
    ds_read_b128 a[12:15], v137 offset:176
    ds_read_b128 a[16:19], v137 offset:240
    ds_read_b128 a[20:23], v137 offset:304
    ds_read_b128 a[24:27], v137 offset:368
    ds_read_b128 a[28:31], v137 offset:432
    ds_read_b128 a[32:35], v137 offset:496
    ds_read_b128 a[36:39], v137 offset:560
    ds_read_b128 a[40:43], v137 offset:624
    ds_read_b128 a[44:47], v137 offset:688
    ds_read_b128 a[48:51], v137 offset:752
    ds_read_b128 a[52:55], v137 offset:816
    ds_read_b128 a[56:59], v137 offset:880
    ds_read_b128 a[60:63], v137 offset:944
    ds_read_b128 a[64:67], v137 offset:1008
    ds_read_b128 a[68:71], v137 offset:1072
    ds_read_b128 a[72:75], v137 offset:1136
    ds_read_b128 a[76:79], v137 offset:1200
    ds_read_b128 a[80:83], v137 offset:1264
    ds_read_b128 a[84:87], v137 offset:1328
    ds_read_b128 a[88:91], v137 offset:1392
    ds_read_b128 a[92:95], v137 offset:1456
    ds_read_b128 a[96:99], v137 offset:1520
    ds_read_b128 a[100:103], v137 offset:1584
    ds_read_b128 a[104:107], v137 offset:1648
    ds_read_b128 a[108:111], v137 offset:1712
    ds_read_b128 a[112:115], v137 offset:1776
    ds_read_b128 a[116:119], v137 offset:1840
    ds_read_b128 a[120:123], v137 offset:1904
    ds_read_b128 a[124:127], v137 offset:1968
    ds_read_b128 a[128:131], v137 offset:2032
    ds_read_b128 a[132:135], v137 offset:2096
    ds_read_b128 a[136:139], v137 offset:2160
    ds_read_b128 a[140:143], v137 offset:2224
    ds_read_b128 a[144:147], v137 offset:2288
    ds_read_b128 a[148:151], v137 offset:2352
    ds_read_b128 a[152:155], v137 offset:2416
    ds_read_b128 a[156:159], v137 offset:2480
    ds_read_b128 a[160:163], v137 offset:2544
    ds_read_b128 a[164:167], v137 offset:2608
    ds_read_b128 a[168:171], v137 offset:2672
    ds_read_b128 a[172:175], v137 offset:2736
    ds_read_b128 a[176:179], v137 offset:2800
    ds_read_b128 a[180:183], v137 offset:2864
    ds_read_b128 a[184:187], v137 offset:2928
    ds_read_b128 a[188:191], v137 offset:2992
    ds_read_b128 a[192:195], v137 offset:3056
    ds_read_b128 a[196:199], v137 offset:3120
    ds_read_b128 a[200:203], v137 offset:3184
    ds_read_b128 a[204:207], v137 offset:3248
    ds_read_b128 a[208:211], v137 offset:3312
    ds_read_b128 a[212:215], v137 offset:3376
    ds_read_b128 a[216:219], v137 offset:3440
    ds_read_b128 a[220:223], v137 offset:3504
    ds_read_b128 a[224:227], v137 offset:3568
    ds_read_b128 a[228:231], v137 offset:3632
    ds_read_b128 a[232:235], v137 offset:3696
    ds_read_b128 a[236:239], v137 offset:3760
    ds_read_b128 a[240:243], v137 offset:3824
    ds_read_b128 a[244:247], v137 offset:3888
    ds_read_b128 a[248:251], v137 offset:3952
    ds_read_b128 a[252:255], v137 offset:4016
L_fused_kernel_w0_12:
    s_mov_b32 s44, s18
    s_mov_b32 s45, s19
    s_mov_b32 s46, 7340032
    s_mov_b32 s47, 0x20000
    s_mov_b32 s52, s20
    s_mov_b32 s53, s21
    s_mov_b32 s54, 7340032
    s_mov_b32 s55, 0x20000
    s_lshl_b32 s3, s2, 2
    s_add_u32 s3, s3, s32
    s_mul_i32 s3, s3, 3584
    v_lshlrev_b32 v116, 3, v136
    v_add_u32 v102, s3, v116
    v_mov_b32 v116, 0x7ff00000
    v_cmp_gt_u32 vcc, 256, v136
    s_nop 1
    v_cndmask_b32 v102, v116, v102, vcc
    s_add_u32 s40, s28, 8388608
    s_addc_u32 s41, s29, 0
    s_mov_b32 s42, 4194304
    s_mov_b32 s43, 0x20000
    s_mov_b32 s56, s4
    s_mov_b32 s57, s5
    s_mov_b32 s58, 4194304
    s_mov_b32 s59, 0x20000
    v_mbcnt_lo_u32_b32 v116, -1, 0
    v_mbcnt_hi_u32_b32 v116, -1, v116
    s_and_b32 s16, s60, 1
    s_lshl_b32 s16, s16, 4
    s_lshr_b32 s17, s17, s16
    s_lshl_b32 s17, s17, 16
    v_and_b32 v117, 15, v116
    v_lshrrev_b32 v118, 4, v116
    v_add_u32 v112, s32, v117
    v_and_b32 v112, 3, v112
    v_lshl_add_u32 v118, v117, 2, v118
    v_bfe_u32 v117, v117, 2, 1
    v_xor_b32 v117, v117, v118
    v_lshlrev_b32 v117, 6, v117
    v_lshl_add_u32 v112, v112, 4, v117
    s_lshl_b32 s16, s32, 4
    s_and_b32 s16, s16, 0
    s_add_u32 s16, s16, 131072
    v_add_u32 v112, s16, v112
    v_lshrrev_b32 v117, 2, v116
    s_and_b32 s16, s32, 1
    v_xor_b32 v117, s16, v117
    v_lshlrev_b32 v117, 6, v117
    v_lshrrev_b32 v118, 4, v116
    v_add_u32 v118, v118, v116
    v_and_b32 v118, 3, v118
    v_lshl_add_u32 v117, v118, 4, v117
    s_lshl_b32 s16, s32, 10
    s_add_u32 s16, s16, 131072
    v_add_u32 v113, s16, v117
    v_lshrrev_b32 v117, 2, v116
    v_lshlrev_b32 v114, 17, v117
    v_and_b32 v117, 7, v117
    v_lshlrev_b32 v117, 7, v117
    v_and_b32 v118, 3, v116
    v_lshl_add_u32 v117, v118, 4, v117
    s_and_b32 s16, s60, 0xfffffffc
    s_lshl_b32 s16, s16, 4
    v_add_u32 v117, s16, v117
    v_and_b32 v117, 16383, v117
    v_add_u32 v114, v114, v117
    s_and_b32 s16, s32, 1
    s_lshl_b32 s16, s16, 21
    s_lshr_b32 s3, s32, 1
    s_lshl_b32 s3, s3, 14
    s_add_u32 s16, s16, s3
    v_add_u32 v114, s16, v114
    v_mov_b32 v0, 0
    v_mov_b32 v1, 0
    v_mov_b32 v2, 0
    v_mov_b32 v3, 0
    v_mov_b32 v4, 0
    v_mov_b32 v5, 0
    v_mov_b32 v6, 0
    v_mov_b32 v7, 0
    v_mov_b32 v8, 0
    v_mov_b32 v9, 0
    v_mov_b32 v10, 0
    v_mov_b32 v11, 0
    v_mov_b32 v12, 0
    v_mov_b32 v13, 0
    v_mov_b32 v14, 0
    v_mov_b32 v15, 0
    v_mov_b32 v16, 0
    v_mov_b32 v17, 0
    v_mov_b32 v18, 0
    v_mov_b32 v19, 0
    v_mov_b32 v20, 0
    v_mov_b32 v21, 0
    v_mov_b32 v22, 0
    v_mov_b32 v23, 0
    v_mov_b32 v24, 0
    v_mov_b32 v25, 0
    v_mov_b32 v26, 0
    v_mov_b32 v27, 0
    v_mov_b32 v28, 0
    v_mov_b32 v29, 0
    v_mov_b32 v30, 0
    v_mov_b32 v31, 0
    s_waitcnt vmcnt(0)
    ds_write_b128 v139, v[32:35] offset:5952
    ds_write_b128 v139, v[36:39] offset:5696
    ds_write_b128 v139, v[40:43] offset:5440
    ds_write_b128 v139, v[44:47] offset:5184
    v_mov_b32_dpp v116, v32 wave_shl:1 row_mask:0xf bank_mask:0xf
    v_readlane_b32 s16, v36, 0
    s_nop 1
    v_writelane_b32 v116, s16, 63
    v_alignbit_b32 v48, v33, v32, 16
    v_alignbit_b32 v49, v34, v33, 16
    v_alignbit_b32 v50, v35, v34, 16
    v_alignbit_b32 v51, v116, v35, 16
    ds_write_b128 v139, v[48:51] offset:768
    v_mov_b32_dpp v116, v36 wave_shl:1 row_mask:0xf bank_mask:0xf
    v_readlane_b32 s16, v40, 0
    s_nop 1
    v_writelane_b32 v116, s16, 63
    v_alignbit_b32 v52, v37, v36, 16
    v_alignbit_b32 v53, v38, v37, 16
    v_alignbit_b32 v54, v39, v38, 16
    v_alignbit_b32 v55, v116, v39, 16
    ds_write_b128 v139, v[52:55] offset:512
    v_mov_b32_dpp v116, v40 wave_shl:1 row_mask:0xf bank_mask:0xf
    v_readlane_b32 s16, v44, 0
    s_nop 1
    v_writelane_b32 v116, s16, 63
    v_alignbit_b32 v56, v41, v40, 16
    v_alignbit_b32 v57, v42, v41, 16
    v_alignbit_b32 v58, v43, v42, 16
    v_alignbit_b32 v59, v116, v43, 16
    ds_write_b128 v139, v[56:59] offset:256
    v_mov_b32_dpp v116, v44 wave_shl:1 row_mask:0xf bank_mask:0xf
    v_writelane_b32 v116, 0, 63
    v_alignbit_b32 v60, v45, v44, 16
    v_alignbit_b32 v61, v46, v45, 16
    v_alignbit_b32 v62, v47, v46, 16
    v_alignbit_b32 v63, v116, v47, 16
    ds_write_b128 v139, v[60:63] offset:0
    s_waitcnt lgkmcnt(0)
    ds_read_b128 v[32:35], v138 offset:0
    ds_read_b128 v[36:39], v138 offset:5184
    ds_read_b128 v[40:43], v138 offset:16
    ds_read_b128 v[44:47], v138 offset:5200
    ds_read_b128 v[48:51], v138 offset:32
    ds_read_b128 v[52:55], v138 offset:5216
    s_waitcnt lgkmcnt(4)
    v_mfma_f32_16x16x32_bf16 v[0:3], a[60:63], v[32:35], v[0:3]
    ds_read_b128 v[56:59], v138 offset:48
    v_mfma_f32_16x16x32_bf16 v[4:7], a[60:63], v[36:39], v[4:7]
    ds_read_b128 v[60:63], v138 offset:5232
    v_mfma_f32_16x16x32_bf16 v[8:11], a[124:127], v[32:35], v[8:11]
    v_mfma_f32_16x16x32_bf16 v[12:15], a[124:127], v[36:39], v[12:15]
    buffer_load_dwordx4 v[144:147], v134, s[56:59], 0 offen offset:0
    v_mfma_f32_16x16x32_bf16 v[16:19], a[188:191], v[32:35], v[16:19]
    v_mfma_f32_16x16x32_bf16 v[20:23], a[188:191], v[36:39], v[20:23]
    v_mfma_f32_16x16x32_bf16 v[24:27], a[252:255], v[32:35], v[24:27]
    v_mfma_f32_16x16x32_bf16 v[28:31], a[252:255], v[36:39], v[28:31]
    s_waitcnt lgkmcnt(4)
    v_mfma_f32_16x16x32_bf16 v[0:3], a[56:59], v[40:43], v[0:3]
    ds_read_b128 v[64:67], v138 offset:64
    v_mfma_f32_16x16x32_bf16 v[4:7], a[56:59], v[44:47], v[4:7]
    ds_read_b128 v[68:71], v138 offset:5248
    v_mfma_f32_16x16x32_bf16 v[8:11], a[120:123], v[40:43], v[8:11]
    ds_read_b128 v[72:75], v138 offset:80
    v_mfma_f32_16x16x32_bf16 v[12:15], a[120:123], v[44:47], v[12:15]
    buffer_load_dwordx4 v[148:151], v134, s[56:59], 0 offen offset:128
    ds_read_b128 v[76:79], v138 offset:5264
    v_mfma_f32_16x16x32_bf16 v[16:19], a[184:187], v[40:43], v[16:19]
    ds_read_b128 v[32:35], v138 offset:96
    v_mfma_f32_16x16x32_bf16 v[20:23], a[184:187], v[44:47], v[20:23]
    ds_read_b128 v[36:39], v138 offset:5280
    v_mfma_f32_16x16x32_bf16 v[24:27], a[248:251], v[40:43], v[24:27]
    v_mfma_f32_16x16x32_bf16 v[28:31], a[248:251], v[44:47], v[28:31]
    s_waitcnt lgkmcnt(8)
    v_mfma_f32_16x16x32_bf16 v[0:3], a[52:55], v[48:51], v[0:3]
    ds_read_b128 v[40:43], v138 offset:112
    v_mfma_f32_16x16x32_bf16 v[4:7], a[52:55], v[52:55], v[4:7]
    ds_read_b128 v[44:47], v138 offset:5296
    v_mfma_f32_16x16x32_bf16 v[8:11], a[116:119], v[48:51], v[8:11]
    v_mfma_f32_16x16x32_bf16 v[12:15], a[116:119], v[52:55], v[12:15]
    buffer_load_dwordx4 v[152:155], v134, s[56:59], 0 offen offset:256
    v_mfma_f32_16x16x32_bf16 v[16:19], a[180:183], v[48:51], v[16:19]
    s_branch L_fused_kernel_pc1
L_fused_kernel_isl0_1:
    s_branch L_fused_kernel_isl0_5
L_fused_kernel_pc1:
    v_mfma_f32_16x16x32_bf16 v[20:23], a[180:183], v[52:55], v[20:23]
    v_mfma_f32_16x16x32_bf16 v[24:27], a[244:247], v[48:51], v[24:27]
    v_mfma_f32_16x16x32_bf16 v[28:31], a[244:247], v[52:55], v[28:31]
    s_waitcnt lgkmcnt(8)
    v_mfma_f32_16x16x32_bf16 v[0:3], a[48:51], v[56:59], v[0:3]
    ds_read_b128 v[48:51], v138 offset:128
    v_mfma_f32_16x16x32_bf16 v[4:7], a[48:51], v[60:63], v[4:7]
    ds_read_b128 v[52:55], v138 offset:5312
    v_mfma_f32_16x16x32_bf16 v[8:11], a[112:115], v[56:59], v[8:11]
    v_mfma_f32_16x16x32_bf16 v[12:15], a[112:115], v[60:63], v[12:15]
    buffer_load_dwordx4 v[156:159], v134, s[56:59], 0 offen offset:384
    v_mfma_f32_16x16x32_bf16 v[16:19], a[176:179], v[56:59], v[16:19]
    v_mfma_f32_16x16x32_bf16 v[20:23], a[176:179], v[60:63], v[20:23]
    v_mfma_f32_16x16x32_bf16 v[24:27], a[240:243], v[56:59], v[24:27]
    v_mfma_f32_16x16x32_bf16 v[28:31], a[240:243], v[60:63], v[28:31]
    s_waitcnt lgkmcnt(8)
    v_mfma_f32_16x16x32_bf16 v[0:3], a[44:47], v[64:67], v[0:3]
    ds_read_b128 v[56:59], v138 offset:144
    v_mfma_f32_16x16x32_bf16 v[4:7], a[44:47], v[68:71], v[4:7]
    ds_read_b128 v[60:63], v138 offset:5328
    v_mfma_f32_16x16x32_bf16 v[8:11], a[108:111], v[64:67], v[8:11]
    v_mfma_f32_16x16x32_bf16 v[12:15], a[108:111], v[68:71], v[12:15]
    v_mfma_f32_16x16x32_bf16 v[16:19], a[172:175], v[64:67], v[16:19]
    v_mfma_f32_16x16x32_bf16 v[20:23], a[172:175], v[68:71], v[20:23]
    v_mfma_f32_16x16x32_bf16 v[24:27], a[236:239], v[64:67], v[24:27]
    v_mfma_f32_16x16x32_bf16 v[28:31], a[236:239], v[68:71], v[28:31]
    s_waitcnt lgkmcnt(8)
    v_mfma_f32_16x16x32_bf16 v[0:3], a[40:43], v[72:75], v[0:3]
    ds_read_b128 v[64:67], v138 offset:160
    v_mfma_f32_16x16x32_bf16 v[4:7], a[40:43], v[76:79], v[4:7]
    ds_read_b128 v[68:71], v138 offset:5344
    v_mfma_f32_16x16x32_bf16 v[8:11], a[104:107], v[72:75], v[8:11]
    v_mfma_f32_16x16x32_bf16 v[12:15], a[104:107], v[76:79], v[12:15]
    v_mfma_f32_16x16x32_bf16 v[16:19], a[168:171], v[72:75], v[16:19]
    v_mfma_f32_16x16x32_bf16 v[20:23], a[168:171], v[76:79], v[20:23]
    v_mfma_f32_16x16x32_bf16 v[24:27], a[232:235], v[72:75], v[24:27]
    v_mfma_f32_16x16x32_bf16 v[28:31], a[232:235], v[76:79], v[28:31]
    s_waitcnt lgkmcnt(8)
    v_mfma_f32_16x16x32_bf16 v[0:3], a[36:39], v[32:35], v[0:3]
    ds_read_b128 v[72:75], v138 offset:176
    v_mfma_f32_16x16x32_bf16 v[4:7], a[36:39], v[36:39], v[4:7]
    ds_read_b128 v[76:79], v138 offset:5360
    v_mfma_f32_16x16x32_bf16 v[8:11], a[100:103], v[32:35], v[8:11]
    v_mfma_f32_16x16x32_bf16 v[12:15], a[100:103], v[36:39], v[12:15]
    v_mfma_f32_16x16x32_bf16 v[16:19], a[164:167], v[32:35], v[16:19]
    v_mfma_f32_16x16x32_bf16 v[20:23], a[164:167], v[36:39], v[20:23]
    v_mfma_f32_16x16x32_bf16 v[24:27], a[228:231], v[32:35], v[24:27]
    v_mfma_f32_16x16x32_bf16 v[28:31], a[228:231], v[36:39], v[28:31]
    s_waitcnt lgkmcnt(8)
    v_mfma_f32_16x16x32_bf16 v[0:3], a[32:35], v[40:43], v[0:3]
    ds_read_b128 v[32:35], v138 offset:192
    v_mfma_f32_16x16x32_bf16 v[4:7], a[32:35], v[44:47], v[4:7]
    ds_read_b128 v[36:39], v138 offset:5376
    v_mfma_f32_16x16x32_bf16 v[8:11], a[96:99], v[40:43], v[8:11]
    v_mfma_f32_16x16x32_bf16 v[12:15], a[96:99], v[44:47], v[12:15]
    v_mfma_f32_16x16x32_bf16 v[16:19], a[160:163], v[40:43], v[16:19]
    v_mfma_f32_16x16x32_bf16 v[20:23], a[160:163], v[44:47], v[20:23]
    v_mfma_f32_16x16x32_bf16 v[24:27], a[224:227], v[40:43], v[24:27]
    v_mfma_f32_16x16x32_bf16 v[28:31], a[224:227], v[44:47], v[28:31]
    s_waitcnt lgkmcnt(8)
    v_mfma_f32_16x16x32_bf16 v[0:3], a[28:31], v[48:51], v[0:3]
    ds_read_b128 v[40:43], v138 offset:208
    v_mfma_f32_16x16x32_bf16 v[4:7], a[28:31], v[52:55], v[4:7]
    ds_read_b128 v[44:47], v138 offset:5392
    v_mfma_f32_16x16x32_bf16 v[8:11], a[92:95], v[48:51], v[8:11]
    v_mfma_f32_16x16x32_bf16 v[12:15], a[92:95], v[52:55], v[12:15]
    v_mfma_f32_16x16x32_bf16 v[16:19], a[156:159], v[48:51], v[16:19]
    v_mfma_f32_16x16x32_bf16 v[20:23], a[156:159], v[52:55], v[20:23]
    s_mov_b32 s3, 0
    buffer_load_dword v100, v102, s[44:47], s3 offen
    v_mfma_f32_16x16x32_bf16 v[24:27], a[220:223], v[48:51], v[24:27]
    v_mfma_f32_16x16x32_bf16 v[28:31], a[220:223], v[52:55], v[28:31]
    s_waitcnt lgkmcnt(8)
    v_mfma_f32_16x16x32_bf16 v[0:3], a[24:27], v[56:59], v[0:3]
    ds_read_b128 v[48:51], v138 offset:224
    v_mfma_f32_16x16x32_bf16 v[4:7], a[24:27], v[60:63], v[4:7]
    ds_read_b128 v[52:55], v138 offset:5408
    v_mfma_f32_16x16x32_bf16 v[8:11], a[88:91], v[56:59], v[8:11]
    v_mfma_f32_16x16x32_bf16 v[12:15], a[88:91], v[60:63], v[12:15]
    v_mfma_f32_16x16x32_bf16 v[16:19], a[152:155], v[56:59], v[16:19]
    v_mfma_f32_16x16x32_bf16 v[20:23], a[152:155], v[60:63], v[20:23]
    v_mfma_f32_16x16x32_bf16 v[24:27], a[216:219], v[56:59], v[24:27]
    v_mfma_f32_16x16x32_bf16 v[28:31], a[216:219], v[60:63], v[28:31]
    s_waitcnt lgkmcnt(8)
    v_mfma_f32_16x16x32_bf16 v[0:3], a[20:23], v[64:67], v[0:3]
    ds_read_b128 v[56:59], v138 offset:240
    v_mfma_f32_16x16x32_bf16 v[4:7], a[20:23], v[68:71], v[4:7]
    ds_read_b128 v[60:63], v138 offset:5424
    v_mfma_f32_16x16x32_bf16 v[8:11], a[84:87], v[64:67], v[8:11]
    v_mfma_f32_16x16x32_bf16 v[12:15], a[84:87], v[68:71], v[12:15]
    v_mfma_f32_16x16x32_bf16 v[16:19], a[148:151], v[64:67], v[16:19]
    v_mfma_f32_16x16x32_bf16 v[20:23], a[148:151], v[68:71], v[20:23]
    v_mfma_f32_16x16x32_bf16 v[24:27], a[212:215], v[64:67], v[24:27]
    v_mfma_f32_16x16x32_bf16 v[28:31], a[212:215], v[68:71], v[28:31]
    s_waitcnt lgkmcnt(8)
    v_mfma_f32_16x16x32_bf16 v[0:3], a[16:19], v[72:75], v[0:3]
    ds_read_b128 v[64:67], v138 offset:256
    v_mfma_f32_16x16x32_bf16 v[4:7], a[16:19], v[76:79], v[4:7]
    ds_read_b128 v[68:71], v138 offset:5440
    v_mfma_f32_16x16x32_bf16 v[8:11], a[80:83], v[72:75], v[8:11]
    v_mfma_f32_16x16x32_bf16 v[12:15], a[80:83], v[76:79], v[12:15]
    v_mfma_f32_16x16x32_bf16 v[16:19], a[144:147], v[72:75], v[16:19]
    v_mfma_f32_16x16x32_bf16 v[20:23], a[144:147], v[76:79], v[20:23]
    v_mfma_f32_16x16x32_bf16 v[24:27], a[208:211], v[72:75], v[24:27]
    v_mfma_f32_16x16x32_bf16 v[28:31], a[208:211], v[76:79], v[28:31]
    s_waitcnt lgkmcnt(8)
    v_mfma_f32_16x16x32_bf16 v[0:3], a[12:15], v[32:35], v[0:3]
    ds_read_b128 v[72:75], v138 offset:272
    v_mfma_f32_16x16x32_bf16 v[4:7], a[12:15], v[36:39], v[4:7]
    ds_read_b128 v[76:79], v138 offset:5456
    v_mfma_f32_16x16x32_bf16 v[8:11], a[76:79], v[32:35], v[8:11]
    v_mfma_f32_16x16x32_bf16 v[12:15], a[76:79], v[36:39], v[12:15]
    v_mfma_f32_16x16x32_bf16 v[16:19], a[140:143], v[32:35], v[16:19]
    v_mfma_f32_16x16x32_bf16 v[20:23], a[140:143], v[36:39], v[20:23]
    v_mfma_f32_16x16x32_bf16 v[24:27], a[204:207], v[32:35], v[24:27]
    v_mfma_f32_16x16x32_bf16 v[28:31], a[204:207], v[36:39], v[28:31]
    s_waitcnt lgkmcnt(8)
    v_mfma_f32_16x16x32_bf16 v[0:3], a[8:11], v[40:43], v[0:3]
    ds_read_b128 v[32:35], v138 offset:288
    v_mfma_f32_16x16x32_bf16 v[4:7], a[8:11], v[44:47], v[4:7]
    ds_read_b128 v[36:39], v138 offset:5472
    v_mfma_f32_16x16x32_bf16 v[8:11], a[72:75], v[40:43], v[8:11]
    v_mfma_f32_16x16x32_bf16 v[12:15], a[72:75], v[44:47], v[12:15]
    v_mfma_f32_16x16x32_bf16 v[16:19], a[136:139], v[40:43], v[16:19]
    v_mfma_f32_16x16x32_bf16 v[20:23], a[136:139], v[44:47], v[20:23]
    v_mfma_f32_16x16x32_bf16 v[24:27], a[200:203], v[40:43], v[24:27]
    v_mfma_f32_16x16x32_bf16 v[28:31], a[200:203], v[44:47], v[28:31]
    s_waitcnt lgkmcnt(8)
    v_mfma_f32_16x16x32_bf16 v[0:3], a[4:7], v[48:51], v[0:3]
    ds_read_b128 v[40:43], v138 offset:304
    v_mfma_f32_16x16x32_bf16 v[4:7], a[4:7], v[52:55], v[4:7]
    ds_read_b128 v[44:47], v138 offset:5488
    v_mfma_f32_16x16x32_bf16 v[8:11], a[68:71], v[48:51], v[8:11]
    v_mfma_f32_16x16x32_bf16 v[12:15], a[68:71], v[52:55], v[12:15]
    v_mfma_f32_16x16x32_bf16 v[16:19], a[132:135], v[48:51], v[16:19]
    v_mfma_f32_16x16x32_bf16 v[20:23], a[132:135], v[52:55], v[20:23]
    v_mfma_f32_16x16x32_bf16 v[24:27], a[196:199], v[48:51], v[24:27]
    v_mfma_f32_16x16x32_bf16 v[28:31], a[196:199], v[52:55], v[28:31]
    s_waitcnt lgkmcnt(8)
    v_mfma_f32_16x16x32_bf16 v[0:3], a[0:3], v[56:59], v[0:3]
    v_lshlrev_b32 v88, 16, v63
    v_mfma_f32_16x16x32_bf16 v[4:7], a[0:3], v[60:63], v[4:7]
    v_and_b32 v89, 0xffff0000, v63
    v_mfma_f32_16x16x32_bf16 v[8:11], a[64:67], v[56:59], v[8:11]
    v_lshlrev_b32 v90, 16, v62
    v_mfma_f32_16x16x32_bf16 v[12:15], a[64:67], v[60:63], v[12:15]
    v_and_b32 v91, 0xffff0000, v62
    v_mfma_f32_16x16x32_bf16 v[16:19], a[128:131], v[56:59], v[16:19]
    v_lshlrev_b32 v92, 16, v61
    v_mfma_f32_16x16x32_bf16 v[20:23], a[128:131], v[60:63], v[20:23]
    s_mov_b32 s3, 0
    buffer_load_dword v100, v102, s[52:55], s3 offen
    v_and_b32 v93, 0xffff0000, v61
    v_mfma_f32_16x16x32_bf16 v[24:27], a[192:195], v[56:59], v[24:27]
    v_lshlrev_b32 v94, 16, v60
    v_mfma_f32_16x16x32_bf16 v[28:31], a[192:195], v[60:63], v[28:31]
    v_and_b32 v95, 0xffff0000, v60
    ds_read_b128 v[48:51], v138 offset:320
    s_waitcnt lgkmcnt(7)
    v_mfma_f32_16x16x32_bf16 v[8:11], a[60:63], v[64:67], v[8:11]
    ds_read_b128 v[52:55], v138 offset:5504
    v_mfma_f32_16x16x32_bf16 v[12:15], a[60:63], v[68:71], v[12:15]
    ds_read_b128 v[56:59], v138 offset:336
    v_mfma_f32_16x16x32_bf16 v[16:19], a[124:127], v[64:67], v[16:19]
    ds_read_b128 v[60:63], v138 offset:5520
    v_fmac_f32 v4, s17, v88
    v_mfma_f32_16x16x32_bf16 v[20:23], a[124:127], v[68:71], v[20:23]
    v_fmac_f32 v0, s17, v89
    v_fmac_f32 v5, s17, v90
    v_fmac_f32 v1, s17, v91
    v_mfma_f32_16x16x32_bf16 v[24:27], a[188:191], v[64:67], v[24:27]
    v_fmac_f32 v6, s17, v92
    v_fmac_f32 v2, s17, v93
    v_mfma_f32_16x16x32_bf16 v[28:31], a[188:191], v[68:71], v[28:31]
    v_fmac_f32 v7, s17, v94
    v_fmac_f32 v3, s17, v95
    s_waitcnt lgkmcnt(8)
    v_mfma_f32_16x16x32_bf16 v[8:11], a[56:59], v[72:75], v[8:11]
    ds_read_b128 v[64:67], v138 offset:352
    v_cvt_pk_bf16_f32 v96, v0, v4
    v_mfma_f32_16x16x32_bf16 v[12:15], a[56:59], v[76:79], v[12:15]
    ds_read_b128 v[68:71], v138 offset:5536
    v_cvt_pk_bf16_f32 v97, v1, v5
    v_mfma_f32_16x16x32_bf16 v[16:19], a[120:123], v[72:75], v[16:19]
    v_cvt_pk_bf16_f32 v98, v2, v6
    v_cvt_pk_bf16_f32 v99, v3, v7
    ds_write_b128 v112, v[96:99] offset:0
    v_mfma_f32_16x16x32_bf16 v[20:23], a[120:123], v[76:79], v[20:23]
    v_mfma_f32_16x16x32_bf16 v[24:27], a[184:187], v[72:75], v[24:27]
    v_mfma_f32_16x16x32_bf16 v[28:31], a[184:187], v[76:79], v[28:31]
    s_waitcnt lgkmcnt(9)
    v_mfma_f32_16x16x32_bf16 v[8:11], a[52:55], v[32:35], v[8:11]
    ds_read_b128 v[72:75], v138 offset:368
    v_mfma_f32_16x16x32_bf16 v[12:15], a[52:55], v[36:39], v[12:15]
    ds_read_b128 v[76:79], v138 offset:5552
    v_mfma_f32_16x16x32_bf16 v[16:19], a[116:119], v[32:35], v[16:19]
    v_mfma_f32_16x16x32_bf16 v[20:23], a[116:119], v[36:39], v[20:23]
    v_mfma_f32_16x16x32_bf16 v[24:27], a[180:183], v[32:35], v[24:27]
    s_waitcnt lgkmcnt(2)
    s_barrier
    v_mfma_f32_16x16x32_bf16 v[28:31], a[180:183], v[36:39], v[28:31]
    ds_read_b128 v[104:107], v113 offset:0
    v_mfma_f32_16x16x32_bf16 v[8:11], a[48:51], v[40:43], v[8:11]
    ds_read_b128 v[32:35], v138 offset:384
    v_mfma_f32_16x16x32_bf16 v[12:15], a[48:51], v[44:47], v[12:15]
    ds_read_b128 v[36:39], v138 offset:5568
    v_mfma_f32_16x16x32_bf16 v[16:19], a[112:115], v[40:43], v[16:19]
    v_mfma_f32_16x16x32_bf16 v[20:23], a[112:115], v[44:47], v[20:23]
    v_mfma_f32_16x16x32_bf16 v[24:27], a[176:179], v[40:43], v[24:27]
    v_mfma_f32_16x16x32_bf16 v[28:31], a[176:179], v[44:47], v[28:31]
    v_mfma_f32_16x16x32_bf16 v[8:11], a[44:47], v[48:51], v[8:11]
    ds_read_b128 v[40:43], v138 offset:400
    s_mov_b32 s16, 0
    v_mfma_f32_16x16x32_bf16 v[12:15], a[44:47], v[52:55], v[12:15]
    ds_read_b128 v[44:47], v138 offset:5584
    s_waitcnt lgkmcnt(4)
    v_mfma_f32_16x16x32_bf16 v[16:19], a[108:111], v[48:51], v[16:19]
    buffer_store_dwordx4 v[104:107], v114, s[40:43], s16 offen sc1
    v_mfma_f32_16x16x32_bf16 v[20:23], a[108:111], v[52:55], v[20:23]
    v_mfma_f32_16x16x32_bf16 v[24:27], a[172:175], v[48:51], v[24:27]
    v_mfma_f32_16x16x32_bf16 v[28:31], a[172:175], v[52:55], v[28:31]
    v_mfma_f32_16x16x32_bf16 v[8:11], a[40:43], v[56:59], v[8:11]
    ds_read_b128 v[48:51], v138 offset:416
    v_mfma_f32_16x16x32_bf16 v[12:15], a[40:43], v[60:63], v[12:15]
    ds_read_b128 v[52:55], v138 offset:5600
    v_mfma_f32_16x16x32_bf16 v[16:19], a[104:107], v[56:59], v[16:19]
    v_mfma_f32_16x16x32_bf16 v[20:23], a[104:107], v[60:63], v[20:23]
    v_mfma_f32_16x16x32_bf16 v[24:27], a[168:171], v[56:59], v[24:27]
    v_mfma_f32_16x16x32_bf16 v[28:31], a[168:171], v[60:63], v[28:31]
    v_mfma_f32_16x16x32_bf16 v[8:11], a[36:39], v[64:67], v[8:11]
    ds_read_b128 v[56:59], v138 offset:432
    v_mfma_f32_16x16x32_bf16 v[12:15], a[36:39], v[68:71], v[12:15]
    ds_read_b128 v[60:63], v138 offset:5616
    v_mfma_f32_16x16x32_bf16 v[16:19], a[100:103], v[64:67], v[16:19]
    v_mfma_f32_16x16x32_bf16 v[20:23], a[100:103], v[68:71], v[20:23]
    v_mfma_f32_16x16x32_bf16 v[24:27], a[164:167], v[64:67], v[24:27]
    v_mfma_f32_16x16x32_bf16 v[28:31], a[164:167], v[68:71], v[28:31]
    v_mfma_f32_16x16x32_bf16 v[8:11], a[32:35], v[72:75], v[8:11]
    ds_read_b128 v[64:67], v138 offset:448
    v_mfma_f32_16x16x32_bf16 v[12:15], a[32:35], v[76:79], v[12:15]
    ds_read_b128 v[68:71], v138 offset:5632
    v_mfma_f32_16x16x32_bf16 v[16:19], a[96:99], v[72:75], v[16:19]
    v_mfma_f32_16x16x32_bf16 v[20:23], a[96:99], v[76:79], v[20:23]
    v_mfma_f32_16x16x32_bf16 v[24:27], a[160:163], v[72:75], v[24:27]
    v_mfma_f32_16x16x32_bf16 v[28:31], a[160:163], v[76:79], v[28:31]
    s_waitcnt lgkmcnt(8)
    v_mfma_f32_16x16x32_bf16 v[8:11], a[28:31], v[32:35], v[8:11]
    ds_read_b128 v[72:75], v138 offset:464
    v_mfma_f32_16x16x32_bf16 v[12:15], a[28:31], v[36:39], v[12:15]
    ds_read_b128 v[76:79], v138 offset:5648
    v_mfma_f32_16x16x32_bf16 v[16:19], a[92:95], v[32:35], v[16:19]
    v_mfma_f32_16x16x32_bf16 v[20:23], a[92:95], v[36:39], v[20:23]
    v_mfma_f32_16x16x32_bf16 v[24:27], a[156:159], v[32:35], v[24:27]
    v_mfma_f32_16x16x32_bf16 v[28:31], a[156:159], v[36:39], v[28:31]
    s_mov_b32 s3, 2048
    buffer_load_dword v100, v102, s[44:47], s3 offen
    s_waitcnt lgkmcnt(8)
    v_mfma_f32_16x16x32_bf16 v[8:11], a[24:27], v[40:43], v[8:11]
    ds_read_b128 v[32:35], v138 offset:480
    v_mfma_f32_16x16x32_bf16 v[12:15], a[24:27], v[44:47], v[12:15]
    ds_read_b128 v[36:39], v138 offset:5664
    v_mfma_f32_16x16x32_bf16 v[16:19], a[88:91], v[40:43], v[16:19]
    v_mfma_f32_16x16x32_bf16 v[20:23], a[88:91], v[44:47], v[20:23]
    v_mfma_f32_16x16x32_bf16 v[24:27], a[152:155], v[40:43], v[24:27]
    v_mfma_f32_16x16x32_bf16 v[28:31], a[152:155], v[44:47], v[28:31]
    s_waitcnt lgkmcnt(8)
    v_mfma_f32_16x16x32_bf16 v[8:11], a[20:23], v[48:51], v[8:11]
    ds_read_b128 v[40:43], v138 offset:496
    v_mfma_f32_16x16x32_bf16 v[12:15], a[20:23], v[52:55], v[12:15]
    ds_read_b128 v[44:47], v138 offset:5680
    v_mfma_f32_16x16x32_bf16 v[16:19], a[84:87], v[48:51], v[16:19]
    v_mfma_f32_16x16x32_bf16 v[20:23], a[84:87], v[52:55], v[20:23]
    v_mfma_f32_16x16x32_bf16 v[24:27], a[148:151], v[48:51], v[24:27]
    v_mfma_f32_16x16x32_bf16 v[28:31], a[148:151], v[52:55], v[28:31]
    s_waitcnt lgkmcnt(8)
    v_mfma_f32_16x16x32_bf16 v[8:11], a[16:19], v[56:59], v[8:11]
    ds_read_b128 v[48:51], v138 offset:512
    v_mfma_f32_16x16x32_bf16 v[12:15], a[16:19], v[60:63], v[12:15]
    ds_read_b128 v[52:55], v138 offset:5696
    v_mfma_f32_16x16x32_bf16 v[16:19], a[80:83], v[56:59], v[16:19]
    v_mfma_f32_16x16x32_bf16 v[20:23], a[80:83], v[60:63], v[20:23]
    v_mfma_f32_16x16x32_bf16 v[24:27], a[144:147], v[56:59], v[24:27]
    v_mfma_f32_16x16x32_bf16 v[28:31], a[144:147], v[60:63], v[28:31]
    s_waitcnt lgkmcnt(8)
    v_mfma_f32_16x16x32_bf16 v[8:11], a[12:15], v[64:67], v[8:11]
    ds_read_b128 v[56:59], v138 offset:528
    v_mfma_f32_16x16x32_bf16 v[12:15], a[12:15], v[68:71], v[12:15]
    ds_read_b128 v[60:63], v138 offset:5712
    v_mfma_f32_16x16x32_bf16 v[16:19], a[76:79], v[64:67], v[16:19]
    v_mfma_f32_16x16x32_bf16 v[20:23], a[76:79], v[68:71], v[20:23]
    v_mfma_f32_16x16x32_bf16 v[24:27], a[140:143], v[64:67], v[24:27]
    v_mfma_f32_16x16x32_bf16 v[28:31], a[140:143], v[68:71], v[28:31]
    s_waitcnt lgkmcnt(8)
    v_mfma_f32_16x16x32_bf16 v[8:11], a[8:11], v[72:75], v[8:11]
    ds_read_b128 v[64:67], v138 offset:544
    v_mfma_f32_16x16x32_bf16 v[12:15], a[8:11], v[76:79], v[12:15]
    ds_read_b128 v[68:71], v138 offset:5728
    v_mfma_f32_16x16x32_bf16 v[16:19], a[72:75], v[72:75], v[16:19]
    v_mfma_f32_16x16x32_bf16 v[20:23], a[72:75], v[76:79], v[20:23]
    v_mfma_f32_16x16x32_bf16 v[24:27], a[136:139], v[72:75], v[24:27]
    v_mfma_f32_16x16x32_bf16 v[28:31], a[136:139], v[76:79], v[28:31]
    s_waitcnt lgkmcnt(8)
    v_mfma_f32_16x16x32_bf16 v[8:11], a[4:7], v[32:35], v[8:11]
    ds_read_b128 v[72:75], v138 offset:560
    v_mfma_f32_16x16x32_bf16 v[12:15], a[4:7], v[36:39], v[12:15]
    ds_read_b128 v[76:79], v138 offset:5744
    v_mfma_f32_16x16x32_bf16 v[16:19], a[68:71], v[32:35], v[16:19]
    v_mfma_f32_16x16x32_bf16 v[20:23], a[68:71], v[36:39], v[20:23]
    v_mfma_f32_16x16x32_bf16 v[24:27], a[132:135], v[32:35], v[24:27]
    v_mfma_f32_16x16x32_bf16 v[28:31], a[132:135], v[36:39], v[28:31]
    s_waitcnt lgkmcnt(8)
    v_mfma_f32_16x16x32_bf16 v[8:11], a[0:3], v[40:43], v[8:11]
    v_lshlrev_b32 v88, 16, v47
    v_and_b32 v89, 0xffff0000, v47
    v_mfma_f32_16x16x32_bf16 v[12:15], a[0:3], v[44:47], v[12:15]
    v_lshlrev_b32 v90, 16, v46
    v_and_b32 v91, 0xffff0000, v46
    v_mfma_f32_16x16x32_bf16 v[16:19], a[64:67], v[40:43], v[16:19]
    v_lshlrev_b32 v92, 16, v45
    v_mfma_f32_16x16x32_bf16 v[20:23], a[64:67], v[44:47], v[20:23]
    v_and_b32 v93, 0xffff0000, v45
    v_mfma_f32_16x16x32_bf16 v[24:27], a[128:131], v[40:43], v[24:27]
    v_lshlrev_b32 v94, 16, v44
    v_mfma_f32_16x16x32_bf16 v[28:31], a[128:131], v[44:47], v[28:31]
    v_and_b32 v95, 0xffff0000, v44
    ds_read_b128 v[32:35], v138 offset:576
    s_waitcnt lgkmcnt(7)
    v_mfma_f32_16x16x32_bf16 v[16:19], a[60:63], v[48:51], v[16:19]
    ds_read_b128 v[36:39], v138 offset:5760
    v_mfma_f32_16x16x32_bf16 v[20:23], a[60:63], v[52:55], v[20:23]
    ds_read_b128 v[40:43], v138 offset:592
    v_mfma_f32_16x16x32_bf16 v[24:27], a[124:127], v[48:51], v[24:27]
    ds_read_b128 v[44:47], v138 offset:5776
    v_fmac_f32 v12, s17, v88
    v_mfma_f32_16x16x32_bf16 v[28:31], a[124:127], v[52:55], v[28:31]
    v_fmac_f32 v8, s17, v89
    v_fmac_f32 v13, s17, v90
    v_fmac_f32 v9, s17, v91
    s_waitcnt lgkmcnt(8)
    v_mfma_f32_16x16x32_bf16 v[16:19], a[56:59], v[56:59], v[16:19]
    ds_read_b128 v[48:51], v138 offset:608
    v_fmac_f32 v14, s17, v92
    v_mfma_f32_16x16x32_bf16 v[20:23], a[56:59], v[60:63], v[20:23]
    ds_read_b128 v[52:55], v138 offset:5792
    v_fmac_f32 v10, s17, v93
    v_mfma_f32_16x16x32_bf16 v[24:27], a[120:123], v[56:59], v[24:27]
    v_fmac_f32 v15, s17, v94
    v_fmac_f32 v11, s17, v95
    v_cvt_pk_bf16_f32 v96, v8, v12
    v_mfma_f32_16x16x32_bf16 v[28:31], a[120:123], v[60:63], v[28:31]
    v_cvt_pk_bf16_f32 v97, v9, v13
    v_cvt_pk_bf16_f32 v98, v10, v14
    v_cvt_pk_bf16_f32 v99, v11, v15
    s_waitcnt lgkmcnt(8)
    v_mfma_f32_16x16x32_bf16 v[16:19], a[52:55], v[64:67], v[16:19]
    ds_read_b128 v[56:59], v138 offset:624
    ds_write_b128 v112, v[96:99] offset:4096
    v_mfma_f32_16x16x32_bf16 v[20:23], a[52:55], v[68:71], v[20:23]
    ds_read_b128 v[60:63], v138 offset:5808
    v_mfma_f32_16x16x32_bf16 v[24:27], a[116:119], v[64:67], v[24:27]
    v_mfma_f32_16x16x32_bf16 v[28:31], a[116:119], v[68:71], v[28:31]
    s_waitcnt lgkmcnt(9)
    v_mfma_f32_16x16x32_bf16 v[16:19], a[48:51], v[72:75], v[16:19]
    ds_read_b128 v[64:67], v138 offset:640
    v_mfma_f32_16x16x32_bf16 v[20:23], a[48:51], v[76:79], v[20:23]
    s_mov_b32 s3, 2048
    buffer_load_dword v100, v102, s[52:55], s3 offen
    ds_read_b128 v[68:71], v138 offset:5824
    v_mfma_f32_16x16x32_bf16 v[24:27], a[112:115], v[72:75], v[24:27]
    v_mfma_f32_16x16x32_bf16 v[28:31], a[112:115], v[76:79], v[28:31]
    s_waitcnt lgkmcnt(9)
    v_mfma_f32_16x16x32_bf16 v[16:19], a[44:47], v[32:35], v[16:19]
    ds_read_b128 v[72:75], v138 offset:656
    s_waitcnt lgkmcnt(4)
    v_mfma_f32_16x16x32_bf16 v[20:23], a[44:47], v[36:39], v[20:23]
    ds_read_b128 v[76:79], v138 offset:5840
    s_barrier
    v_mfma_f32_16x16x32_bf16 v[24:27], a[108:111], v[32:35], v[24:27]
    ds_read_b128 v[108:111], v113 offset:4096
    v_mfma_f32_16x16x32_bf16 v[28:31], a[108:111], v[36:39], v[28:31]
    v_mfma_f32_16x16x32_bf16 v[16:19], a[40:43], v[40:43], v[16:19]
    ds_read_b128 v[32:35], v138 offset:672
    v_mfma_f32_16x16x32_bf16 v[20:23], a[40:43], v[44:47], v[20:23]
    ds_read_b128 v[36:39], v138 offset:5856
    v_mfma_f32_16x16x32_bf16 v[24:27], a[104:107], v[40:43], v[24:27]
    v_mfma_f32_16x16x32_bf16 v[28:31], a[104:107], v[44:47], v[28:31]
    v_mfma_f32_16x16x32_bf16 v[16:19], a[36:39], v[48:51], v[16:19]
    ds_read_b128 v[40:43], v138 offset:688
    s_mov_b32 s16, 32768
    v_mfma_f32_16x16x32_bf16 v[20:23], a[36:39], v[52:55], v[20:23]
    ds_read_b128 v[44:47], v138 offset:5872
    s_waitcnt lgkmcnt(4)
    v_mfma_f32_16x16x32_bf16 v[24:27], a[100:103], v[48:51], v[24:27]
    buffer_store_dwordx4 v[108:111], v114, s[40:43], s16 offen sc1
    v_mfma_f32_16x16x32_bf16 v[28:31], a[100:103], v[52:55], v[28:31]
    v_mfma_f32_16x16x32_bf16 v[16:19], a[32:35], v[56:59], v[16:19]
    ds_read_b128 v[48:51], v138 offset:704
    v_mfma_f32_16x16x32_bf16 v[20:23], a[32:35], v[60:63], v[20:23]
    ds_read_b128 v[52:55], v138 offset:5888
    v_mfma_f32_16x16x32_bf16 v[24:27], a[96:99], v[56:59], v[24:27]
    v_mfma_f32_16x16x32_bf16 v[28:31], a[96:99], v[60:63], v[28:31]
    v_mfma_f32_16x16x32_bf16 v[16:19], a[28:31], v[64:67], v[16:19]
    ds_read_b128 v[56:59], v138 offset:720
    v_mfma_f32_16x16x32_bf16 v[20:23], a[28:31], v[68:71], v[20:23]
    ds_read_b128 v[60:63], v138 offset:5904
    v_mfma_f32_16x16x32_bf16 v[24:27], a[92:95], v[64:67], v[24:27]
    v_mfma_f32_16x16x32_bf16 v[28:31], a[92:95], v[68:71], v[28:31]
    v_mfma_f32_16x16x32_bf16 v[16:19], a[24:27], v[72:75], v[16:19]
    ds_read_b128 v[64:67], v138 offset:736
    v_mfma_f32_16x16x32_bf16 v[20:23], a[24:27], v[76:79], v[20:23]
    ds_read_b128 v[68:71], v138 offset:5920
    v_mfma_f32_16x16x32_bf16 v[24:27], a[88:91], v[72:75], v[24:27]
    v_mfma_f32_16x16x32_bf16 v[28:31], a[88:91], v[76:79], v[28:31]
    s_waitcnt lgkmcnt(8)
    v_mfma_f32_16x16x32_bf16 v[16:19], a[20:23], v[32:35], v[16:19]
    ds_read_b128 v[72:75], v138 offset:752
    v_mfma_f32_16x16x32_bf16 v[20:23], a[20:23], v[36:39], v[20:23]
    ds_read_b128 v[76:79], v138 offset:5936
    v_mfma_f32_16x16x32_bf16 v[24:27], a[84:87], v[32:35], v[24:27]
    v_mfma_f32_16x16x32_bf16 v[28:31], a[84:87], v[36:39], v[28:31]
    s_waitcnt lgkmcnt(8)
    v_mfma_f32_16x16x32_bf16 v[16:19], a[16:19], v[40:43], v[16:19]
    ds_read_b128 v[32:35], v138 offset:768
    v_mfma_f32_16x16x32_bf16 v[20:23], a[16:19], v[44:47], v[20:23]
    ds_read_b128 v[36:39], v138 offset:5952
    v_mfma_f32_16x16x32_bf16 v[24:27], a[80:83], v[40:43], v[24:27]
    v_mfma_f32_16x16x32_bf16 v[28:31], a[80:83], v[44:47], v[28:31]
    s_waitcnt lgkmcnt(8)
    v_mfma_f32_16x16x32_bf16 v[16:19], a[12:15], v[48:51], v[16:19]
    ds_read_b128 v[40:43], v138 offset:784
    v_mfma_f32_16x16x32_bf16 v[20:23], a[12:15], v[52:55], v[20:23]
    ds_read_b128 v[44:47], v138 offset:5968
    v_mfma_f32_16x16x32_bf16 v[24:27], a[76:79], v[48:51], v[24:27]
    v_mfma_f32_16x16x32_bf16 v[28:31], a[76:79], v[52:55], v[28:31]
    s_waitcnt lgkmcnt(8)
    v_mfma_f32_16x16x32_bf16 v[16:19], a[8:11], v[56:59], v[16:19]
    ds_read_b128 v[48:51], v138 offset:800
    v_mfma_f32_16x16x32_bf16 v[20:23], a[8:11], v[60:63], v[20:23]
    ds_read_b128 v[52:55], v138 offset:5984
    v_mfma_f32_16x16x32_bf16 v[24:27], a[72:75], v[56:59], v[24:27]
    v_mfma_f32_16x16x32_bf16 v[28:31], a[72:75], v[60:63], v[28:31]
    s_waitcnt lgkmcnt(8)
    v_mfma_f32_16x16x32_bf16 v[16:19], a[4:7], v[64:67], v[16:19]
    ds_read_b128 v[56:59], v138 offset:816
    v_mfma_f32_16x16x32_bf16 v[20:23], a[4:7], v[68:71], v[20:23]
    ds_read_b128 v[60:63], v138 offset:6000
    v_mfma_f32_16x16x32_bf16 v[24:27], a[68:71], v[64:67], v[24:27]
    v_mfma_f32_16x16x32_bf16 v[28:31], a[68:71], v[68:71], v[28:31]
    s_waitcnt lgkmcnt(8)
    v_mfma_f32_16x16x32_bf16 v[16:19], a[0:3], v[72:75], v[16:19]
    v_lshlrev_b32 v88, 16, v79
    v_and_b32 v89, 0xffff0000, v79
    v_mfma_f32_16x16x32_bf16 v[20:23], a[0:3], v[76:79], v[20:23]
    v_lshlrev_b32 v90, 16, v78
    v_and_b32 v91, 0xffff0000, v78
    v_mfma_f32_16x16x32_bf16 v[24:27], a[64:67], v[72:75], v[24:27]
    v_lshlrev_b32 v92, 16, v77
    v_and_b32 v93, 0xffff0000, v77
    v_mfma_f32_16x16x32_bf16 v[28:31], a[64:67], v[76:79], v[28:31]
    v_lshlrev_b32 v94, 16, v76
    v_and_b32 v95, 0xffff0000, v76
    s_waitcnt lgkmcnt(6)
    v_mfma_f32_16x16x32_bf16 v[24:27], a[60:63], v[32:35], v[24:27]
    ds_read_b128 v[64:67], v138 offset:832
    v_mfma_f32_16x16x32_bf16 v[28:31], a[60:63], v[36:39], v[28:31]
    ds_read_b128 v[68:71], v138 offset:6016
    s_waitcnt lgkmcnt(6)
    v_mfma_f32_16x16x32_bf16 v[24:27], a[56:59], v[40:43], v[24:27]
    ds_read_b128 v[72:75], v138 offset:848
    v_fmac_f32 v20, s17, v88
    v_mfma_f32_16x16x32_bf16 v[28:31], a[56:59], v[44:47], v[28:31]
    ds_read_b128 v[76:79], v138 offset:6032
    v_fmac_f32 v16, s17, v89
    s_waitcnt lgkmcnt(6)
    v_mfma_f32_16x16x32_bf16 v[24:27], a[52:55], v[48:51], v[24:27]
    ds_read_b128 v[32:35], v138 offset:864
    v_fmac_f32 v21, s17, v90
    v_mfma_f32_16x16x32_bf16 v[28:31], a[52:55], v[52:55], v[28:31]
    ds_read_b128 v[36:39], v138 offset:6048
    v_fmac_f32 v17, s17, v91
    s_waitcnt lgkmcnt(6)
    v_mfma_f32_16x16x32_bf16 v[24:27], a[48:51], v[56:59], v[24:27]
    ds_read_b128 v[40:43], v138 offset:880
    v_fmac_f32 v22, s17, v92
    v_mfma_f32_16x16x32_bf16 v[28:31], a[48:51], v[60:63], v[28:31]
    ds_read_b128 v[44:47], v138 offset:6064
    v_fmac_f32 v18, s17, v93
    s_waitcnt lgkmcnt(6)
    v_mfma_f32_16x16x32_bf16 v[24:27], a[44:47], v[64:67], v[24:27]
    ds_read_b128 v[48:51], v138 offset:896
    v_fmac_f32 v23, s17, v94
    v_mfma_f32_16x16x32_bf16 v[28:31], a[44:47], v[68:71], v[28:31]
    ds_read_b128 v[52:55], v138 offset:6080
    v_fmac_f32 v19, s17, v95
    s_waitcnt lgkmcnt(6)
    v_mfma_f32_16x16x32_bf16 v[24:27], a[40:43], v[72:75], v[24:27]
    ds_read_b128 v[56:59], v138 offset:912
    v_cvt_pk_bf16_f32 v96, v16, v20
    v_mfma_f32_16x16x32_bf16 v[28:31], a[40:43], v[76:79], v[28:31]
    ds_read_b128 v[60:63], v138 offset:6096
    v_cvt_pk_bf16_f32 v97, v17, v21
    s_waitcnt lgkmcnt(6)
    v_mfma_f32_16x16x32_bf16 v[24:27], a[36:39], v[32:35], v[24:27]
    ds_read_b128 v[64:67], v138 offset:928
    v_cvt_pk_bf16_f32 v98, v18, v22
    v_mfma_f32_16x16x32_bf16 v[28:31], a[36:39], v[36:39], v[28:31]
    ds_read_b128 v[68:71], v138 offset:6112
    v_cvt_pk_bf16_f32 v99, v19, v23
    s_waitcnt lgkmcnt(6)
    v_mfma_f32_16x16x32_bf16 v[24:27], a[32:35], v[40:43], v[24:27]
    ds_read_b128 v[72:75], v138 offset:944
    ds_write_b128 v112, v[96:99] offset:8192
    v_mfma_f32_16x16x32_bf16 v[28:31], a[32:35], v[44:47], v[28:31]
    ds_read_b128 v[76:79], v138 offset:6128
    s_waitcnt lgkmcnt(7)
    v_mfma_f32_16x16x32_bf16 v[24:27], a[28:31], v[48:51], v[24:27]
    ds_read_b128 v[32:35], v138 offset:960
    s_waitcnt lgkmcnt(2)
    v_mfma_f32_16x16x32_bf16 v[28:31], a[28:31], v[52:55], v[28:31]
    ds_read_b128 v[36:39], v138 offset:6144
    s_barrier
    v_mfma_f32_16x16x32_bf16 v[24:27], a[24:27], v[56:59], v[24:27]
    ds_read_b128 v[40:43], v138 offset:976
    ds_read_b128 v[104:107], v113 offset:8192
    v_mfma_f32_16x16x32_bf16 v[28:31], a[24:27], v[60:63], v[28:31]
    ds_read_b128 v[44:47], v138 offset:6160
    v_mfma_f32_16x16x32_bf16 v[24:27], a[20:23], v[64:67], v[24:27]
    ds_read_b128 v[48:51], v138 offset:992
    v_mfma_f32_16x16x32_bf16 v[28:31], a[20:23], v[68:71], v[28:31]
    ds_read_b128 v[52:55], v138 offset:6176
    s_waitcnt lgkmcnt(7)
    v_mfma_f32_16x16x32_bf16 v[24:27], a[16:19], v[72:75], v[24:27]
    ds_read_b128 v[56:59], v138 offset:1008
    v_mfma_f32_16x16x32_bf16 v[28:31], a[16:19], v[76:79], v[28:31]
    ds_read_b128 v[60:63], v138 offset:6192
    s_waitcnt lgkmcnt(7)
    v_mfma_f32_16x16x32_bf16 v[24:27], a[12:15], v[32:35], v[24:27]
    s_mov_b32 s16, 65536
    s_waitcnt lgkmcnt(5)
    buffer_store_dwordx4 v[104:107], v114, s[40:43], s16 offen sc1
    v_mfma_f32_16x16x32_bf16 v[28:31], a[12:15], v[36:39], v[28:31]
    s_waitcnt lgkmcnt(4)
    v_mfma_f32_16x16x32_bf16 v[24:27], a[8:11], v[40:43], v[24:27]
    v_mfma_f32_16x16x32_bf16 v[28:31], a[8:11], v[44:47], v[28:31]
    s_waitcnt lgkmcnt(2)
    v_mfma_f32_16x16x32_bf16 v[24:27], a[4:7], v[48:51], v[24:27]
    v_mfma_f32_16x16x32_bf16 v[28:31], a[4:7], v[52:55], v[28:31]
    s_waitcnt lgkmcnt(0)
    v_mfma_f32_16x16x32_bf16 v[24:27], a[0:3], v[56:59], v[24:27]
    v_lshlrev_b32 v88, 16, v63
    v_and_b32 v89, 0xffff0000, v63
    v_lshlrev_b32 v90, 16, v62
    v_and_b32 v91, 0xffff0000, v62
    v_mfma_f32_16x16x32_bf16 v[28:31], a[0:3], v[60:63], v[28:31]
    v_lshlrev_b32 v92, 16, v61
    v_and_b32 v93, 0xffff0000, v61
    v_lshlrev_b32 v94, 16, v60
    v_and_b32 v95, 0xffff0000, v60
    s_nop 7
    v_fmac_f32 v28, s17, v88
    v_fmac_f32 v24, s17, v89
    v_fmac_f32 v29, s17, v90
    v_fmac_f32 v25, s17, v91
    v_fmac_f32 v30, s17, v92
    v_fmac_f32 v26, s17, v93
    s_branch L_fused_kernel_pc2
L_fused_kernel_isl0_2:
    s_branch L_fused_kernel_isl0_6
L_fused_kernel_pc2:
    v_fmac_f32 v31, s17, v94
    v_fmac_f32 v27, s17, v95
    v_cvt_pk_bf16_f32 v96, v24, v28
    v_cvt_pk_bf16_f32 v97, v25, v29
    v_cvt_pk_bf16_f32 v98, v26, v30
    v_cvt_pk_bf16_f32 v99, v27, v31
    ds_write_b128 v112, v[96:99] offset:12288
    s_waitcnt lgkmcnt(0)
    s_barrier
    ds_read_b128 v[104:107], v113 offset:12288
    s_mov_b32 s16, 98304
    s_waitcnt lgkmcnt(0)
    buffer_store_dwordx4 v[104:107], v114, s[40:43], s16 offen sc1
    s_lshl_b32 s3, s2, 7
    s_add_u32 s3, s3, 65536
    s_waitcnt vmcnt(0)
    s_barrier
    s_add_u32 s62, s30, 2
    s_addc_u32 s63, s31, 0
    s_cmp_lg_u32 s32, 0
    s_cbranch_scc1 L_fused_kernel_pub_13
    v_mov_b32 v2, s62
    v_mov_b32 v3, s63
    v_mov_b32 v4, 0x7ff00000
    v_writelane_b32 v4, 0, 0
    buffer_store_dwordx2 v[2:3], v4, s[36:39], s3 offen sc1
L_fused_kernel_pub_13:
    v_mbcnt_lo_u32_b32 v240, -1, 0
    v_mbcnt_hi_u32_b32 v240, -1, v240
    s_and_b32 s3, s33, 1
    s_lshl_b32 s3, s3, 2
    s_and_b32 s16, s34, 3
    s_add_u32 s4, s3, s16
    s_lshr_b32 s3, s33, 1
    s_lshl_b32 s3, s3, 3
    s_lshr_b32 s16, s34, 2
    s_add_u32 s5, s3, s16
    s_and_b32 s3, s32, 1
    s_lshl_b32 s3, s3, 4
    s_movk_i32 s16, 4682
    s_movk_i32 s10, 7168
    v_add_u32 v241, 0, v240
    v_mul_u32_u24 v242, s16, v241
    v_lshrrev_b32 v242, 16, v242
    v_mul_u32_u24 v243, 14, v242
    v_sub_u32 v243, v241, v243
    v_add_u32 v242, s3, v242
    v_lshrrev_b32 v244, 4, v242
    v_lshlrev_b32 v244, 4, v244
    v_bfe_u32 v241, v242, 2, 1
    v_lshl_add_u32 v244, v241, 3, v244
    v_bfe_u32 v241, v242, 3, 1
    v_lshl_add_u32 v244, v241, 2, v244
    v_and_b32 v241, 3, v242
    v_add_u32 v244, v244, v241
    v_mul_lo_u32 v244, v244, s10
    v_lshl_add_u32 v244, v243, 4, v244
    v_subrev_u32 v224, 0, v244
    v_add_u32 v241, 64, v240
    v_mul_u32_u24 v242, s16, v241
    v_lshrrev_b32 v242, 16, v242
    v_mul_u32_u24 v243, 14, v242
    v_sub_u32 v243, v241, v243
    v_add_u32 v242, s3, v242
    v_lshrrev_b32 v244, 4, v242
    v_lshlrev_b32 v244, 4, v244
    v_bfe_u32 v241, v242, 2, 1
    v_lshl_add_u32 v244, v241, 3, v244
    v_bfe_u32 v241, v242, 3, 1
    v_lshl_add_u32 v244, v241, 2, v244
    v_and_b32 v241, 3, v242
    v_add_u32 v244, v244, v241
    v_mul_lo_u32 v244, v244, s10
    v_lshl_add_u32 v244, v243, 4, v244
    v_subrev_u32 v225, 1024, v244
    v_add_u32 v241, 128, v240
    v_mul_u32_u24 v242, s16, v241
    v_lshrrev_b32 v242, 16, v242
    v_mul_u32_u24 v243, 14, v242
    v_sub_u32 v243, v241, v243
    v_add_u32 v242, s3, v242
    v_lshrrev_b32 v244, 4, v242
    v_lshlrev_b32 v244, 4, v244
    v_bfe_u32 v241, v242, 2, 1
    v_lshl_add_u32 v244, v241, 3, v244
    v_bfe_u32 v241, v242, 3, 1
    v_lshl_add_u32 v244, v241, 2, v244
    v_and_b32 v241, 3, v242
    v_add_u32 v244, v244, v241
    v_mul_lo_u32 v244, v244, s10
    v_lshl_add_u32 v244, v243, 4, v244
    v_subrev_u32 v226, 2048, v244
    v_add_u32 v241, 192, v240
    v_mul_u32_u24 v242, s16, v241
    v_lshrrev_b32 v242, 16, v242
    v_mul_u32_u24 v243, 14, v242
    v_sub_u32 v243, v241, v243
    v_add_u32 v242, s3, v242
    v_lshrrev_b32 v244, 4, v242
    v_lshlrev_b32 v244, 4, v244
    v_bfe_u32 v241, v242, 2, 1
    v_lshl_add_u32 v244, v241, 3, v244
    v_bfe_u32 v241, v242, 3, 1
    v_lshl_add_u32 v244, v241, 2, v244
    v_and_b32 v241, 3, v242
    v_add_u32 v244, v244, v241
    v_mul_lo_u32 v244, v244, s10
    v_lshl_add_u32 v244, v243, 4, v244
    v_subrev_u32 v227, 3072, v244
    v_cmp_gt_u32 vcc, 32, v240
    v_mov_b32 v241, 0x7ff00000
    s_nop 0
    v_cndmask_b32 v227, v241, v227, vcc
    s_lshl_b32 s3, s4, 4
    s_lshl_b32 s16, s32, 2
    s_add_u32 s3, s3, s16
    s_lshl_b32 s3, s3, 10
    v_lshlrev_b32 v228, 4, v240
    v_add_u32 v228, s3, v228
    v_bfe_u32 v242, v240, 4, 1
    v_lshlrev_b32 v241, 2, v242
    v_bfe_u32 v242, v240, 2, 2
    v_add_u32 v241, v241, v242
    v_mul_u32_u24 v241, 224, v241
    v_lshrrev_b32 v242, 5, v240
    v_lshl_add_u32 v241, v242, 12, v241
    v_and_b32 v242, 3, v240
    v_lshl_add_u32 v229, v242, 3, v241
    v_add_u32 v230, 0x10000, v229
    s_lshl_b32 s3, s2, 2
    s_add_u32 s3, s3, s32
    s_mul_i32 s16, s3, 7168
    v_lshlrev_b32 v231, 7, v240
    v_add_u32 v231, s16, v231
    v_cmp_gt_u32 vcc, 16, v240
    v_mov_b32 v241, 0x7ff00000
    s_lshl_b32 s16, s3, 12
    v_cndmask_b32 v231, v241, v231, vcc
    v_lshlrev_b32 v233, 4, v240
    v_add_u32 v233, s16, v233
    v_mov_b32 v236, -1
    v_mov_b32 v237, -1
    v_mov_b32 v238, -1
    v_mov_b32 v239, -1
    s_lshl_b32 s16, s2, 1
    s_and_b32 s3, s32, 1
    s_add_u32 s16, s16, s3
    s_lshr_b32 s3, s16, 3
    s_mul_i32 s3, s3, 7168
    s_and_b32 s16, s16, 7
    s_mul_i32 s16, s16, 896
    s_add_u32 s16, s16, s3
    v_lshlrev_b32 v232, 7, v240
    v_add_u32 v232, s16, v232
    v_cmp_gt_u32 vcc, 7, v240
    s_nop 1
    v_cndmask_b32 v232, v241, v232, vcc
    s_cmp_lt_u32 s32, 2
    s_cselect_b32 s52, s18, s20
    s_cselect_b32 s53, s19, s21
    s_mov_b32 s54, 7340032
    s_mov_b32 s55, 0x20000
    s_lshl_b32 s6, s32, 12
    s_mul_i32 s7, s5, 224
    s_lshr_b32 s3, s5, 1
    s_mul_i32 s3, s3, 7
    s_and_b32 s16, s5, 1
    s_mul_i32 s10, s16, 3
    s_add_u32 s10, s10, s3
    s_lshl_b32 s10, s10, 17
    s_add_u32 s11, s10, 131072
    s_add_u32 s12, s10, 262144
    s_add_u32 s13, s3, 6
    s_lshl_b32 s13, s13, 17
    s_lshl_b32 s16, s16, 3
    s_add_u32 s13, s13, s16
    s_lshl_b32 s3, s32, 3
    s_lshr_b32 s16, s33, 1
    s_lshl_b32 s16, s16, 2
    s_lshr_b32 s16, 8193, s16
    s_and_b32 s16, s16, 15
    s_lshr_b32 s61, s34, 2
    s_xor_b32 s16, s16, s61
    s_lshl_b32 s16, s16, 8
    v_lshrrev_b32 v241, 4, v240
    v_add_u32 v241, 0, v241
    v_add_u32 v241, s3, v241
    v_and_b32 v242, 7, v241
    v_lshlrev_b32 v242, 1, v242
    v_and_b32 v243, 15, v240
    v_xor_b32 v243, v243, v242
    v_mul_u32_u24 v241, 2048, v241
    v_lshl_add_u32 v241, v243, 4, v241
    v_add_u32 v234, s16, v241
    v_lshrrev_b32 v241, 4, v240
    v_add_u32 v241, 4, v241
    v_add_u32 v241, s3, v241
    v_and_b32 v242, 7, v241
    v_lshlrev_b32 v242, 1, v242
    v_and_b32 v243, 15, v240
    v_xor_b32 v243, v243, v242
    v_mul_u32_u24 v241, 2048, v241
    v_lshl_add_u32 v241, v243, 4, v241
    v_add_u32 v235, s16, v241
    v_subrev_u32 v235, 1024, v235
    s_and_b32 s3, s33, 1
    s_cmp_eq_u32 s3, 0
    s_mov_b32 s16, 1966147138
    s_cselect_b32 s21, s16, 1680298768
    s_and_b32 s16, s21, 15
    s_lshl_b32 s3, s3, 3
    s_add_u32 s3, s3, s16
    s_mul_i32 s15, s3, 458752
    s_cmp_ge_u32 s32, 2
    s_mov_b32 s16, 393216
    s_cselect_b32 s17, s16, 196608
    s_lshl_b32 s14, s32, 11
    s_add_u32 m0, s6, 0
    s_add_u32 s8, s7, 0
    buffer_load_dwordx4 v224, s[52:55], s8 offen offset:0  lds
    buffer_load_dwordx4 v225, s[52:55], s8 offen offset:1024  lds
    buffer_load_dwordx4 v226, s[52:55], s8 offen offset:2048  lds
    buffer_load_dwordx4 v227, s[52:55], s8 offen offset:3072  lds
    s_add_u32 m0, s6, 16384
    s_add_u32 s8, s7, 229376
    buffer_load_dwordx4 v224, s[52:55], s8 offen offset:0  lds
    buffer_load_dwordx4 v225, s[52:55], s8 offen offset:1024  lds
    buffer_load_dwordx4 v226, s[52:55], s8 offen offset:2048  lds
    buffer_load_dwordx4 v227, s[52:55], s8 offen offset:3072  lds
    s_add_u32 m0, s6, 32768
    s_add_u32 s8, s7, 458752
    buffer_load_dwordx4 v224, s[52:55], s8 offen offset:0  lds
    buffer_load_dwordx4 v225, s[52:55], s8 offen offset:1024  lds
    buffer_load_dwordx4 v226, s[52:55], s8 offen offset:2048  lds
    buffer_load_dwordx4 v227, s[52:55], s8 offen offset:3072  lds
    s_add_u32 m0, s6, 49152
    s_add_u32 s8, s7, 688128
    buffer_load_dwordx4 v224, s[52:55], s8 offen offset:0  lds
    buffer_load_dwordx4 v225, s[52:55], s8 offen offset:1024  lds
    buffer_load_dwordx4 v226, s[52:55], s8 offen offset:2048  lds
    buffer_load_dwordx4 v227, s[52:55], s8 offen offset:3072  lds
    v_lshlrev_b32 v160, 16, v144
    v_and_b32 v161, 0xffff0000, v144
    v_lshlrev_b32 v162, 16, v145
    v_and_b32 v163, 0xffff0000, v145
    v_lshlrev_b32 v164, 16, v146
    v_and_b32 v165, 0xffff0000, v146
    v_lshlrev_b32 v166, 16, v147
    v_and_b32 v167, 0xffff0000, v147
    v_lshlrev_b32 v168, 16, v148
    v_and_b32 v169, 0xffff0000, v148
    v_lshlrev_b32 v170, 16, v149
    v_and_b32 v171, 0xffff0000, v149
    v_lshlrev_b32 v172, 16, v150
    v_and_b32 v173, 0xffff0000, v150
    v_lshlrev_b32 v174, 16, v151
    v_and_b32 v175, 0xffff0000, v151
    v_lshlrev_b32 v176, 16, v152
    v_and_b32 v177, 0xffff0000, v152
    v_lshlrev_b32 v178, 16, v153
    v_and_b32 v179, 0xffff0000, v153
    v_lshlrev_b32 v180, 16, v154
    v_and_b32 v181, 0xffff0000, v154
    v_lshlrev_b32 v182, 16, v155
    v_and_b32 v183, 0xffff0000, v155
    v_lshlrev_b32 v184, 16, v156
    v_and_b32 v185, 0xffff0000, v156
    v_lshlrev_b32 v186, 16, v157
    v_and_b32 v187, 0xffff0000, v157
    v_lshlrev_b32 v188, 16, v158
    v_and_b32 v189, 0xffff0000, v158
    v_lshlrev_b32 v190, 16, v159
    v_and_b32 v191, 0xffff0000, v159
    v_mbcnt_lo_u32_b32 v14, -1, 0
    v_mbcnt_hi_u32_b32 v14, -1, v14
    v_and_b32 v14, 7, v14
    v_lshlrev_b32 v14, 3, v14
    v_add_u32 v13, 147456, v14
    s_lshl_b32 s3, s32, 6
    v_add_u32 v12, s3, v13
    v_pk_add_f32 v[0:1], v[160:161], v[162:163]
    v_pk_mul_f32 v[2:3], v[160:161], v[160:161]
    v_pk_add_f32 v[4:5], v[164:165], v[166:167]
    v_pk_mul_f32 v[6:7], v[162:163], v[162:163]
    v_pk_fma_f32 v[2:3], v[164:165], v[164:165], v[2:3]
    v_pk_fma_f32 v[6:7], v[166:167], v[166:167], v[6:7]
    v_pk_fma_f32 v[2:3], v[168:169], v[168:169], v[2:3]
    v_pk_add_f32 v[0:1], v[0:1], v[168:169]
    v_pk_fma_f32 v[6:7], v[170:171], v[170:171], v[6:7]
    v_pk_add_f32 v[4:5], v[4:5], v[170:171]
    v_pk_fma_f32 v[2:3], v[172:173], v[172:173], v[2:3]
    v_pk_add_f32 v[0:1], v[0:1], v[172:173]
    v_pk_fma_f32 v[6:7], v[174:175], v[174:175], v[6:7]
    v_pk_add_f32 v[4:5], v[4:5], v[174:175]
    v_pk_fma_f32 v[2:3], v[176:177], v[176:177], v[2:3]
    v_pk_add_f32 v[0:1], v[0:1], v[176:177]
    v_pk_fma_f32 v[6:7], v[178:179], v[178:179], v[6:7]
    v_pk_add_f32 v[4:5], v[4:5], v[178:179]
    v_pk_fma_f32 v[2:3], v[180:181], v[180:181], v[2:3]
    v_pk_add_f32 v[0:1], v[0:1], v[180:181]
    v_pk_fma_f32 v[6:7], v[182:183], v[182:183], v[6:7]
    v_pk_add_f32 v[4:5], v[4:5], v[182:183]
    v_pk_fma_f32 v[2:3], v[184:185], v[184:185], v[2:3]
    v_pk_add_f32 v[0:1], v[0:1], v[184:185]
    v_pk_fma_f32 v[6:7], v[186:187], v[186:187], v[6:7]
    v_pk_add_f32 v[4:5], v[4:5], v[186:187]
    v_pk_fma_f32 v[2:3], v[188:189], v[188:189], v[2:3]
    v_pk_add_f32 v[0:1], v[0:1], v[188:189]
    v_pk_fma_f32 v[6:7], v[190:191], v[190:191], v[6:7]
    v_pk_add_f32 v[4:5], v[4:5], v[190:191]
    v_pk_add_f32 v[0:1], v[0:1], v[4:5]
    v_pk_add_f32 v[2:3], v[2:3], v[6:7]
    v_add_f32 v0, v0, v1
    v_add_f32 v1, v2, v3
    s_nop 1
    v_add_f32_dpp v0, v0, v0 row_ror:8 row_mask:0xf bank_mask:0xf
    v_add_f32_dpp v1, v1, v1 row_ror:8 row_mask:0xf bank_mask:0xf
    v_mov_b32 v2, v0
    v_mov_b32 v3, v1
    s_nop 1
    v_permlane16_swap_b32 v2, v0
    v_permlane16_swap_b32 v3, v1
    s_nop 1
    v_add_f32 v0, v0, v2
    v_add_f32 v1, v1, v3
    v_mov_b32 v2, v0
    v_mov_b32 v3, v1
    s_nop 1
    v_permlane32_swap_b32 v2, v0
    v_permlane32_swap_b32 v3, v1
    s_nop 1
    v_add_f32 v0, v0, v2
    v_add_f32 v1, v1, v3
    ds_write_b64 v12, v[0:1] offset:0
    s_waitcnt lgkmcnt(0)
    s_barrier
    ds_read_b64 v[0:1], v13 offset:0
    ds_read_b64 v[2:3], v13 offset:64
    ds_read_b64 v[4:5], v13 offset:128
    ds_read_b64 v[6:7], v13 offset:192
    s_waitcnt lgkmcnt(0)
    v_pk_add_f32 v[0:1], v[0:1], v[2:3]
    v_pk_add_f32 v[4:5], v[4:5], v[6:7]
    v_pk_add_f32 v[0:1], v[0:1], v[4:5]
    v_mul_f32 v0, 0x3a800000, v0
    v_mul_f32 v1, 0x3a800000, v1
    v_fma_f32 v1, -v0, v0, v1
    v_max_f32 v1, 0, v1
    v_add_f32 v1, 0x3727c5ac, v1
    v_rsq_f32 v4, v1
    s_nop 0
    v_mov_b32 v5, v4
    v_mul_f32 v2, -v0, v4
    v_mov_b32 v3, v2
    v_pk_fma_f32 v[192:193], v[160:161], v[4:5], v[2:3]
    v_pk_fma_f32 v[194:195], v[162:163], v[4:5], v[2:3]
    v_pk_fma_f32 v[196:197], v[164:165], v[4:5], v[2:3]
    v_pk_fma_f32 v[198:199], v[166:167], v[4:5], v[2:3]
    v_pk_fma_f32 v[200:201], v[168:169], v[4:5], v[2:3]
    v_pk_fma_f32 v[202:203], v[170:171], v[4:5], v[2:3]
    v_pk_fma_f32 v[204:205], v[172:173], v[4:5], v[2:3]
    v_pk_fma_f32 v[206:207], v[174:175], v[4:5], v[2:3]
    v_pk_fma_f32 v[208:209], v[176:177], v[4:5], v[2:3]
    v_pk_fma_f32 v[210:211], v[178:179], v[4:5], v[2:3]
    v_pk_fma_f32 v[212:213], v[180:181], v[4:5], v[2:3]
    v_pk_fma_f32 v[214:215], v[182:183], v[4:5], v[2:3]
    v_pk_fma_f32 v[216:217], v[184:185], v[4:5], v[2:3]
    v_pk_fma_f32 v[218:219], v[186:187], v[4:5], v[2:3]
    v_pk_fma_f32 v[220:221], v[188:189], v[4:5], v[2:3]
    v_pk_fma_f32 v[222:223], v[190:191], v[4:5], v[2:3]
    v_mbcnt_lo_u32_b32 v0, -1, 0
    v_mbcnt_hi_u32_b32 v0, -1, v0
    v_lshlrev_b32 v0, 7, v0
    s_lshl_b32 s16, s32, 13
    s_add_u32 s16, s16, 65536
    v_add_u32 v0, s16, v0
    s_mov_b32 s35, 400000
L_fused_kernel_poll_15:
    buffer_load_dwordx2 v[2:3], v0, s[36:39], 0 offen sc1
    s_sub_u32 s35, s35, 1
    s_cbranch_scc1 L_fused_kernel_pd_16
    s_waitcnt vmcnt(0)
    v_cmp_ne_u64 vcc, s[62:63], v[2:3]
    s_nop 4
    s_and_b64 exec, exec, vcc
    s_cbranch_execnz L_fused_kernel_poll_15
L_fused_kernel_pd_16:
    s_mov_b64 exec, -1
    s_waitcnt vmcnt(0)
L_fused_kernel_wf_14:
    s_barrier
    s_and_b32 s3, s2, 31
    s_lshl_b32 s3, s3, 17
    s_lshr_b32 s16, s2, 5
    s_lshl_b32 s16, s16, 14
    s_add_u32 s3, s3, s16
    s_lshl_b32 s16, s32, 12
    s_add_u32 m0, s16, 131072
    s_and_b32 s60, s2, 7
    s_lshl_b32 s60, s60, 7
    s_add_u32 s16, s16, s60
    v_add_u32 v0, s16, v136
    v_add_u32 v0, 0, v0
    v_and_b32 v0, 16383, v0
    v_add_u32 v1, s16, v136
    v_add_u32 v1, 1024, v1
    v_and_b32 v1, 16383, v1
    v_add_u32 v2, s16, v136
    v_add_u32 v2, 2048, v2
    v_and_b32 v2, 16383, v2
    v_add_u32 v3, s16, v136
    v_add_u32 v3, 3072, v3
    v_and_b32 v3, 16383, v3
    buffer_load_dwordx4 v0, s[40:43], s3 offen sc1 lds
    s_add_u32 m0, m0, 1024
    s_nop 0
    buffer_load_dwordx4 v1, s[40:43], s3 offen sc1 lds
    s_add_u32 m0, m0, 1024
    s_nop 0
    buffer_load_dwordx4 v2, s[40:43], s3 offen sc1 lds
    s_add_u32 m0, m0, 1024
    s_nop 0
    buffer_load_dwordx4 v3, s[40:43], s3 offen sc1 lds
    s_add_u32 s56, s28, 28311552
    s_addc_u32 s57, s29, 0
    s_mov_b32 s58, 4194304
    s_mov_b32 s59, 0x20000
    v_lshrrev_b32 v112, 11, v134
    v_mul_u32_u24 v112, 0, v112
    v_add_u32 v112, v112, v134
    s_add_u32 s44, s28, 23068672
    s_addc_u32 s45, s29, 0
    s_mov_b32 s46, 4194304
    s_mov_b32 s47, 0x20000
    v_mbcnt_lo_u32_b32 v110, -1, 0
    v_mbcnt_hi_u32_b32 v110, -1, v110
    v_lshrrev_b32 v96, 4, v110
    v_lshlrev_b32 v96, 8, v96
    v_bfe_u32 v97, v110, 1, 1
    v_lshl_add_u32 v96, v97, 7, v96
    v_bfe_u32 v97, v110, 2, 2
    v_lshl_add_u32 v96, v97, 4, v96
    v_and_b32 v97, 1, v110
    v_lshl_add_u32 v96, v97, 3, v96
    s_lshl_b32 s16, s32, 12
    s_add_u32 s16, s16, 131072
    v_add_u32 v111, s16, v96
    v_mbcnt_lo_u32_b32 v110, -1, 0
    v_mbcnt_hi_u32_b32 v110, -1, v110
    v_and_b32 v110, 7, v110
    v_lshlrev_b32 v110, 3, v110
    v_add_u32 v109, 147456, v110
    s_lshl_b32 s3, s32, 6
    v_add_u32 v108, s3, v109
    s_waitcnt vmcnt(0)
    ds_read_b64_tr_b16 v[0:1], v111 offset:0
    ds_read_b64_tr_b16 v[2:3], v111 offset:64
    ds_read_b64_tr_b16 v[4:5], v111 offset:1024
    ds_read_b64_tr_b16 v[6:7], v111 offset:1088
    ds_read_b64_tr_b16 v[8:9], v111 offset:2048
    ds_read_b64_tr_b16 v[10:11], v111 offset:2112
    ds_read_b64_tr_b16 v[12:13], v111 offset:3072
    ds_read_b64_tr_b16 v[14:15], v111 offset:3136
    s_waitcnt lgkmcnt(6)
    v_lshlrev_b32 v16, 16, v0
    v_and_b32 v17, 0xffff0000, v0
    v_lshlrev_b32 v18, 16, v1
    v_and_b32 v19, 0xffff0000, v1
    v_lshlrev_b32 v20, 16, v2
    v_and_b32 v21, 0xffff0000, v2
    v_lshlrev_b32 v22, 16, v3
    v_and_b32 v23, 0xffff0000, v3
    v_pk_fma_f32 v[48:49], v[192:193], v[16:17], v[160:161]
    v_pk_fma_f32 v[50:51], v[194:195], v[18:19], v[162:163]
    v_pk_fma_f32 v[52:53], v[196:197], v[20:21], v[164:165]
    v_pk_fma_f32 v[54:55], v[198:199], v[22:23], v[166:167]
    v_cvt_pk_bf16_f32 v80, v48, v49
    v_cvt_pk_bf16_f32 v81, v50, v51
    v_cvt_pk_bf16_f32 v82, v52, v53
    v_cvt_pk_bf16_f32 v83, v54, v55
    buffer_store_dwordx4 v[80:83], v112, s[56:59], 0 offen offset:0 sc1
    s_waitcnt lgkmcnt(4)
    v_lshlrev_b32 v24, 16, v4
    v_and_b32 v25, 0xffff0000, v4
    v_lshlrev_b32 v26, 16, v5
    v_and_b32 v27, 0xffff0000, v5
    v_lshlrev_b32 v28, 16, v6
    v_and_b32 v29, 0xffff0000, v6
    v_lshlrev_b32 v30, 16, v7
    v_and_b32 v31, 0xffff0000, v7
    v_pk_fma_f32 v[56:57], v[200:201], v[24:25], v[168:169]
    v_pk_fma_f32 v[58:59], v[202:203], v[26:27], v[170:171]
    v_pk_fma_f32 v[60:61], v[204:205], v[28:29], v[172:173]
    v_pk_fma_f32 v[62:63], v[206:207], v[30:31], v[174:175]
    v_cvt_pk_bf16_f32 v84, v56, v57
    v_cvt_pk_bf16_f32 v85, v58, v59
    v_cvt_pk_bf16_f32 v86, v60, v61
    v_cvt_pk_bf16_f32 v87, v62, v63
    buffer_store_dwordx4 v[84:87], v112, s[56:59], 0 offen offset:128 sc1
    s_waitcnt lgkmcnt(2)
    v_lshlrev_b32 v32, 16, v8
    v_and_b32 v33, 0xffff0000, v8
    v_lshlrev_b32 v34, 16, v9
    v_and_b32 v35, 0xffff0000, v9
    v_lshlrev_b32 v36, 16, v10
    v_and_b32 v37, 0xffff0000, v10
    v_lshlrev_b32 v38, 16, v11
    v_and_b32 v39, 0xffff0000, v11
    v_pk_fma_f32 v[64:65], v[208:209], v[32:33], v[176:177]
    v_pk_fma_f32 v[66:67], v[210:211], v[34:35], v[178:179]
    v_pk_fma_f32 v[68:69], v[212:213], v[36:37], v[180:181]
    v_pk_fma_f32 v[70:71], v[214:215], v[38:39], v[182:183]
    v_cvt_pk_bf16_f32 v88, v64, v65
    v_cvt_pk_bf16_f32 v89, v66, v67
    v_cvt_pk_bf16_f32 v90, v68, v69
    v_cvt_pk_bf16_f32 v91, v70, v71
    buffer_store_dwordx4 v[88:91], v112, s[56:59], 0 offen offset:256 sc1
    s_waitcnt lgkmcnt(0)
    v_lshlrev_b32 v40, 16, v12
    v_and_b32 v41, 0xffff0000, v12
    v_lshlrev_b32 v42, 16, v13
    v_and_b32 v43, 0xffff0000, v13
    v_lshlrev_b32 v44, 16, v14
    v_and_b32 v45, 0xffff0000, v14
    v_lshlrev_b32 v46, 16, v15
    v_and_b32 v47, 0xffff0000, v15
    v_pk_fma_f32 v[72:73], v[216:217], v[40:41], v[184:185]
    v_pk_fma_f32 v[74:75], v[218:219], v[42:43], v[186:187]
    v_pk_fma_f32 v[76:77], v[220:221], v[44:45], v[188:189]
    v_pk_fma_f32 v[78:79], v[222:223], v[46:47], v[190:191]
    v_cvt_pk_bf16_f32 v92, v72, v73
    v_cvt_pk_bf16_f32 v93, v74, v75
    v_cvt_pk_bf16_f32 v94, v76, v77
    v_cvt_pk_bf16_f32 v95, v78, v79
    buffer_store_dwordx4 v[92:95], v112, s[56:59], 0 offen offset:384 sc1
    v_lshlrev_b32 v48, 16, v80
    v_and_b32 v49, 0xffff0000, v80
    v_lshlrev_b32 v50, 16, v81
    v_and_b32 v51, 0xffff0000, v81
    v_lshlrev_b32 v52, 16, v82
    v_and_b32 v53, 0xffff0000, v82
    v_lshlrev_b32 v54, 16, v83
    v_and_b32 v55, 0xffff0000, v83
    v_lshlrev_b32 v56, 16, v84
    v_and_b32 v57, 0xffff0000, v84
    v_lshlrev_b32 v58, 16, v85
    v_and_b32 v59, 0xffff0000, v85
    v_lshlrev_b32 v60, 16, v86
    v_and_b32 v61, 0xffff0000, v86
    v_lshlrev_b32 v62, 16, v87
    v_and_b32 v63, 0xffff0000, v87
    v_lshlrev_b32 v64, 16, v88
    v_and_b32 v65, 0xffff0000, v88
    v_lshlrev_b32 v66, 16, v89
    v_and_b32 v67, 0xffff0000, v89
    v_lshlrev_b32 v68, 16, v90
    v_and_b32 v69, 0xffff0000, v90
    v_lshlrev_b32 v70, 16, v91
    v_and_b32 v71, 0xffff0000, v91
    v_lshlrev_b32 v72, 16, v92
    v_and_b32 v73, 0xffff0000, v92
    v_lshlrev_b32 v74, 16, v93
    v_and_b32 v75, 0xffff0000, v93
    v_lshlrev_b32 v76, 16, v94
    v_and_b32 v77, 0xffff0000, v94
    v_lshlrev_b32 v78, 16, v95
    v_and_b32 v79, 0xffff0000, v95
    v_pk_add_f32 v[96:97], v[48:49], v[50:51]
    v_pk_mul_f32 v[98:99], v[48:49], v[48:49]
    v_pk_add_f32 v[100:101], v[52:53], v[54:55]
    v_pk_mul_f32 v[102:103], v[50:51], v[50:51]
    v_pk_fma_f32 v[98:99], v[52:53], v[52:53], v[98:99]
    v_pk_fma_f32 v[102:103], v[54:55], v[54:55], v[102:103]
    v_pk_fma_f32 v[98:99], v[56:57], v[56:57], v[98:99]
    v_pk_add_f32 v[96:97], v[96:97], v[56:57]
    v_pk_fma_f32 v[102:103], v[58:59], v[58:59], v[102:103]
    v_pk_add_f32 v[100:101], v[100:101], v[58:59]
    v_pk_fma_f32 v[98:99], v[60:61], v[60:61], v[98:99]
    v_pk_add_f32 v[96:97], v[96:97], v[60:61]
    v_pk_fma_f32 v[102:103], v[62:63], v[62:63], v[102:103]
    v_pk_add_f32 v[100:101], v[100:101], v[62:63]
    v_pk_fma_f32 v[98:99], v[64:65], v[64:65], v[98:99]
    v_pk_add_f32 v[96:97], v[96:97], v[64:65]
    v_pk_fma_f32 v[102:103], v[66:67], v[66:67], v[102:103]
    v_pk_add_f32 v[100:101], v[100:101], v[66:67]
    v_pk_fma_f32 v[98:99], v[68:69], v[68:69], v[98:99]
    v_pk_add_f32 v[96:97], v[96:97], v[68:69]
    v_pk_fma_f32 v[102:103], v[70:71], v[70:71], v[102:103]
    v_pk_add_f32 v[100:101], v[100:101], v[70:71]
    v_pk_fma_f32 v[98:99], v[72:73], v[72:73], v[98:99]
    v_pk_add_f32 v[96:97], v[96:97], v[72:73]
    v_pk_fma_f32 v[102:103], v[74:75], v[74:75], v[102:103]
    v_pk_add_f32 v[100:101], v[100:101], v[74:75]
    v_pk_fma_f32 v[98:99], v[76:77], v[76:77], v[98:99]
    v_pk_add_f32 v[96:97], v[96:97], v[76:77]
    v_pk_fma_f32 v[102:103], v[78:79], v[78:79], v[102:103]
    v_pk_add_f32 v[100:101], v[100:101], v[78:79]
    v_pk_add_f32 v[96:97], v[96:97], v[100:101]
    v_pk_add_f32 v[98:99], v[98:99], v[102:103]
    v_add_f32 v96, v96, v97
    v_add_f32 v97, v98, v99
    s_nop 1
    v_add_f32_dpp v96, v96, v96 row_ror:8 row_mask:0xf bank_mask:0xf
    v_add_f32_dpp v97, v97, v97 row_ror:8 row_mask:0xf bank_mask:0xf
    v_mov_b32 v98, v96
    v_mov_b32 v99, v97
    s_nop 1
    v_permlane16_swap_b32 v98, v96
    v_permlane16_swap_b32 v99, v97
    s_nop 1
    v_add_f32 v96, v96, v98
    v_add_f32 v97, v97, v99
    v_mov_b32 v98, v96
    v_mov_b32 v99, v97
    s_nop 1
    v_permlane32_swap_b32 v98, v96
    v_permlane32_swap_b32 v99, v97
    s_nop 1
    v_add_f32 v96, v96, v98
    v_add_f32 v97, v97, v99
    ds_write_b64 v108, v[96:97] offset:256
    s_waitcnt lgkmcnt(0)
    s_barrier
    ds_read_b64 v[96:97], v109 offset:256
    ds_read_b64 v[98:99], v109 offset:320
    ds_read_b64 v[100:101], v109 offset:384
    ds_read_b64 v[102:103], v109 offset:448
    s_waitcnt lgkmcnt(0)
    v_pk_add_f32 v[96:97], v[96:97], v[98:99]
    v_pk_add_f32 v[100:101], v[100:101], v[102:103]
    v_pk_add_f32 v[96:97], v[96:97], v[100:101]
    v_mul_f32 v96, 0x3a800000, v96
    v_mul_f32 v97, 0x3a800000, v97
    v_fma_f32 v97, -v96, v96, v97
    v_max_f32 v97, 0, v97
    v_add_f32 v97, 0x3727c5ac, v97
    v_rsq_f32 v100, v97
    s_nop 0
    v_mov_b32 v101, v100
    v_mul_f32 v98, -v96, v100
    v_mov_b32 v99, v98
    v_pk_fma_f32 v[48:49], v[48:49], v[100:101], v[98:99]
    v_pk_fma_f32 v[50:51], v[50:51], v[100:101], v[98:99]
    v_pk_fma_f32 v[52:53], v[52:53], v[100:101], v[98:99]
    v_pk_fma_f32 v[54:55], v[54:55], v[100:101], v[98:99]
    v_cvt_pk_bf16_f32 v16, v48, v49
    v_cvt_pk_bf16_f32 v17, v50, v51
    v_cvt_pk_bf16_f32 v18, v52, v53
    v_cvt_pk_bf16_f32 v19, v54, v55
    s_mov_b32 s3, 0
    buffer_store_dwordx4 v[16:19], v135, s[44:47], s3 offen sc1
    v_pk_fma_f32 v[56:57], v[56:57], v[100:101], v[98:99]
    v_pk_fma_f32 v[58:59], v[58:59], v[100:101], v[98:99]
    v_pk_fma_f32 v[60:61], v[60:61], v[100:101], v[98:99]
    v_pk_fma_f32 v[62:63], v[62:63], v[100:101], v[98:99]
    v_cvt_pk_bf16_f32 v20, v56, v57
    v_cvt_pk_bf16_f32 v21, v58, v59
    v_cvt_pk_bf16_f32 v22, v60, v61
    v_cvt_pk_bf16_f32 v23, v62, v63
    s_mov_b32 s3, 262144
    buffer_store_dwordx4 v[20:23], v135, s[44:47], s3 offen sc1
    v_pk_fma_f32 v[64:65], v[64:65], v[100:101], v[98:99]
    v_pk_fma_f32 v[66:67], v[66:67], v[100:101], v[98:99]
    v_pk_fma_f32 v[68:69], v[68:69], v[100:101], v[98:99]
    v_pk_fma_f32 v[70:71], v[70:71], v[100:101], v[98:99]
    v_cvt_pk_bf16_f32 v24, v64, v65
    v_cvt_pk_bf16_f32 v25, v66, v67
    s_branch L_fused_kernel_pc3
L_fused_kernel_isl0_3:
    s_branch L_fused_kernel_isl0_7
L_fused_kernel_pc3:
    v_cvt_pk_bf16_f32 v26, v68, v69
    v_cvt_pk_bf16_f32 v27, v70, v71
    s_mov_b32 s3, 524288
    buffer_store_dwordx4 v[24:27], v135, s[44:47], s3 offen sc1
    v_pk_fma_f32 v[72:73], v[72:73], v[100:101], v[98:99]
    v_pk_fma_f32 v[74:75], v[74:75], v[100:101], v[98:99]
    v_pk_fma_f32 v[76:77], v[76:77], v[100:101], v[98:99]
    v_pk_fma_f32 v[78:79], v[78:79], v[100:101], v[98:99]
    v_cvt_pk_bf16_f32 v28, v72, v73
    v_cvt_pk_bf16_f32 v29, v74, v75
    v_cvt_pk_bf16_f32 v30, v76, v77
    v_cvt_pk_bf16_f32 v31, v78, v79
    s_mov_b32 s3, 786432
    buffer_store_dwordx4 v[28:31], v135, s[44:47], s3 offen sc1
    s_lshl_b32 s3, s2, 7
    s_add_u32 s3, s3, 98304
    v_mbcnt_lo_u32_b32 v0, -1, 0
    v_mbcnt_hi_u32_b32 v0, -1, v0
    v_lshlrev_b32 v0, 7, v0
    s_lshl_b32 s16, s4, 12
    s_add_u32 s16, s16, 98304
    v_add_u32 v0, s16, v0
    s_waitcnt vmcnt(0)
    s_barrier
    s_add_u32 s62, s30, 3
    s_addc_u32 s63, s31, 0
    s_cmp_lg_u32 s32, 0
    s_cbranch_scc1 L_fused_kernel_pub_18
    v_mov_b32 v2, s62
    v_mov_b32 v3, s63
    v_mov_b32 v4, 0x7ff00000
    v_writelane_b32 v4, 0, 0
    buffer_store_dwordx2 v[2:3], v4, s[36:39], s3 offen sc1
L_fused_kernel_pub_18:
    s_cmp_lg_u32 s32, 0
    s_cbranch_scc1 L_fused_kernel_wf_19
    s_mov_b32 s35, 400000
    s_mov_b64 exec, 0xffffffff
L_fused_kernel_poll_20:
    buffer_load_dwordx2 v[2:3], v0, s[36:39], 0 offen sc1
    s_sub_u32 s35, s35, 1
    s_cbranch_scc1 L_fused_kernel_pd_21
    s_waitcnt vmcnt(0)
    v_cmp_ne_u64 vcc, s[62:63], v[2:3]
    s_nop 4
    s_and_b64 exec, exec, vcc
    s_cbranch_execnz L_fused_kernel_poll_20
L_fused_kernel_pd_21:
    s_mov_b64 exec, -1
    s_waitcnt vmcnt(0)
L_fused_kernel_wf_19:
    s_barrier
    s_add_u32 s48, s28, 8388608
    s_addc_u32 s49, s29, 0
    s_mov_b32 s50, 14680064
    s_mov_b32 s51, 0x20000
    s_mov_b32 s40, s28
    s_mov_b32 s41, s29
    s_mov_b32 s42, 8388608
    s_mov_b32 s43, 0x20000
    s_mov_b32 s56, s22
    s_mov_b32 s57, s23
    s_mov_b32 s58, 7340032
    s_mov_b32 s59, 0x20000
    s_mov_b32 s9, 0
    buffer_load_dwordx4 a[32:35], v228, s[44:47], s9 offen offset:0 sc1
    buffer_load_dwordx4 a[36:39], v228, s[44:47], s9 offen offset:1024 sc1
    buffer_load_dwordx4 a[40:43], v228, s[44:47], s9 offen offset:2048 sc1
    buffer_load_dwordx4 a[44:47], v228, s[44:47], s9 offen offset:3072 sc1
    s_mov_b32 s9, 131072
    buffer_load_dwordx4 a[48:51], v228, s[44:47], s9 offen offset:0 sc1
    buffer_load_dwordx4 a[52:55], v228, s[44:47], s9 offen offset:1024 sc1
    buffer_load_dwordx4 a[56:59], v228, s[44:47], s9 offen offset:2048 sc1
    buffer_load_dwordx4 a[60:63], v228, s[44:47], s9 offen offset:3072 sc1
    ds_read_b64_tr_b16 a[0:1], v229 offset:0
    ds_read_b64_tr_b16 a[2:3], v229 offset:1792
    ds_read_b64_tr_b16 a[4:5], v229 offset:16384
    ds_read_b64_tr_b16 a[6:7], v229 offset:18176
    ds_read_b64_tr_b16 a[8:9], v229 offset:8192
    ds_read_b64_tr_b16 a[10:11], v229 offset:9984
    ds_read_b64_tr_b16 a[12:13], v229 offset:24576
    ds_read_b64_tr_b16 a[14:15], v229 offset:26368
    ds_read_b64_tr_b16 a[16:17], v229 offset:32
    ds_read_b64_tr_b16 a[18:19], v229 offset:1824
    ds_read_b64_tr_b16 a[20:21], v229 offset:16416
    ds_read_b64_tr_b16 a[22:23], v229 offset:18208
    s_waitcnt vmcnt(0) lgkmcnt(8)
    v_mfma_f32_16x16x32_bf16 v[0:3], a[0:3], a[32:35], 0
    ds_read_b64_tr_b16 a[24:25], v229 offset:8224
    s_mov_b32 s9, 262144
    v_mfma_f32_16x16x32_bf16 v[0:3], a[4:7], a[48:51], v[0:3]
    buffer_load_dwordx4 a[64:67], v228, s[44:47], s9 offen offset:0 sc1
    v_mfma_f32_16x16x32_bf16 v[56:59], a[0:3], a[36:39], 0
    ds_read_b64_tr_b16 a[26:27], v229 offset:10016
    v_mfma_f32_16x16x32_bf16 v[56:59], a[4:7], a[52:55], v[56:59]
    v_mfma_f32_16x16x32_bf16 v[112:115], a[0:3], a[40:43], 0
    ds_read_b64_tr_b16 a[28:29], v229 offset:24608
    v_mfma_f32_16x16x32_bf16 v[112:115], a[4:7], a[56:59], v[112:115]
    v_mfma_f32_16x16x32_bf16 v[168:171], a[0:3], a[44:47], 0
    ds_read_b64_tr_b16 a[30:31], v229 offset:26400
    v_mfma_f32_16x16x32_bf16 v[168:171], a[4:7], a[60:63], v[168:171]
    buffer_load_dwordx4 a[68:71], v228, s[44:47], s9 offen offset:1024 sc1
    s_waitcnt lgkmcnt(8)
    v_mfma_f32_16x16x32_bf16 v[28:31], a[8:11], a[32:35], 0
    ds_read_b64_tr_b16 a[0:1], v229 offset:64
    v_mfma_f32_16x16x32_bf16 v[28:31], a[12:15], a[48:51], v[28:31]
    v_mfma_f32_16x16x32_bf16 v[84:87], a[8:11], a[36:39], 0
    ds_read_b64_tr_b16 a[2:3], v229 offset:1856
    v_mfma_f32_16x16x32_bf16 v[84:87], a[12:15], a[52:55], v[84:87]
    v_mfma_f32_16x16x32_bf16 v[140:143], a[8:11], a[40:43], 0
    ds_read_b64_tr_b16 a[4:5], v229 offset:16448
    v_mfma_f32_16x16x32_bf16 v[140:143], a[12:15], a[56:59], v[140:143]
    buffer_load_dwordx4 a[72:75], v228, s[44:47], s9 offen offset:2048 sc1
    v_mfma_f32_16x16x32_bf16 v[196:199], a[8:11], a[44:47], 0
    ds_read_b64_tr_b16 a[6:7], v229 offset:18240
    v_mfma_f32_16x16x32_bf16 v[196:199], a[12:15], a[60:63], v[196:199]
    s_waitcnt lgkmcnt(8)
    v_mfma_f32_16x16x32_bf16 v[4:7], a[16:19], a[32:35], 0
    ds_read_b64_tr_b16 a[8:9], v229 offset:8256
    v_mfma_f32_16x16x32_bf16 v[4:7], a[20:23], a[48:51], v[4:7]
    v_mfma_f32_16x16x32_bf16 v[60:63], a[16:19], a[36:39], 0
    ds_read_b64_tr_b16 a[10:11], v229 offset:10048
    v_mfma_f32_16x16x32_bf16 v[60:63], a[20:23], a[52:55], v[60:63]
    buffer_load_dwordx4 a[76:79], v228, s[44:47], s9 offen offset:3072 sc1
    s_mov_b32 s9, 393216
    v_mfma_f32_16x16x32_bf16 v[116:119], a[16:19], a[40:43], 0
    ds_read_b64_tr_b16 a[12:13], v229 offset:24640
    v_mfma_f32_16x16x32_bf16 v[116:119], a[20:23], a[56:59], v[116:119]
    v_mfma_f32_16x16x32_bf16 v[172:175], a[16:19], a[44:47], 0
    ds_read_b64_tr_b16 a[14:15], v229 offset:26432
    v_mfma_f32_16x16x32_bf16 v[172:175], a[20:23], a[60:63], v[172:175]
    s_waitcnt lgkmcnt(8)
    v_mfma_f32_16x16x32_bf16 v[32:35], a[24:27], a[32:35], 0
    ds_read_b64_tr_b16 a[16:17], v229 offset:96
    v_mfma_f32_16x16x32_bf16 v[32:35], a[28:31], a[48:51], v[32:35]
    buffer_load_dwordx4 a[80:83], v228, s[44:47], s9 offen offset:0 sc1
    v_mfma_f32_16x16x32_bf16 v[88:91], a[24:27], a[36:39], 0
    ds_read_b64_tr_b16 a[18:19], v229 offset:1888
    v_mfma_f32_16x16x32_bf16 v[88:91], a[28:31], a[52:55], v[88:91]
    v_mfma_f32_16x16x32_bf16 v[144:147], a[24:27], a[40:43], 0
    ds_read_b64_tr_b16 a[20:21], v229 offset:16480
    v_mfma_f32_16x16x32_bf16 v[144:147], a[28:31], a[56:59], v[144:147]
    v_mfma_f32_16x16x32_bf16 v[200:203], a[24:27], a[44:47], 0
    ds_read_b64_tr_b16 a[22:23], v229 offset:18272
    v_mfma_f32_16x16x32_bf16 v[200:203], a[28:31], a[60:63], v[200:203]
    buffer_load_dwordx4 a[84:87], v228, s[44:47], s9 offen offset:1024 sc1
    s_waitcnt lgkmcnt(8)
    v_mfma_f32_16x16x32_bf16 v[8:11], a[0:3], a[32:35], 0
    ds_read_b64_tr_b16 a[24:25], v229 offset:8288
    v_mfma_f32_16x16x32_bf16 v[8:11], a[4:7], a[48:51], v[8:11]
    v_mfma_f32_16x16x32_bf16 v[64:67], a[0:3], a[36:39], 0
    ds_read_b64_tr_b16 a[26:27], v229 offset:10080
    v_mfma_f32_16x16x32_bf16 v[64:67], a[4:7], a[52:55], v[64:67]
    v_mfma_f32_16x16x32_bf16 v[120:123], a[0:3], a[40:43], 0
    ds_read_b64_tr_b16 a[28:29], v229 offset:24672
    v_mfma_f32_16x16x32_bf16 v[120:123], a[4:7], a[56:59], v[120:123]
    buffer_load_dwordx4 a[88:91], v228, s[44:47], s9 offen offset:2048 sc1
    v_mfma_f32_16x16x32_bf16 v[176:179], a[0:3], a[44:47], 0
    ds_read_b64_tr_b16 a[30:31], v229 offset:26464
    v_mfma_f32_16x16x32_bf16 v[176:179], a[4:7], a[60:63], v[176:179]
    s_waitcnt lgkmcnt(8)
    v_mfma_f32_16x16x32_bf16 v[36:39], a[8:11], a[32:35], 0
    ds_read_b64_tr_b16 a[0:1], v229 offset:128
    v_mfma_f32_16x16x32_bf16 v[36:39], a[12:15], a[48:51], v[36:39]
    v_mfma_f32_16x16x32_bf16 v[92:95], a[8:11], a[36:39], 0
    ds_read_b64_tr_b16 a[2:3], v229 offset:1920
    v_mfma_f32_16x16x32_bf16 v[92:95], a[12:15], a[52:55], v[92:95]
    buffer_load_dwordx4 a[92:95], v228, s[44:47], s9 offen offset:3072 sc1
    s_add_u32 s8, s7, 917504
    s_add_u32 m0, s6, 65536
    v_mfma_f32_16x16x32_bf16 v[148:151], a[8:11], a[40:43], 0
    ds_read_b64_tr_b16 a[4:5], v229 offset:16512
    v_mfma_f32_16x16x32_bf16 v[148:151], a[12:15], a[56:59], v[148:151]
    v_mfma_f32_16x16x32_bf16 v[204:207], a[8:11], a[44:47], 0
    ds_read_b64_tr_b16 a[6:7], v229 offset:18304
    v_mfma_f32_16x16x32_bf16 v[204:207], a[12:15], a[60:63], v[204:207]
    s_waitcnt lgkmcnt(8)
    v_mfma_f32_16x16x32_bf16 v[12:15], a[16:19], a[32:35], 0
    ds_read_b64_tr_b16 a[8:9], v229 offset:8320
    v_mfma_f32_16x16x32_bf16 v[12:15], a[20:23], a[48:51], v[12:15]
    buffer_load_dwordx4 v224, s[52:55], s8 offen offset:0  lds
    v_mfma_f32_16x16x32_bf16 v[68:71], a[16:19], a[36:39], 0
    ds_read_b64_tr_b16 a[10:11], v229 offset:10112
    v_mfma_f32_16x16x32_bf16 v[68:71], a[20:23], a[52:55], v[68:71]
    v_mfma_f32_16x16x32_bf16 v[124:127], a[16:19], a[40:43], 0
    ds_read_b64_tr_b16 a[12:13], v229 offset:24704
    v_mfma_f32_16x16x32_bf16 v[124:127], a[20:23], a[56:59], v[124:127]
    v_mfma_f32_16x16x32_bf16 v[180:183], a[16:19], a[44:47], 0
    ds_read_b64_tr_b16 a[14:15], v229 offset:26496
    v_mfma_f32_16x16x32_bf16 v[180:183], a[20:23], a[60:63], v[180:183]
    buffer_load_dwordx4 v225, s[52:55], s8 offen offset:1024  lds
    s_waitcnt lgkmcnt(8)
    v_mfma_f32_16x16x32_bf16 v[40:43], a[24:27], a[32:35], 0
    ds_read_b64_tr_b16 a[16:17], v229 offset:160
    v_mfma_f32_16x16x32_bf16 v[40:43], a[28:31], a[48:51], v[40:43]
    v_mfma_f32_16x16x32_bf16 v[96:99], a[24:27], a[36:39], 0
    ds_read_b64_tr_b16 a[18:19], v229 offset:1952
    v_mfma_f32_16x16x32_bf16 v[96:99], a[28:31], a[52:55], v[96:99]
    v_mfma_f32_16x16x32_bf16 v[152:155], a[24:27], a[40:43], 0
    ds_read_b64_tr_b16 a[20:21], v229 offset:16544
    v_mfma_f32_16x16x32_bf16 v[152:155], a[28:31], a[56:59], v[152:155]
    buffer_load_dwordx4 v226, s[52:55], s8 offen offset:2048  lds
    v_mfma_f32_16x16x32_bf16 v[208:211], a[24:27], a[44:47], 0
    ds_read_b64_tr_b16 a[22:23], v229 offset:18336
    v_mfma_f32_16x16x32_bf16 v[208:211], a[28:31], a[60:63], v[208:211]
    s_waitcnt lgkmcnt(8)
    v_mfma_f32_16x16x32_bf16 v[16:19], a[0:3], a[32:35], 0
    ds_read_b64_tr_b16 a[24:25], v229 offset:8352
    v_mfma_f32_16x16x32_bf16 v[16:19], a[4:7], a[48:51], v[16:19]
    v_mfma_f32_16x16x32_bf16 v[72:75], a[0:3], a[36:39], 0
    ds_read_b64_tr_b16 a[26:27], v229 offset:10144
    v_mfma_f32_16x16x32_bf16 v[72:75], a[4:7], a[52:55], v[72:75]
    buffer_load_dwordx4 v227, s[52:55], s8 offen offset:3072  lds
    s_add_u32 s8, s7, 1146880
    s_add_u32 m0, s6, 81920
    v_mfma_f32_16x16x32_bf16 v[128:131], a[0:3], a[40:43], 0
    ds_read_b64_tr_b16 a[28:29], v229 offset:24736
    v_mfma_f32_16x16x32_bf16 v[128:131], a[4:7], a[56:59], v[128:131]
    v_mfma_f32_16x16x32_bf16 v[184:187], a[0:3], a[44:47], 0
    ds_read_b64_tr_b16 a[30:31], v229 offset:26528
    v_mfma_f32_16x16x32_bf16 v[184:187], a[4:7], a[60:63], v[184:187]
    s_waitcnt lgkmcnt(8)
    v_mfma_f32_16x16x32_bf16 v[44:47], a[8:11], a[32:35], 0
    ds_read_b64_tr_b16 a[0:1], v229 offset:192
    v_mfma_f32_16x16x32_bf16 v[44:47], a[12:15], a[48:51], v[44:47]
    buffer_load_dwordx4 v224, s[52:55], s8 offen offset:0  lds
    v_mfma_f32_16x16x32_bf16 v[100:103], a[8:11], a[36:39], 0
    ds_read_b64_tr_b16 a[2:3], v229 offset:1984
    v_mfma_f32_16x16x32_bf16 v[100:103], a[12:15], a[52:55], v[100:103]
    v_mfma_f32_16x16x32_bf16 v[156:159], a[8:11], a[40:43], 0
    ds_read_b64_tr_b16 a[4:5], v229 offset:16576
    v_mfma_f32_16x16x32_bf16 v[156:159], a[12:15], a[56:59], v[156:159]
    v_mfma_f32_16x16x32_bf16 v[212:215], a[8:11], a[44:47], 0
    ds_read_b64_tr_b16 a[6:7], v229 offset:18368
    v_mfma_f32_16x16x32_bf16 v[212:215], a[12:15], a[60:63], v[212:215]
    buffer_load_dwordx4 v225, s[52:55], s8 offen offset:1024  lds
    s_waitcnt lgkmcnt(8)
    v_mfma_f32_16x16x32_bf16 v[20:23], a[16:19], a[32:35], 0
    ds_read_b64_tr_b16 a[8:9], v229 offset:8384
    v_mfma_f32_16x16x32_bf16 v[20:23], a[20:23], a[48:51], v[20:23]
    v_mfma_f32_16x16x32_bf16 v[76:79], a[16:19], a[36:39], 0
    ds_read_b64_tr_b16 a[10:11], v229 offset:10176
    v_mfma_f32_16x16x32_bf16 v[76:79], a[20:23], a[52:55], v[76:79]
    v_mfma_f32_16x16x32_bf16 v[132:135], a[16:19], a[40:43], 0
    ds_read_b64_tr_b16 a[12:13], v229 offset:24768
    v_mfma_f32_16x16x32_bf16 v[132:135], a[20:23], a[56:59], v[132:135]
    buffer_load_dwordx4 v226, s[52:55], s8 offen offset:2048  lds
    v_mfma_f32_16x16x32_bf16 v[188:191], a[16:19], a[44:47], 0
    ds_read_b64_tr_b16 a[14:15], v229 offset:26560
    v_mfma_f32_16x16x32_bf16 v[188:191], a[20:23], a[60:63], v[188:191]
    s_waitcnt lgkmcnt(8)
    v_mfma_f32_16x16x32_bf16 v[48:51], a[24:27], a[32:35], 0
    ds_read_b64_tr_b16 a[16:17], v229 offset:32768
    v_mfma_f32_16x16x32_bf16 v[48:51], a[28:31], a[48:51], v[48:51]
    v_mfma_f32_16x16x32_bf16 v[104:107], a[24:27], a[36:39], 0
    ds_read_b64_tr_b16 a[18:19], v229 offset:34560
    v_mfma_f32_16x16x32_bf16 v[104:107], a[28:31], a[52:55], v[104:107]
    buffer_load_dwordx4 v227, s[52:55], s8 offen offset:3072  lds
    s_mov_b32 s9, 524288
    v_mfma_f32_16x16x32_bf16 v[160:163], a[24:27], a[40:43], 0
    ds_read_b64_tr_b16 a[20:21], v229 offset:49152
    v_mfma_f32_16x16x32_bf16 v[160:163], a[28:31], a[56:59], v[160:163]
    v_mfma_f32_16x16x32_bf16 v[216:219], a[24:27], a[44:47], 0
    ds_read_b64_tr_b16 a[22:23], v229 offset:50944
    v_mfma_f32_16x16x32_bf16 v[216:219], a[28:31], a[60:63], v[216:219]
    s_waitcnt lgkmcnt(8)
    v_mfma_f32_16x16x32_bf16 v[24:27], a[0:3], a[32:35], 0
    ds_read_b64_tr_b16 a[24:25], v229 offset:40960
    v_mfma_f32_16x16x32_bf16 v[24:27], a[4:7], a[48:51], v[24:27]
    buffer_load_dwordx4 a[96:99], v228, s[44:47], s9 offen offset:0 sc1
    v_mfma_f32_16x16x32_bf16 v[80:83], a[0:3], a[36:39], 0
    ds_read_b64_tr_b16 a[26:27], v229 offset:42752
    v_mfma_f32_16x16x32_bf16 v[80:83], a[4:7], a[52:55], v[80:83]
    v_mfma_f32_16x16x32_bf16 v[136:139], a[0:3], a[40:43], 0
    ds_read_b64_tr_b16 a[28:29], v229 offset:57344
    v_mfma_f32_16x16x32_bf16 v[136:139], a[4:7], a[56:59], v[136:139]
    v_mfma_f32_16x16x32_bf16 v[192:195], a[0:3], a[44:47], 0
    ds_read_b64_tr_b16 a[30:31], v229 offset:59136
    v_mfma_f32_16x16x32_bf16 v[192:195], a[4:7], a[60:63], v[192:195]
    buffer_load_dwordx4 a[100:103], v228, s[44:47], s9 offen offset:1024 sc1
    s_waitcnt lgkmcnt(8)
    v_mfma_f32_16x16x32_bf16 v[52:55], a[8:11], a[32:35], 0
    ds_read_b64_tr_b16 a[0:1], v229 offset:32800
    v_mfma_f32_16x16x32_bf16 v[52:55], a[12:15], a[48:51], v[52:55]
    v_mfma_f32_16x16x32_bf16 v[108:111], a[8:11], a[36:39], 0
    ds_read_b64_tr_b16 a[2:3], v229 offset:34592
    v_mfma_f32_16x16x32_bf16 v[108:111], a[12:15], a[52:55], v[108:111]
    v_mfma_f32_16x16x32_bf16 v[164:167], a[8:11], a[40:43], 0
    ds_read_b64_tr_b16 a[4:5], v229 offset:49184
    v_mfma_f32_16x16x32_bf16 v[164:167], a[12:15], a[56:59], v[164:167]
    buffer_load_dwordx4 a[104:107], v228, s[44:47], s9 offen offset:2048 sc1
    v_mfma_f32_16x16x32_bf16 v[220:223], a[8:11], a[44:47], 0
    ds_read_b64_tr_b16 a[6:7], v229 offset:50976
    v_mfma_f32_16x16x32_bf16 v[220:223], a[12:15], a[60:63], v[220:223]
    s_waitcnt vmcnt(11) lgkmcnt(8)
    v_mfma_f32_16x16x32_bf16 v[0:3], a[16:19], a[64:67], v[0:3]
    ds_read_b64_tr_b16 a[8:9], v229 offset:40992
    v_mfma_f32_16x16x32_bf16 v[0:3], a[20:23], a[80:83], v[0:3]
    v_mfma_f32_16x16x32_bf16 v[56:59], a[16:19], a[68:71], v[56:59]
    ds_read_b64_tr_b16 a[10:11], v229 offset:42784
    v_mfma_f32_16x16x32_bf16 v[56:59], a[20:23], a[84:87], v[56:59]
    buffer_load_dwordx4 a[108:111], v228, s[44:47], s9 offen offset:3072 sc1
    s_mov_b32 s9, 655360
    v_mfma_f32_16x16x32_bf16 v[112:115], a[16:19], a[72:75], v[112:115]
    ds_read_b64_tr_b16 a[12:13], v229 offset:57376
    v_mfma_f32_16x16x32_bf16 v[112:115], a[20:23], a[88:91], v[112:115]
    v_mfma_f32_16x16x32_bf16 v[168:171], a[16:19], a[76:79], v[168:171]
    ds_read_b64_tr_b16 a[14:15], v229 offset:59168
    v_mfma_f32_16x16x32_bf16 v[168:171], a[20:23], a[92:95], v[168:171]
    s_waitcnt lgkmcnt(8)
    v_mfma_f32_16x16x32_bf16 v[28:31], a[24:27], a[64:67], v[28:31]
    ds_read_b64_tr_b16 a[16:17], v229 offset:32832
    v_mfma_f32_16x16x32_bf16 v[28:31], a[28:31], a[80:83], v[28:31]
    buffer_load_dwordx4 a[112:115], v228, s[44:47], s9 offen offset:0 sc1
    v_mfma_f32_16x16x32_bf16 v[84:87], a[24:27], a[68:71], v[84:87]
    ds_read_b64_tr_b16 a[18:19], v229 offset:34624
    v_mfma_f32_16x16x32_bf16 v[84:87], a[28:31], a[84:87], v[84:87]
    v_mfma_f32_16x16x32_bf16 v[140:143], a[24:27], a[72:75], v[140:143]
    ds_read_b64_tr_b16 a[20:21], v229 offset:49216
    v_mfma_f32_16x16x32_bf16 v[140:143], a[28:31], a[88:91], v[140:143]
    v_mfma_f32_16x16x32_bf16 v[196:199], a[24:27], a[76:79], v[196:199]
    ds_read_b64_tr_b16 a[22:23], v229 offset:51008
    v_mfma_f32_16x16x32_bf16 v[196:199], a[28:31], a[92:95], v[196:199]
    buffer_load_dwordx4 a[116:119], v228, s[44:47], s9 offen offset:1024 sc1
    s_waitcnt lgkmcnt(8)
    v_mfma_f32_16x16x32_bf16 v[4:7], a[0:3], a[64:67], v[4:7]
    ds_read_b64_tr_b16 a[24:25], v229 offset:41024
    v_mfma_f32_16x16x32_bf16 v[4:7], a[4:7], a[80:83], v[4:7]
    v_mfma_f32_16x16x32_bf16 v[60:63], a[0:3], a[68:71], v[60:63]
    ds_read_b64_tr_b16 a[26:27], v229 offset:42816
    v_mfma_f32_16x16x32_bf16 v[60:63], a[4:7], a[84:87], v[60:63]
    v_mfma_f32_16x16x32_bf16 v[116:119], a[0:3], a[72:75], v[116:119]
    ds_read_b64_tr_b16 a[28:29], v229 offset:57408
    v_mfma_f32_16x16x32_bf16 v[116:119], a[4:7], a[88:91], v[116:119]
    buffer_load_dwordx4 a[120:123], v228, s[44:47], s9 offen offset:2048 sc1
    v_mfma_f32_16x16x32_bf16 v[172:175], a[0:3], a[76:79], v[172:175]
    ds_read_b64_tr_b16 a[30:31], v229 offset:59200
    v_mfma_f32_16x16x32_bf16 v[172:175], a[4:7], a[92:95], v[172:175]
    s_waitcnt lgkmcnt(8)
    v_mfma_f32_16x16x32_bf16 v[32:35], a[8:11], a[64:67], v[32:35]
    ds_read_b64_tr_b16 a[0:1], v229 offset:32864
    v_mfma_f32_16x16x32_bf16 v[32:35], a[12:15], a[80:83], v[32:35]
    v_mfma_f32_16x16x32_bf16 v[88:91], a[8:11], a[68:71], v[88:91]
    ds_read_b64_tr_b16 a[2:3], v229 offset:34656
    v_mfma_f32_16x16x32_bf16 v[88:91], a[12:15], a[84:87], v[88:91]
    buffer_load_dwordx4 a[124:127], v228, s[44:47], s9 offen offset:3072 sc1
    s_add_u32 s8, s7, 1376256
    s_add_u32 m0, s6, 98304
    v_mfma_f32_16x16x32_bf16 v[144:147], a[8:11], a[72:75], v[144:147]
    ds_read_b64_tr_b16 a[4:5], v229 offset:49248
    v_mfma_f32_16x16x32_bf16 v[144:147], a[12:15], a[88:91], v[144:147]
    v_mfma_f32_16x16x32_bf16 v[200:203], a[8:11], a[76:79], v[200:203]
    ds_read_b64_tr_b16 a[6:7], v229 offset:51040
    v_mfma_f32_16x16x32_bf16 v[200:203], a[12:15], a[92:95], v[200:203]
    s_waitcnt lgkmcnt(8)
    v_mfma_f32_16x16x32_bf16 v[8:11], a[16:19], a[64:67], v[8:11]
    ds_read_b64_tr_b16 a[8:9], v229 offset:41056
    v_mfma_f32_16x16x32_bf16 v[8:11], a[20:23], a[80:83], v[8:11]
    buffer_load_dwordx4 v224, s[52:55], s8 offen offset:0  lds
    v_mfma_f32_16x16x32_bf16 v[64:67], a[16:19], a[68:71], v[64:67]
    ds_read_b64_tr_b16 a[10:11], v229 offset:42848
    v_mfma_f32_16x16x32_bf16 v[64:67], a[20:23], a[84:87], v[64:67]
    v_mfma_f32_16x16x32_bf16 v[120:123], a[16:19], a[72:75], v[120:123]
    ds_read_b64_tr_b16 a[12:13], v229 offset:57440
    v_mfma_f32_16x16x32_bf16 v[120:123], a[20:23], a[88:91], v[120:123]
    v_mfma_f32_16x16x32_bf16 v[176:179], a[16:19], a[76:79], v[176:179]
    ds_read_b64_tr_b16 a[14:15], v229 offset:59232
    v_mfma_f32_16x16x32_bf16 v[176:179], a[20:23], a[92:95], v[176:179]
    buffer_load_dwordx4 v225, s[52:55], s8 offen offset:1024  lds
    s_waitcnt lgkmcnt(8)
    v_mfma_f32_16x16x32_bf16 v[36:39], a[24:27], a[64:67], v[36:39]
    ds_read_b64_tr_b16 a[16:17], v229 offset:32896
    v_mfma_f32_16x16x32_bf16 v[36:39], a[28:31], a[80:83], v[36:39]
    v_mfma_f32_16x16x32_bf16 v[92:95], a[24:27], a[68:71], v[92:95]
    ds_read_b64_tr_b16 a[18:19], v229 offset:34688
    v_mfma_f32_16x16x32_bf16 v[92:95], a[28:31], a[84:87], v[92:95]
    v_mfma_f32_16x16x32_bf16 v[148:151], a[24:27], a[72:75], v[148:151]
    ds_read_b64_tr_b16 a[20:21], v229 offset:49280
    v_mfma_f32_16x16x32_bf16 v[148:151], a[28:31], a[88:91], v[148:151]
    buffer_load_dwordx4 v226, s[52:55], s8 offen offset:2048  lds
    v_mfma_f32_16x16x32_bf16 v[204:207], a[24:27], a[76:79], v[204:207]
    ds_read_b64_tr_b16 a[22:23], v229 offset:51072
    v_mfma_f32_16x16x32_bf16 v[204:207], a[28:31], a[92:95], v[204:207]
    s_waitcnt lgkmcnt(8)
    v_mfma_f32_16x16x32_bf16 v[12:15], a[0:3], a[64:67], v[12:15]
    ds_read_b64_tr_b16 a[24:25], v229 offset:41088
    v_mfma_f32_16x16x32_bf16 v[12:15], a[4:7], a[80:83], v[12:15]
    v_mfma_f32_16x16x32_bf16 v[68:71], a[0:3], a[68:71], v[68:71]
    ds_read_b64_tr_b16 a[26:27], v229 offset:42880
    v_mfma_f32_16x16x32_bf16 v[68:71], a[4:7], a[84:87], v[68:71]
    buffer_load_dwordx4 v227, s[52:55], s8 offen offset:3072  lds
    s_add_u32 s8, s7, 1605632
    s_add_u32 m0, s6, 114688
    v_mfma_f32_16x16x32_bf16 v[124:127], a[0:3], a[72:75], v[124:127]
    ds_read_b64_tr_b16 a[28:29], v229 offset:57472
    v_mfma_f32_16x16x32_bf16 v[124:127], a[4:7], a[88:91], v[124:127]
    v_mfma_f32_16x16x32_bf16 v[180:183], a[0:3], a[76:79], v[180:183]
    ds_read_b64_tr_b16 a[30:31], v229 offset:59264
    v_mfma_f32_16x16x32_bf16 v[180:183], a[4:7], a[92:95], v[180:183]
    s_waitcnt lgkmcnt(8)
    v_mfma_f32_16x16x32_bf16 v[40:43], a[8:11], a[64:67], v[40:43]
    ds_read_b64_tr_b16 a[0:1], v229 offset:32928
    v_mfma_f32_16x16x32_bf16 v[40:43], a[12:15], a[80:83], v[40:43]
    buffer_load_dwordx4 v224, s[52:55], s8 offen offset:0  lds
    v_mfma_f32_16x16x32_bf16 v[96:99], a[8:11], a[68:71], v[96:99]
    ds_read_b64_tr_b16 a[2:3], v229 offset:34720
    v_mfma_f32_16x16x32_bf16 v[96:99], a[12:15], a[84:87], v[96:99]
    v_mfma_f32_16x16x32_bf16 v[152:155], a[8:11], a[72:75], v[152:155]
    ds_read_b64_tr_b16 a[4:5], v229 offset:49312
    v_mfma_f32_16x16x32_bf16 v[152:155], a[12:15], a[88:91], v[152:155]
    v_mfma_f32_16x16x32_bf16 v[208:211], a[8:11], a[76:79], v[208:211]
    ds_read_b64_tr_b16 a[6:7], v229 offset:51104
    v_mfma_f32_16x16x32_bf16 v[208:211], a[12:15], a[92:95], v[208:211]
    buffer_load_dwordx4 v225, s[52:55], s8 offen offset:1024  lds
    s_waitcnt lgkmcnt(8)
    v_mfma_f32_16x16x32_bf16 v[16:19], a[16:19], a[64:67], v[16:19]
    ds_read_b64_tr_b16 a[8:9], v229 offset:41120
    v_mfma_f32_16x16x32_bf16 v[16:19], a[20:23], a[80:83], v[16:19]
    v_mfma_f32_16x16x32_bf16 v[72:75], a[16:19], a[68:71], v[72:75]
    ds_read_b64_tr_b16 a[10:11], v229 offset:42912
    v_mfma_f32_16x16x32_bf16 v[72:75], a[20:23], a[84:87], v[72:75]
    v_mfma_f32_16x16x32_bf16 v[128:131], a[16:19], a[72:75], v[128:131]
    ds_read_b64_tr_b16 a[12:13], v229 offset:57504
    v_mfma_f32_16x16x32_bf16 v[128:131], a[20:23], a[88:91], v[128:131]
    buffer_load_dwordx4 v226, s[52:55], s8 offen offset:2048  lds
    v_mfma_f32_16x16x32_bf16 v[184:187], a[16:19], a[76:79], v[184:187]
    ds_read_b64_tr_b16 a[14:15], v229 offset:59296
    v_mfma_f32_16x16x32_bf16 v[184:187], a[20:23], a[92:95], v[184:187]
    s_waitcnt lgkmcnt(8)
    v_mfma_f32_16x16x32_bf16 v[44:47], a[24:27], a[64:67], v[44:47]
    ds_read_b64_tr_b16 a[16:17], v229 offset:32960
    v_mfma_f32_16x16x32_bf16 v[44:47], a[28:31], a[80:83], v[44:47]
    v_mfma_f32_16x16x32_bf16 v[100:103], a[24:27], a[68:71], v[100:103]
    ds_read_b64_tr_b16 a[18:19], v229 offset:34752
    v_mfma_f32_16x16x32_bf16 v[100:103], a[28:31], a[84:87], v[100:103]
    buffer_load_dwordx4 v227, s[52:55], s8 offen offset:3072  lds
    s_mov_b32 s9, 786432
    v_mfma_f32_16x16x32_bf16 v[156:159], a[24:27], a[72:75], v[156:159]
    ds_read_b64_tr_b16 a[20:21], v229 offset:49344
    v_mfma_f32_16x16x32_bf16 v[156:159], a[28:31], a[88:91], v[156:159]
    v_mfma_f32_16x16x32_bf16 v[212:215], a[24:27], a[76:79], v[212:215]
    ds_read_b64_tr_b16 a[22:23], v229 offset:51136
    v_mfma_f32_16x16x32_bf16 v[212:215], a[28:31], a[92:95], v[212:215]
    s_waitcnt lgkmcnt(8)
    v_mfma_f32_16x16x32_bf16 v[20:23], a[0:3], a[64:67], v[20:23]
    ds_read_b64_tr_b16 a[24:25], v229 offset:41152
    v_mfma_f32_16x16x32_bf16 v[20:23], a[4:7], a[80:83], v[20:23]
    buffer_load_dwordx4 a[128:131], v228, s[44:47], s9 offen offset:0 sc1
    v_mfma_f32_16x16x32_bf16 v[76:79], a[0:3], a[68:71], v[76:79]
    ds_read_b64_tr_b16 a[26:27], v229 offset:42944
    v_mfma_f32_16x16x32_bf16 v[76:79], a[4:7], a[84:87], v[76:79]
    v_mfma_f32_16x16x32_bf16 v[132:135], a[0:3], a[72:75], v[132:135]
    ds_read_b64_tr_b16 a[28:29], v229 offset:57536
    v_mfma_f32_16x16x32_bf16 v[132:135], a[4:7], a[88:91], v[132:135]
    v_mfma_f32_16x16x32_bf16 v[188:191], a[0:3], a[76:79], v[188:191]
    ds_read_b64_tr_b16 a[30:31], v229 offset:59328
    v_mfma_f32_16x16x32_bf16 v[188:191], a[4:7], a[92:95], v[188:191]
    buffer_load_dwordx4 a[132:135], v228, s[44:47], s9 offen offset:1024 sc1
    s_waitcnt vmcnt(18) lgkmcnt(8)
    s_barrier
    v_mfma_f32_16x16x32_bf16 v[48:51], a[8:11], a[64:67], v[48:51]
    ds_read_b64_tr_b16 a[0:1], v230 offset:0
    v_mfma_f32_16x16x32_bf16 v[48:51], a[12:15], a[80:83], v[48:51]
    v_mfma_f32_16x16x32_bf16 v[104:107], a[8:11], a[68:71], v[104:107]
    ds_read_b64_tr_b16 a[2:3], v230 offset:1792
    v_mfma_f32_16x16x32_bf16 v[104:107], a[12:15], a[84:87], v[104:107]
    v_mfma_f32_16x16x32_bf16 v[160:163], a[8:11], a[72:75], v[160:163]
    ds_read_b64_tr_b16 a[4:5], v230 offset:16384
    v_mfma_f32_16x16x32_bf16 v[160:163], a[12:15], a[88:91], v[160:163]
    buffer_load_dwordx4 a[136:139], v228, s[44:47], s9 offen offset:2048 sc1
    v_mfma_f32_16x16x32_bf16 v[216:219], a[8:11], a[76:79], v[216:219]
    ds_read_b64_tr_b16 a[6:7], v230 offset:18176
    v_mfma_f32_16x16x32_bf16 v[216:219], a[12:15], a[92:95], v[216:219]
    s_waitcnt lgkmcnt(8)
    v_mfma_f32_16x16x32_bf16 v[24:27], a[16:19], a[64:67], v[24:27]
    ds_read_b64_tr_b16 a[8:9], v230 offset:8192
    v_mfma_f32_16x16x32_bf16 v[24:27], a[20:23], a[80:83], v[24:27]
    v_mfma_f32_16x16x32_bf16 v[80:83], a[16:19], a[68:71], v[80:83]
    ds_read_b64_tr_b16 a[10:11], v230 offset:9984
    v_mfma_f32_16x16x32_bf16 v[80:83], a[20:23], a[84:87], v[80:83]
    buffer_load_dwordx4 a[140:143], v228, s[44:47], s9 offen offset:3072 sc1
    s_mov_b32 s9, 917504
    v_mfma_f32_16x16x32_bf16 v[136:139], a[16:19], a[72:75], v[136:139]
    ds_read_b64_tr_b16 a[12:13], v230 offset:24576
    v_mfma_f32_16x16x32_bf16 v[136:139], a[20:23], a[88:91], v[136:139]
    v_mfma_f32_16x16x32_bf16 v[192:195], a[16:19], a[76:79], v[192:195]
    ds_read_b64_tr_b16 a[14:15], v230 offset:26368
    v_mfma_f32_16x16x32_bf16 v[192:195], a[20:23], a[92:95], v[192:195]
    s_waitcnt lgkmcnt(8)
    v_mfma_f32_16x16x32_bf16 v[52:55], a[24:27], a[64:67], v[52:55]
    ds_read_b64_tr_b16 a[16:17], v230 offset:32
    v_mfma_f32_16x16x32_bf16 v[52:55], a[28:31], a[80:83], v[52:55]
    buffer_load_dwordx4 a[144:147], v228, s[44:47], s9 offen offset:0 sc1
    v_mfma_f32_16x16x32_bf16 v[108:111], a[24:27], a[68:71], v[108:111]
    ds_read_b64_tr_b16 a[18:19], v230 offset:1824
    v_mfma_f32_16x16x32_bf16 v[108:111], a[28:31], a[84:87], v[108:111]
    v_mfma_f32_16x16x32_bf16 v[164:167], a[24:27], a[72:75], v[164:167]
    ds_read_b64_tr_b16 a[20:21], v230 offset:16416
    v_mfma_f32_16x16x32_bf16 v[164:167], a[28:31], a[88:91], v[164:167]
    v_mfma_f32_16x16x32_bf16 v[220:223], a[24:27], a[76:79], v[220:223]
    ds_read_b64_tr_b16 a[22:23], v230 offset:18208
    v_mfma_f32_16x16x32_bf16 v[220:223], a[28:31], a[92:95], v[220:223]
    buffer_load_dwordx4 a[148:151], v228, s[44:47], s9 offen offset:1024 sc1
    s_waitcnt vmcnt(14) lgkmcnt(8)
    v_mfma_f32_16x16x32_bf16 v[0:3], a[0:3], a[96:99], v[0:3]
    ds_read_b64_tr_b16 a[24:25], v230 offset:8224
    v_mfma_f32_16x16x32_bf16 v[0:3], a[4:7], a[112:115], v[0:3]
    v_mfma_f32_16x16x32_bf16 v[56:59], a[0:3], a[100:103], v[56:59]
    ds_read_b64_tr_b16 a[26:27], v230 offset:10016
    v_mfma_f32_16x16x32_bf16 v[56:59], a[4:7], a[116:119], v[56:59]
    v_mfma_f32_16x16x32_bf16 v[112:115], a[0:3], a[104:107], v[112:115]
    ds_read_b64_tr_b16 a[28:29], v230 offset:24608
    v_mfma_f32_16x16x32_bf16 v[112:115], a[4:7], a[120:123], v[112:115]
    buffer_load_dwordx4 a[152:155], v228, s[44:47], s9 offen offset:2048 sc1
    v_mfma_f32_16x16x32_bf16 v[168:171], a[0:3], a[108:111], v[168:171]
    ds_read_b64_tr_b16 a[30:31], v230 offset:26400
    v_mfma_f32_16x16x32_bf16 v[168:171], a[4:7], a[124:127], v[168:171]
    s_waitcnt lgkmcnt(8)
    v_mfma_f32_16x16x32_bf16 v[28:31], a[8:11], a[96:99], v[28:31]
    ds_read_b64_tr_b16 a[0:1], v230 offset:64
    v_mfma_f32_16x16x32_bf16 v[28:31], a[12:15], a[112:115], v[28:31]
    v_mfma_f32_16x16x32_bf16 v[84:87], a[8:11], a[100:103], v[84:87]
    ds_read_b64_tr_b16 a[2:3], v230 offset:1856
    v_mfma_f32_16x16x32_bf16 v[84:87], a[12:15], a[116:119], v[84:87]
    buffer_load_dwordx4 a[156:159], v228, s[44:47], s9 offen offset:3072 sc1
    s_add_u32 s8, s7, 1835008
    s_add_u32 m0, s6, 0
    v_mfma_f32_16x16x32_bf16 v[140:143], a[8:11], a[104:107], v[140:143]
    ds_read_b64_tr_b16 a[4:5], v230 offset:16448
    v_mfma_f32_16x16x32_bf16 v[140:143], a[12:15], a[120:123], v[140:143]
    v_mfma_f32_16x16x32_bf16 v[196:199], a[8:11], a[108:111], v[196:199]
    ds_read_b64_tr_b16 a[6:7], v230 offset:18240
    v_mfma_f32_16x16x32_bf16 v[196:199], a[12:15], a[124:127], v[196:199]
    s_waitcnt lgkmcnt(8)
    v_mfma_f32_16x16x32_bf16 v[4:7], a[16:19], a[96:99], v[4:7]
    ds_read_b64_tr_b16 a[8:9], v230 offset:8256
    v_mfma_f32_16x16x32_bf16 v[4:7], a[20:23], a[112:115], v[4:7]
    buffer_load_dwordx4 v224, s[52:55], s8 offen offset:0  lds
    v_mfma_f32_16x16x32_bf16 v[60:63], a[16:19], a[100:103], v[60:63]
    ds_read_b64_tr_b16 a[10:11], v230 offset:10048
    v_mfma_f32_16x16x32_bf16 v[60:63], a[20:23], a[116:119], v[60:63]
    v_mfma_f32_16x16x32_bf16 v[116:119], a[16:19], a[104:107], v[116:119]
    ds_read_b64_tr_b16 a[12:13], v230 offset:24640
    v_mfma_f32_16x16x32_bf16 v[116:119], a[20:23], a[120:123], v[116:119]
    v_mfma_f32_16x16x32_bf16 v[172:175], a[16:19], a[108:111], v[172:175]
    ds_read_b64_tr_b16 a[14:15], v230 offset:26432
    s_branch L_fused_kernel_pc4
L_fused_kernel_isl0_4:
    s_branch L_fused_kernel_isl0_8
L_fused_kernel_pc4:
    v_mfma_f32_16x16x32_bf16 v[172:175], a[20:23], a[124:127], v[172:175]
    buffer_load_dwordx4 v225, s[52:55], s8 offen offset:1024  lds
    s_waitcnt lgkmcnt(8)
    v_mfma_f32_16x16x32_bf16 v[32:35], a[24:27], a[96:99], v[32:35]
    ds_read_b64_tr_b16 a[16:17], v230 offset:96
    v_mfma_f32_16x16x32_bf16 v[32:35], a[28:31], a[112:115], v[32:35]
    v_mfma_f32_16x16x32_bf16 v[88:91], a[24:27], a[100:103], v[88:91]
    ds_read_b64_tr_b16 a[18:19], v230 offset:1888
    v_mfma_f32_16x16x32_bf16 v[88:91], a[28:31], a[116:119], v[88:91]
    v_mfma_f32_16x16x32_bf16 v[144:147], a[24:27], a[104:107], v[144:147]
    ds_read_b64_tr_b16 a[20:21], v230 offset:16480
    v_mfma_f32_16x16x32_bf16 v[144:147], a[28:31], a[120:123], v[144:147]
    buffer_load_dwordx4 v226, s[52:55], s8 offen offset:2048  lds
    v_mfma_f32_16x16x32_bf16 v[200:203], a[24:27], a[108:111], v[200:203]
    ds_read_b64_tr_b16 a[22:23], v230 offset:18272
    v_mfma_f32_16x16x32_bf16 v[200:203], a[28:31], a[124:127], v[200:203]
    s_waitcnt lgkmcnt(8)
    v_mfma_f32_16x16x32_bf16 v[8:11], a[0:3], a[96:99], v[8:11]
    ds_read_b64_tr_b16 a[24:25], v230 offset:8288
    v_mfma_f32_16x16x32_bf16 v[8:11], a[4:7], a[112:115], v[8:11]
    v_mfma_f32_16x16x32_bf16 v[64:67], a[0:3], a[100:103], v[64:67]
    ds_read_b64_tr_b16 a[26:27], v230 offset:10080
    v_mfma_f32_16x16x32_bf16 v[64:67], a[4:7], a[116:119], v[64:67]
    buffer_load_dwordx4 v227, s[52:55], s8 offen offset:3072  lds
    s_mov_b32 s16, 3670016
    v_mfma_f32_16x16x32_bf16 v[120:123], a[0:3], a[104:107], v[120:123]
    ds_read_b64_tr_b16 a[28:29], v230 offset:24672
    v_mfma_f32_16x16x32_bf16 v[120:123], a[4:7], a[120:123], v[120:123]
    v_mfma_f32_16x16x32_bf16 v[176:179], a[0:3], a[108:111], v[176:179]
    ds_read_b64_tr_b16 a[30:31], v230 offset:26464
    v_mfma_f32_16x16x32_bf16 v[176:179], a[4:7], a[124:127], v[176:179]
    s_waitcnt lgkmcnt(8)
    v_mfma_f32_16x16x32_bf16 v[36:39], a[8:11], a[96:99], v[36:39]
    ds_read_b64_tr_b16 a[0:1], v230 offset:128
    v_mfma_f32_16x16x32_bf16 v[36:39], a[12:15], a[112:115], v[36:39]
    buffer_load_dword a255, v232, s[52:55], s16 offen
    s_add_u32 s8, s7, 2064384
    s_add_u32 m0, s6, 16384
    v_mfma_f32_16x16x32_bf16 v[92:95], a[8:11], a[100:103], v[92:95]
    ds_read_b64_tr_b16 a[2:3], v230 offset:1920
    v_mfma_f32_16x16x32_bf16 v[92:95], a[12:15], a[116:119], v[92:95]
    v_mfma_f32_16x16x32_bf16 v[148:151], a[8:11], a[104:107], v[148:151]
    ds_read_b64_tr_b16 a[4:5], v230 offset:16512
    v_mfma_f32_16x16x32_bf16 v[148:151], a[12:15], a[120:123], v[148:151]
    v_mfma_f32_16x16x32_bf16 v[204:207], a[8:11], a[108:111], v[204:207]
    ds_read_b64_tr_b16 a[6:7], v230 offset:18304
    v_mfma_f32_16x16x32_bf16 v[204:207], a[12:15], a[124:127], v[204:207]
    buffer_load_dwordx4 v224, s[52:55], s8 offen offset:0  lds
    s_waitcnt lgkmcnt(8)
    v_mfma_f32_16x16x32_bf16 v[12:15], a[16:19], a[96:99], v[12:15]
    ds_read_b64_tr_b16 a[8:9], v230 offset:8320
    v_mfma_f32_16x16x32_bf16 v[12:15], a[20:23], a[112:115], v[12:15]
    v_mfma_f32_16x16x32_bf16 v[68:71], a[16:19], a[100:103], v[68:71]
    ds_read_b64_tr_b16 a[10:11], v230 offset:10112
    v_mfma_f32_16x16x32_bf16 v[68:71], a[20:23], a[116:119], v[68:71]
    v_mfma_f32_16x16x32_bf16 v[124:127], a[16:19], a[104:107], v[124:127]
    ds_read_b64_tr_b16 a[12:13], v230 offset:24704
    v_mfma_f32_16x16x32_bf16 v[124:127], a[20:23], a[120:123], v[124:127]
    buffer_load_dwordx4 v225, s[52:55], s8 offen offset:1024  lds
    v_mfma_f32_16x16x32_bf16 v[180:183], a[16:19], a[108:111], v[180:183]
    ds_read_b64_tr_b16 a[14:15], v230 offset:26496
    v_mfma_f32_16x16x32_bf16 v[180:183], a[20:23], a[124:127], v[180:183]
    s_waitcnt lgkmcnt(8)
    v_mfma_f32_16x16x32_bf16 v[40:43], a[24:27], a[96:99], v[40:43]
    ds_read_b64_tr_b16 a[16:17], v230 offset:160
    v_mfma_f32_16x16x32_bf16 v[40:43], a[28:31], a[112:115], v[40:43]
    v_mfma_f32_16x16x32_bf16 v[96:99], a[24:27], a[100:103], v[96:99]
    ds_read_b64_tr_b16 a[18:19], v230 offset:1952
    v_mfma_f32_16x16x32_bf16 v[96:99], a[28:31], a[116:119], v[96:99]
    buffer_load_dwordx4 v226, s[52:55], s8 offen offset:2048  lds
    v_mfma_f32_16x16x32_bf16 v[152:155], a[24:27], a[104:107], v[152:155]
    ds_read_b64_tr_b16 a[20:21], v230 offset:16544
    v_mfma_f32_16x16x32_bf16 v[152:155], a[28:31], a[120:123], v[152:155]
    v_mfma_f32_16x16x32_bf16 v[208:211], a[24:27], a[108:111], v[208:211]
    ds_read_b64_tr_b16 a[22:23], v230 offset:18336
    v_mfma_f32_16x16x32_bf16 v[208:211], a[28:31], a[124:127], v[208:211]
    s_waitcnt lgkmcnt(8)
    v_mfma_f32_16x16x32_bf16 v[16:19], a[0:3], a[96:99], v[16:19]
    ds_read_b64_tr_b16 a[24:25], v230 offset:8352
    v_mfma_f32_16x16x32_bf16 v[16:19], a[4:7], a[112:115], v[16:19]
    buffer_load_dwordx4 v227, s[52:55], s8 offen offset:3072  lds
    s_mov_b32 s9, 1048576
    v_mfma_f32_16x16x32_bf16 v[72:75], a[0:3], a[100:103], v[72:75]
    ds_read_b64_tr_b16 a[26:27], v230 offset:10144
    v_mfma_f32_16x16x32_bf16 v[72:75], a[4:7], a[116:119], v[72:75]
    v_mfma_f32_16x16x32_bf16 v[128:131], a[0:3], a[104:107], v[128:131]
    ds_read_b64_tr_b16 a[28:29], v230 offset:24736
    v_mfma_f32_16x16x32_bf16 v[128:131], a[4:7], a[120:123], v[128:131]
    v_mfma_f32_16x16x32_bf16 v[184:187], a[0:3], a[108:111], v[184:187]
    ds_read_b64_tr_b16 a[30:31], v230 offset:26528
    v_mfma_f32_16x16x32_bf16 v[184:187], a[4:7], a[124:127], v[184:187]
    buffer_load_dwordx4 a[32:35], v228, s[44:47], s9 offen offset:0 sc1
    s_waitcnt lgkmcnt(8)
    v_mfma_f32_16x16x32_bf16 v[44:47], a[8:11], a[96:99], v[44:47]
    ds_read_b64_tr_b16 a[0:1], v230 offset:192
    v_mfma_f32_16x16x32_bf16 v[44:47], a[12:15], a[112:115], v[44:47]
    v_mfma_f32_16x16x32_bf16 v[100:103], a[8:11], a[100:103], v[100:103]
    ds_read_b64_tr_b16 a[2:3], v230 offset:1984
    v_mfma_f32_16x16x32_bf16 v[100:103], a[12:15], a[116:119], v[100:103]
    v_mfma_f32_16x16x32_bf16 v[156:159], a[8:11], a[104:107], v[156:159]
    ds_read_b64_tr_b16 a[4:5], v230 offset:16576
    v_mfma_f32_16x16x32_bf16 v[156:159], a[12:15], a[120:123], v[156:159]
    buffer_load_dwordx4 a[36:39], v228, s[44:47], s9 offen offset:1024 sc1
    v_mfma_f32_16x16x32_bf16 v[212:215], a[8:11], a[108:111], v[212:215]
    ds_read_b64_tr_b16 a[6:7], v230 offset:18368
    v_mfma_f32_16x16x32_bf16 v[212:215], a[12:15], a[124:127], v[212:215]
    s_waitcnt lgkmcnt(8)
    v_mfma_f32_16x16x32_bf16 v[20:23], a[16:19], a[96:99], v[20:23]
    ds_read_b64_tr_b16 a[8:9], v230 offset:8384
    v_mfma_f32_16x16x32_bf16 v[20:23], a[20:23], a[112:115], v[20:23]
    v_mfma_f32_16x16x32_bf16 v[76:79], a[16:19], a[100:103], v[76:79]
    ds_read_b64_tr_b16 a[10:11], v230 offset:10176
    v_mfma_f32_16x16x32_bf16 v[76:79], a[20:23], a[116:119], v[76:79]
    buffer_load_dwordx4 a[40:43], v228, s[44:47], s9 offen offset:2048 sc1
    v_mfma_f32_16x16x32_bf16 v[132:135], a[16:19], a[104:107], v[132:135]
    ds_read_b64_tr_b16 a[12:13], v230 offset:24768
    v_mfma_f32_16x16x32_bf16 v[132:135], a[20:23], a[120:123], v[132:135]
    v_mfma_f32_16x16x32_bf16 v[188:191], a[16:19], a[108:111], v[188:191]
    ds_read_b64_tr_b16 a[14:15], v230 offset:26560
    v_mfma_f32_16x16x32_bf16 v[188:191], a[20:23], a[124:127], v[188:191]
    s_waitcnt vmcnt(20) lgkmcnt(8)
    s_barrier
    v_mfma_f32_16x16x32_bf16 v[48:51], a[24:27], a[96:99], v[48:51]
    ds_read_b64_tr_b16 a[16:17], v230 offset:32768
    v_mfma_f32_16x16x32_bf16 v[48:51], a[28:31], a[112:115], v[48:51]
    buffer_load_dwordx4 a[44:47], v228, s[44:47], s9 offen offset:3072 sc1
    s_mov_b32 s9, 1179648
    v_mfma_f32_16x16x32_bf16 v[104:107], a[24:27], a[100:103], v[104:107]
    ds_read_b64_tr_b16 a[18:19], v230 offset:34560
    v_mfma_f32_16x16x32_bf16 v[104:107], a[28:31], a[116:119], v[104:107]
    v_mfma_f32_16x16x32_bf16 v[160:163], a[24:27], a[104:107], v[160:163]
    ds_read_b64_tr_b16 a[20:21], v230 offset:49152
    v_mfma_f32_16x16x32_bf16 v[160:163], a[28:31], a[120:123], v[160:163]
    v_mfma_f32_16x16x32_bf16 v[216:219], a[24:27], a[108:111], v[216:219]
    ds_read_b64_tr_b16 a[22:23], v230 offset:50944
    v_mfma_f32_16x16x32_bf16 v[216:219], a[28:31], a[124:127], v[216:219]
    buffer_load_dwordx4 a[48:51], v228, s[44:47], s9 offen offset:0 sc1
    s_waitcnt lgkmcnt(8)
    v_mfma_f32_16x16x32_bf16 v[24:27], a[0:3], a[96:99], v[24:27]
    ds_read_b64_tr_b16 a[24:25], v230 offset:40960
    v_mfma_f32_16x16x32_bf16 v[24:27], a[4:7], a[112:115], v[24:27]
    v_mfma_f32_16x16x32_bf16 v[80:83], a[0:3], a[100:103], v[80:83]
    ds_read_b64_tr_b16 a[26:27], v230 offset:42752
    v_mfma_f32_16x16x32_bf16 v[80:83], a[4:7], a[116:119], v[80:83]
    v_mfma_f32_16x16x32_bf16 v[136:139], a[0:3], a[104:107], v[136:139]
    ds_read_b64_tr_b16 a[28:29], v230 offset:57344
    v_mfma_f32_16x16x32_bf16 v[136:139], a[4:7], a[120:123], v[136:139]
    buffer_load_dwordx4 a[52:55], v228, s[44:47], s9 offen offset:1024 sc1
    v_mfma_f32_16x16x32_bf16 v[192:195], a[0:3], a[108:111], v[192:195]
    ds_read_b64_tr_b16 a[30:31], v230 offset:59136
    v_mfma_f32_16x16x32_bf16 v[192:195], a[4:7], a[124:127], v[192:195]
    s_waitcnt lgkmcnt(8)
    v_mfma_f32_16x16x32_bf16 v[52:55], a[8:11], a[96:99], v[52:55]
    ds_read_b64_tr_b16 a[0:1], v230 offset:32800
    v_mfma_f32_16x16x32_bf16 v[52:55], a[12:15], a[112:115], v[52:55]
    v_mfma_f32_16x16x32_bf16 v[108:111], a[8:11], a[100:103], v[108:111]
    ds_read_b64_tr_b16 a[2:3], v230 offset:34592
    v_mfma_f32_16x16x32_bf16 v[108:111], a[12:15], a[116:119], v[108:111]
    buffer_load_dwordx4 a[56:59], v228, s[44:47], s9 offen offset:2048 sc1
    v_mfma_f32_16x16x32_bf16 v[164:167], a[8:11], a[104:107], v[164:167]
    ds_read_b64_tr_b16 a[4:5], v230 offset:49184
    v_mfma_f32_16x16x32_bf16 v[164:167], a[12:15], a[120:123], v[164:167]
    v_mfma_f32_16x16x32_bf16 v[220:223], a[8:11], a[108:111], v[220:223]
    ds_read_b64_tr_b16 a[6:7], v230 offset:50976
    v_mfma_f32_16x16x32_bf16 v[220:223], a[12:15], a[124:127], v[220:223]
    s_waitcnt vmcnt(16) lgkmcnt(8)
    v_mfma_f32_16x16x32_bf16 v[0:3], a[16:19], a[128:131], v[0:3]
    ds_read_b64_tr_b16 a[8:9], v230 offset:40992
    v_mfma_f32_16x16x32_bf16 v[0:3], a[20:23], a[144:147], v[0:3]
    buffer_load_dwordx4 a[60:63], v228, s[44:47], s9 offen offset:3072 sc1
    s_add_u32 s8, s7, 2293760
    s_add_u32 m0, s6, 32768
    v_mfma_f32_16x16x32_bf16 v[56:59], a[16:19], a[132:135], v[56:59]
    ds_read_b64_tr_b16 a[10:11], v230 offset:42784
    v_mfma_f32_16x16x32_bf16 v[56:59], a[20:23], a[148:151], v[56:59]
    v_mfma_f32_16x16x32_bf16 v[112:115], a[16:19], a[136:139], v[112:115]
    ds_read_b64_tr_b16 a[12:13], v230 offset:57376
    v_mfma_f32_16x16x32_bf16 v[112:115], a[20:23], a[152:155], v[112:115]
    v_mfma_f32_16x16x32_bf16 v[168:171], a[16:19], a[140:143], v[168:171]
    ds_read_b64_tr_b16 a[14:15], v230 offset:59168
    v_mfma_f32_16x16x32_bf16 v[168:171], a[20:23], a[156:159], v[168:171]
    buffer_load_dwordx4 v224, s[52:55], s8 offen offset:0  lds
    s_waitcnt lgkmcnt(8)
    v_mfma_f32_16x16x32_bf16 v[28:31], a[24:27], a[128:131], v[28:31]
    ds_read_b64_tr_b16 a[16:17], v230 offset:32832
    v_mfma_f32_16x16x32_bf16 v[28:31], a[28:31], a[144:147], v[28:31]
    v_mfma_f32_16x16x32_bf16 v[84:87], a[24:27], a[132:135], v[84:87]
    ds_read_b64_tr_b16 a[18:19], v230 offset:34624
    v_mfma_f32_16x16x32_bf16 v[84:87], a[28:31], a[148:151], v[84:87]
    v_mfma_f32_16x16x32_bf16 v[140:143], a[24:27], a[136:139], v[140:143]
    ds_read_b64_tr_b16 a[20:21], v230 offset:49216
    v_mfma_f32_16x16x32_bf16 v[140:143], a[28:31], a[152:155], v[140:143]
    buffer_load_dwordx4 v225, s[52:55], s8 offen offset:1024  lds
    v_mfma_f32_16x16x32_bf16 v[196:199], a[24:27], a[140:143], v[196:199]
    ds_read_b64_tr_b16 a[22:23], v230 offset:51008
    v_mfma_f32_16x16x32_bf16 v[196:199], a[28:31], a[156:159], v[196:199]
    s_waitcnt lgkmcnt(8)
    v_mfma_f32_16x16x32_bf16 v[4:7], a[0:3], a[128:131], v[4:7]
    ds_read_b64_tr_b16 a[24:25], v230 offset:41024
    v_mfma_f32_16x16x32_bf16 v[4:7], a[4:7], a[144:147], v[4:7]
    v_mfma_f32_16x16x32_bf16 v[60:63], a[0:3], a[132:135], v[60:63]
    ds_read_b64_tr_b16 a[26:27], v230 offset:42816
    v_mfma_f32_16x16x32_bf16 v[60:63], a[4:7], a[148:151], v[60:63]
    buffer_load_dwordx4 v226, s[52:55], s8 offen offset:2048  lds
    v_mfma_f32_16x16x32_bf16 v[116:119], a[0:3], a[136:139], v[116:119]
    ds_read_b64_tr_b16 a[28:29], v230 offset:57408
    v_mfma_f32_16x16x32_bf16 v[116:119], a[4:7], a[152:155], v[116:119]
    v_mfma_f32_16x16x32_bf16 v[172:175], a[0:3], a[140:143], v[172:175]
    ds_read_b64_tr_b16 a[30:31], v230 offset:59200
    v_mfma_f32_16x16x32_bf16 v[172:175], a[4:7], a[156:159], v[172:175]
    s_waitcnt lgkmcnt(8)
    v_mfma_f32_16x16x32_bf16 v[32:35], a[8:11], a[128:131], v[32:35]
    ds_read_b64_tr_b16 a[0:1], v230 offset:32864
    v_mfma_f32_16x16x32_bf16 v[32:35], a[12:15], a[144:147], v[32:35]
    buffer_load_dwordx4 v227, s[52:55], s8 offen offset:3072  lds
    s_add_u32 s8, s7, 2523136
    s_add_u32 m0, s6, 49152
    v_mfma_f32_16x16x32_bf16 v[88:91], a[8:11], a[132:135], v[88:91]
    ds_read_b64_tr_b16 a[2:3], v230 offset:34656
    v_mfma_f32_16x16x32_bf16 v[88:91], a[12:15], a[148:151], v[88:91]
    v_mfma_f32_16x16x32_bf16 v[144:147], a[8:11], a[136:139], v[144:147]
    ds_read_b64_tr_b16 a[4:5], v230 offset:49248
    v_mfma_f32_16x16x32_bf16 v[144:147], a[12:15], a[152:155], v[144:147]
    v_mfma_f32_16x16x32_bf16 v[200:203], a[8:11], a[140:143], v[200:203]
    ds_read_b64_tr_b16 a[6:7], v230 offset:51040
    v_mfma_f32_16x16x32_bf16 v[200:203], a[12:15], a[156:159], v[200:203]
    buffer_load_dwordx4 v224, s[52:55], s8 offen offset:0  lds
    s_waitcnt lgkmcnt(8)
    v_mfma_f32_16x16x32_bf16 v[8:11], a[16:19], a[128:131], v[8:11]
    ds_read_b64_tr_b16 a[8:9], v230 offset:41056
    v_mfma_f32_16x16x32_bf16 v[8:11], a[20:23], a[144:147], v[8:11]
    v_mfma_f32_16x16x32_bf16 v[64:67], a[16:19], a[132:135], v[64:67]
    ds_read_b64_tr_b16 a[10:11], v230 offset:42848
    v_mfma_f32_16x16x32_bf16 v[64:67], a[20:23], a[148:151], v[64:67]
    v_mfma_f32_16x16x32_bf16 v[120:123], a[16:19], a[136:139], v[120:123]
    ds_read_b64_tr_b16 a[12:13], v230 offset:57440
    v_mfma_f32_16x16x32_bf16 v[120:123], a[20:23], a[152:155], v[120:123]
    buffer_load_dwordx4 v225, s[52:55], s8 offen offset:1024  lds
    v_mfma_f32_16x16x32_bf16 v[176:179], a[16:19], a[140:143], v[176:179]
    ds_read_b64_tr_b16 a[14:15], v230 offset:59232
    v_mfma_f32_16x16x32_bf16 v[176:179], a[20:23], a[156:159], v[176:179]
    s_waitcnt lgkmcnt(8)
    v_mfma_f32_16x16x32_bf16 v[36:39], a[24:27], a[128:131], v[36:39]
    ds_read_b64_tr_b16 a[16:17], v230 offset:32896
    v_mfma_f32_16x16x32_bf16 v[36:39], a[28:31], a[144:147], v[36:39]
    v_mfma_f32_16x16x32_bf16 v[92:95], a[24:27], a[132:135], v[92:95]
    ds_read_b64_tr_b16 a[18:19], v230 offset:34688
    v_mfma_f32_16x16x32_bf16 v[92:95], a[28:31], a[148:151], v[92:95]
    buffer_load_dwordx4 v226, s[52:55], s8 offen offset:2048  lds
    v_mfma_f32_16x16x32_bf16 v[148:151], a[24:27], a[136:139], v[148:151]
    ds_read_b64_tr_b16 a[20:21], v230 offset:49280
    v_mfma_f32_16x16x32_bf16 v[148:151], a[28:31], a[152:155], v[148:151]
    v_mfma_f32_16x16x32_bf16 v[204:207], a[24:27], a[140:143], v[204:207]
    ds_read_b64_tr_b16 a[22:23], v230 offset:51072
    v_mfma_f32_16x16x32_bf16 v[204:207], a[28:31], a[156:159], v[204:207]
    s_waitcnt lgkmcnt(8)
    v_mfma_f32_16x16x32_bf16 v[12:15], a[0:3], a[128:131], v[12:15]
    ds_read_b64_tr_b16 a[24:25], v230 offset:41088
    v_mfma_f32_16x16x32_bf16 v[12:15], a[4:7], a[144:147], v[12:15]
    buffer_load_dwordx4 v227, s[52:55], s8 offen offset:3072  lds
    s_mov_b32 s16, 4128768
    v_mfma_f32_16x16x32_bf16 v[68:71], a[0:3], a[132:135], v[68:71]
    ds_read_b64_tr_b16 a[26:27], v230 offset:42880
    v_mfma_f32_16x16x32_bf16 v[68:71], a[4:7], a[148:151], v[68:71]
    v_mfma_f32_16x16x32_bf16 v[124:127], a[0:3], a[136:139], v[124:127]
    ds_read_b64_tr_b16 a[28:29], v230 offset:57472
    v_mfma_f32_16x16x32_bf16 v[124:127], a[4:7], a[152:155], v[124:127]
    v_mfma_f32_16x16x32_bf16 v[180:183], a[0:3], a[140:143], v[180:183]
    ds_read_b64_tr_b16 a[30:31], v230 offset:59264
    v_mfma_f32_16x16x32_bf16 v[180:183], a[4:7], a[156:159], v[180:183]
    buffer_load_dword a255, v232, s[52:55], s16 offen
    s_mov_b32 s16, 0
    s_waitcnt lgkmcnt(8)
    v_mfma_f32_16x16x32_bf16 v[40:43], a[8:11], a[128:131], v[40:43]
    ds_read_b64_tr_b16 a[0:1], v230 offset:32928
    v_mfma_f32_16x16x32_bf16 v[40:43], a[12:15], a[144:147], v[40:43]
    v_mfma_f32_16x16x32_bf16 v[96:99], a[8:11], a[132:135], v[96:99]
    ds_read_b64_tr_b16 a[2:3], v230 offset:34720
    v_mfma_f32_16x16x32_bf16 v[96:99], a[12:15], a[148:151], v[96:99]
    v_mfma_f32_16x16x32_bf16 v[152:155], a[8:11], a[136:139], v[152:155]
    ds_read_b64_tr_b16 a[4:5], v230 offset:49312
    v_mfma_f32_16x16x32_bf16 v[152:155], a[12:15], a[152:155], v[152:155]
    buffer_store_dwordx4 v[236:239], v233, s[40:43], s16 offen sc1
    s_mov_b32 s9, 1310720
    v_mfma_f32_16x16x32_bf16 v[208:211], a[8:11], a[140:143], v[208:211]
    ds_read_b64_tr_b16 a[6:7], v230 offset:51104
    v_mfma_f32_16x16x32_bf16 v[208:211], a[12:15], a[156:159], v[208:211]
    s_waitcnt lgkmcnt(8)
    v_mfma_f32_16x16x32_bf16 v[16:19], a[16:19], a[128:131], v[16:19]
    ds_read_b64_tr_b16 a[8:9], v230 offset:41120
    v_mfma_f32_16x16x32_bf16 v[16:19], a[20:23], a[144:147], v[16:19]
    v_mfma_f32_16x16x32_bf16 v[72:75], a[16:19], a[132:135], v[72:75]
    ds_read_b64_tr_b16 a[10:11], v230 offset:42912
    v_mfma_f32_16x16x32_bf16 v[72:75], a[20:23], a[148:151], v[72:75]
    buffer_load_dwordx4 a[64:67], v228, s[44:47], s9 offen offset:0 sc1
    v_mfma_f32_16x16x32_bf16 v[128:131], a[16:19], a[136:139], v[128:131]
    ds_read_b64_tr_b16 a[12:13], v230 offset:57504
    v_mfma_f32_16x16x32_bf16 v[128:131], a[20:23], a[152:155], v[128:131]
    v_mfma_f32_16x16x32_bf16 v[184:187], a[16:19], a[140:143], v[184:187]
    ds_read_b64_tr_b16 a[14:15], v230 offset:59296
    v_mfma_f32_16x16x32_bf16 v[184:187], a[20:23], a[156:159], v[184:187]
    s_waitcnt lgkmcnt(8)
    v_mfma_f32_16x16x32_bf16 v[44:47], a[24:27], a[128:131], v[44:47]
    ds_read_b64_tr_b16 a[16:17], v230 offset:32960
    v_mfma_f32_16x16x32_bf16 v[44:47], a[28:31], a[144:147], v[44:47]
    buffer_load_dwordx4 a[68:71], v228, s[44:47], s9 offen offset:1024 sc1
    v_mfma_f32_16x16x32_bf16 v[100:103], a[24:27], a[132:135], v[100:103]
    ds_read_b64_tr_b16 a[18:19], v230 offset:34752
    v_mfma_f32_16x16x32_bf16 v[100:103], a[28:31], a[148:151], v[100:103]
    v_mfma_f32_16x16x32_bf16 v[156:159], a[24:27], a[136:139], v[156:159]
    ds_read_b64_tr_b16 a[20:21], v230 offset:49344
    v_mfma_f32_16x16x32_bf16 v[156:159], a[28:31], a[152:155], v[156:159]
    v_mfma_f32_16x16x32_bf16 v[212:215], a[24:27], a[140:143], v[212:215]
    ds_read_b64_tr_b16 a[22:23], v230 offset:51136
    v_mfma_f32_16x16x32_bf16 v[212:215], a[28:31], a[156:159], v[212:215]
    buffer_load_dwordx4 a[72:75], v228, s[44:47], s9 offen offset:2048 sc1
    s_waitcnt lgkmcnt(8)
    v_mfma_f32_16x16x32_bf16 v[20:23], a[0:3], a[128:131], v[20:23]
    ds_read_b64_tr_b16 a[24:25], v230 offset:41152
    v_mfma_f32_16x16x32_bf16 v[20:23], a[4:7], a[144:147], v[20:23]
    v_mfma_f32_16x16x32_bf16 v[76:79], a[0:3], a[132:135], v[76:79]
    ds_read_b64_tr_b16 a[26:27], v230 offset:42944
    v_mfma_f32_16x16x32_bf16 v[76:79], a[4:7], a[148:151], v[76:79]
    v_mfma_f32_16x16x32_bf16 v[132:135], a[0:3], a[136:139], v[132:135]
    ds_read_b64_tr_b16 a[28:29], v230 offset:57536
    v_mfma_f32_16x16x32_bf16 v[132:135], a[4:7], a[152:155], v[132:135]
    buffer_load_dwordx4 a[76:79], v228, s[44:47], s9 offen offset:3072 sc1
    s_mov_b32 s9, 1441792
    v_mfma_f32_16x16x32_bf16 v[188:191], a[0:3], a[140:143], v[188:191]
    ds_read_b64_tr_b16 a[30:31], v230 offset:59328
    v_mfma_f32_16x16x32_bf16 v[188:191], a[4:7], a[156:159], v[188:191]
    s_waitcnt vmcnt(22) lgkmcnt(8)
    s_barrier
    v_mfma_f32_16x16x32_bf16 v[48:51], a[8:11], a[128:131], v[48:51]
    ds_read_b64_tr_b16 a[0:1], v229 offset:0
    v_mfma_f32_16x16x32_bf16 v[48:51], a[12:15], a[144:147], v[48:51]
    v_mfma_f32_16x16x32_bf16 v[104:107], a[8:11], a[132:135], v[104:107]
    ds_read_b64_tr_b16 a[2:3], v229 offset:1792
    v_mfma_f32_16x16x32_bf16 v[104:107], a[12:15], a[148:151], v[104:107]
    buffer_load_dwordx4 a[80:83], v228, s[44:47], s9 offen offset:0 sc1
    v_mfma_f32_16x16x32_bf16 v[160:163], a[8:11], a[136:139], v[160:163]
    ds_read_b64_tr_b16 a[4:5], v229 offset:16384
    v_mfma_f32_16x16x32_bf16 v[160:163], a[12:15], a[152:155], v[160:163]
    v_mfma_f32_16x16x32_bf16 v[216:219], a[8:11], a[140:143], v[216:219]
    ds_read_b64_tr_b16 a[6:7], v229 offset:18176
    v_mfma_f32_16x16x32_bf16 v[216:219], a[12:15], a[156:159], v[216:219]
    s_waitcnt lgkmcnt(8)
    v_mfma_f32_16x16x32_bf16 v[24:27], a[16:19], a[128:131], v[24:27]
    ds_read_b64_tr_b16 a[8:9], v229 offset:8192
    v_mfma_f32_16x16x32_bf16 v[24:27], a[20:23], a[144:147], v[24:27]
    buffer_load_dwordx4 a[84:87], v228, s[44:47], s9 offen offset:1024 sc1
    v_mfma_f32_16x16x32_bf16 v[80:83], a[16:19], a[132:135], v[80:83]
    ds_read_b64_tr_b16 a[10:11], v229 offset:9984
    v_mfma_f32_16x16x32_bf16 v[80:83], a[20:23], a[148:151], v[80:83]
    v_mfma_f32_16x16x32_bf16 v[136:139], a[16:19], a[136:139], v[136:139]
    ds_read_b64_tr_b16 a[12:13], v229 offset:24576
    v_mfma_f32_16x16x32_bf16 v[136:139], a[20:23], a[152:155], v[136:139]
    v_mfma_f32_16x16x32_bf16 v[192:195], a[16:19], a[140:143], v[192:195]
    ds_read_b64_tr_b16 a[14:15], v229 offset:26368
    v_mfma_f32_16x16x32_bf16 v[192:195], a[20:23], a[156:159], v[192:195]
    buffer_load_dwordx4 a[88:91], v228, s[44:47], s9 offen offset:2048 sc1
    s_waitcnt lgkmcnt(8)
    v_mfma_f32_16x16x32_bf16 v[52:55], a[24:27], a[128:131], v[52:55]
    ds_read_b64_tr_b16 a[16:17], v229 offset:32
    v_mfma_f32_16x16x32_bf16 v[52:55], a[28:31], a[144:147], v[52:55]
    v_mfma_f32_16x16x32_bf16 v[108:111], a[24:27], a[132:135], v[108:111]
    ds_read_b64_tr_b16 a[18:19], v229 offset:1824
    v_mfma_f32_16x16x32_bf16 v[108:111], a[28:31], a[148:151], v[108:111]
    v_mfma_f32_16x16x32_bf16 v[164:167], a[24:27], a[136:139], v[164:167]
    ds_read_b64_tr_b16 a[20:21], v229 offset:16416
    v_mfma_f32_16x16x32_bf16 v[164:167], a[28:31], a[152:155], v[164:167]
    buffer_load_dwordx4 a[92:95], v228, s[44:47], s9 offen offset:3072 sc1
    s_add_u32 s8, s7, 2752512
    s_add_u32 m0, s6, 65536
    v_mfma_f32_16x16x32_bf16 v[220:223], a[24:27], a[140:143], v[220:223]
    ds_read_b64_tr_b16 a[22:23], v229 offset:18208
    v_mfma_f32_16x16x32_bf16 v[220:223], a[28:31], a[156:159], v[220:223]
    s_waitcnt vmcnt(18) lgkmcnt(8)
    v_mfma_f32_16x16x32_bf16 v[0:3], a[0:3], a[32:35], v[0:3]
    ds_read_b64_tr_b16 a[24:25], v229 offset:8224
    v_mfma_f32_16x16x32_bf16 v[0:3], a[4:7], a[48:51], v[0:3]
    v_mfma_f32_16x16x32_bf16 v[56:59], a[0:3], a[36:39], v[56:59]
    ds_read_b64_tr_b16 a[26:27], v229 offset:10016
    v_mfma_f32_16x16x32_bf16 v[56:59], a[4:7], a[52:55], v[56:59]
    buffer_load_dwordx4 v224, s[52:55], s8 offen offset:0  lds
    v_mfma_f32_16x16x32_bf16 v[112:115], a[0:3], a[40:43], v[112:115]
    ds_read_b64_tr_b16 a[28:29], v229 offset:24608
    v_mfma_f32_16x16x32_bf16 v[112:115], a[4:7], a[56:59], v[112:115]
    v_mfma_f32_16x16x32_bf16 v[168:171], a[0:3], a[44:47], v[168:171]
    ds_read_b64_tr_b16 a[30:31], v229 offset:26400
    v_mfma_f32_16x16x32_bf16 v[168:171], a[4:7], a[60:63], v[168:171]
    s_waitcnt lgkmcnt(8)
    v_mfma_f32_16x16x32_bf16 v[28:31], a[8:11], a[32:35], v[28:31]
    ds_read_b64_tr_b16 a[0:1], v229 offset:64
    v_mfma_f32_16x16x32_bf16 v[28:31], a[12:15], a[48:51], v[28:31]
    buffer_load_dwordx4 v225, s[52:55], s8 offen offset:1024  lds
    v_mfma_f32_16x16x32_bf16 v[84:87], a[8:11], a[36:39], v[84:87]
    ds_read_b64_tr_b16 a[2:3], v229 offset:1856
    v_mfma_f32_16x16x32_bf16 v[84:87], a[12:15], a[52:55], v[84:87]
    v_mfma_f32_16x16x32_bf16 v[140:143], a[8:11], a[40:43], v[140:143]
    ds_read_b64_tr_b16 a[4:5], v229 offset:16448
    v_mfma_f32_16x16x32_bf16 v[140:143], a[12:15], a[56:59], v[140:143]
    v_mfma_f32_16x16x32_bf16 v[196:199], a[8:11], a[44:47], v[196:199]
    ds_read_b64_tr_b16 a[6:7], v229 offset:18240
    v_mfma_f32_16x16x32_bf16 v[196:199], a[12:15], a[60:63], v[196:199]
    buffer_load_dwordx4 v226, s[52:55], s8 offen offset:2048  lds
    s_waitcnt lgkmcnt(8)
    v_mfma_f32_16x16x32_bf16 v[4:7], a[16:19], a[32:35], v[4:7]
    ds_read_b64_tr_b16 a[8:9], v229 offset:8256
    v_mfma_f32_16x16x32_bf16 v[4:7], a[20:23], a[48:51], v[4:7]
    v_mfma_f32_16x16x32_bf16 v[60:63], a[16:19], a[36:39], v[60:63]
    ds_read_b64_tr_b16 a[10:11], v229 offset:10048
    v_mfma_f32_16x16x32_bf16 v[60:63], a[20:23], a[52:55], v[60:63]
    v_mfma_f32_16x16x32_bf16 v[116:119], a[16:19], a[40:43], v[116:119]
    ds_read_b64_tr_b16 a[12:13], v229 offset:24640
    v_mfma_f32_16x16x32_bf16 v[116:119], a[20:23], a[56:59], v[116:119]
    buffer_load_dwordx4 v227, s[52:55], s8 offen offset:3072  lds
    s_add_u32 s8, s7, 2981888
    s_add_u32 m0, s6, 81920
    v_mfma_f32_16x16x32_bf16 v[172:175], a[16:19], a[44:47], v[172:175]
    ds_read_b64_tr_b16 a[14:15], v229 offset:26432
    v_mfma_f32_16x16x32_bf16 v[172:175], a[20:23], a[60:63], v[172:175]
    s_waitcnt lgkmcnt(8)
    v_mfma_f32_16x16x32_bf16 v[32:35], a[24:27], a[32:35], v[32:35]
    ds_read_b64_tr_b16 a[16:17], v229 offset:96
    v_mfma_f32_16x16x32_bf16 v[32:35], a[28:31], a[48:51], v[32:35]
    v_mfma_f32_16x16x32_bf16 v[88:91], a[24:27], a[36:39], v[88:91]
    ds_read_b64_tr_b16 a[18:19], v229 offset:1888
    v_mfma_f32_16x16x32_bf16 v[88:91], a[28:31], a[52:55], v[88:91]
    buffer_load_dwordx4 v224, s[52:55], s8 offen offset:0  lds
    v_mfma_f32_16x16x32_bf16 v[144:147], a[24:27], a[40:43], v[144:147]
    ds_read_b64_tr_b16 a[20:21], v229 offset:16480
    v_mfma_f32_16x16x32_bf16 v[144:147], a[28:31], a[56:59], v[144:147]
    v_mfma_f32_16x16x32_bf16 v[200:203], a[24:27], a[44:47], v[200:203]
    ds_read_b64_tr_b16 a[22:23], v229 offset:18272
    v_mfma_f32_16x16x32_bf16 v[200:203], a[28:31], a[60:63], v[200:203]
    s_waitcnt lgkmcnt(8)
    v_mfma_f32_16x16x32_bf16 v[8:11], a[0:3], a[32:35], v[8:11]
    ds_read_b64_tr_b16 a[24:25], v229 offset:8288
    v_mfma_f32_16x16x32_bf16 v[8:11], a[4:7], a[48:51], v[8:11]
    buffer_load_dwordx4 v225, s[52:55], s8 offen offset:1024  lds
    v_mfma_f32_16x16x32_bf16 v[64:67], a[0:3], a[36:39], v[64:67]
    ds_read_b64_tr_b16 a[26:27], v229 offset:10080
    v_mfma_f32_16x16x32_bf16 v[64:67], a[4:7], a[52:55], v[64:67]
    v_mfma_f32_16x16x32_bf16 v[120:123], a[0:3], a[40:43], v[120:123]
    ds_read_b64_tr_b16 a[28:29], v229 offset:24672
    v_mfma_f32_16x16x32_bf16 v[120:123], a[4:7], a[56:59], v[120:123]
    v_mfma_f32_16x16x32_bf16 v[176:179], a[0:3], a[44:47], v[176:179]
    ds_read_b64_tr_b16 a[30:31], v229 offset:26464
    v_mfma_f32_16x16x32_bf16 v[176:179], a[4:7], a[60:63], v[176:179]
    buffer_load_dwordx4 v226, s[52:55], s8 offen offset:2048  lds
    s_waitcnt lgkmcnt(8)
    v_mfma_f32_16x16x32_bf16 v[36:39], a[8:11], a[32:35], v[36:39]
    ds_read_b64_tr_b16 a[0:1], v229 offset:128
    v_mfma_f32_16x16x32_bf16 v[36:39], a[12:15], a[48:51], v[36:39]
    v_mfma_f32_16x16x32_bf16 v[92:95], a[8:11], a[36:39], v[92:95]
    ds_read_b64_tr_b16 a[2:3], v229 offset:1920
    v_mfma_f32_16x16x32_bf16 v[92:95], a[12:15], a[52:55], v[92:95]
    v_mfma_f32_16x16x32_bf16 v[148:151], a[8:11], a[40:43], v[148:151]
    ds_read_b64_tr_b16 a[4:5], v229 offset:16512
    v_mfma_f32_16x16x32_bf16 v[148:151], a[12:15], a[56:59], v[148:151]
    buffer_load_dwordx4 v227, s[52:55], s8 offen offset:3072  lds
    s_mov_b32 s16, 4587520
    v_mfma_f32_16x16x32_bf16 v[204:207], a[8:11], a[44:47], v[204:207]
    ds_read_b64_tr_b16 a[6:7], v229 offset:18304
    v_mfma_f32_16x16x32_bf16 v[204:207], a[12:15], a[60:63], v[204:207]
    s_waitcnt lgkmcnt(8)
    v_mfma_f32_16x16x32_bf16 v[12:15], a[16:19], a[32:35], v[12:15]
    ds_read_b64_tr_b16 a[8:9], v229 offset:8320
    v_mfma_f32_16x16x32_bf16 v[12:15], a[20:23], a[48:51], v[12:15]
    v_mfma_f32_16x16x32_bf16 v[68:71], a[16:19], a[36:39], v[68:71]
    ds_read_b64_tr_b16 a[10:11], v229 offset:10112
    v_mfma_f32_16x16x32_bf16 v[68:71], a[20:23], a[52:55], v[68:71]
    buffer_load_dword a255, v232, s[52:55], s16 offen
    s_mov_b32 s9, 1572864
    v_mfma_f32_16x16x32_bf16 v[124:127], a[16:19], a[40:43], v[124:127]
    ds_read_b64_tr_b16 a[12:13], v229 offset:24704
    v_mfma_f32_16x16x32_bf16 v[124:127], a[20:23], a[56:59], v[124:127]
    v_mfma_f32_16x16x32_bf16 v[180:183], a[16:19], a[44:47], v[180:183]
    ds_read_b64_tr_b16 a[14:15], v229 offset:26496
    v_mfma_f32_16x16x32_bf16 v[180:183], a[20:23], a[60:63], v[180:183]
    s_waitcnt lgkmcnt(8)
    v_mfma_f32_16x16x32_bf16 v[40:43], a[24:27], a[32:35], v[40:43]
    ds_read_b64_tr_b16 a[16:17], v229 offset:160
    v_mfma_f32_16x16x32_bf16 v[40:43], a[28:31], a[48:51], v[40:43]
    buffer_load_dwordx4 a[96:99], v228, s[44:47], s9 offen offset:0 sc1
    v_mfma_f32_16x16x32_bf16 v[96:99], a[24:27], a[36:39], v[96:99]
    ds_read_b64_tr_b16 a[18:19], v229 offset:1952
    v_mfma_f32_16x16x32_bf16 v[96:99], a[28:31], a[52:55], v[96:99]
    v_mfma_f32_16x16x32_bf16 v[152:155], a[24:27], a[40:43], v[152:155]
    ds_read_b64_tr_b16 a[20:21], v229 offset:16544
    v_mfma_f32_16x16x32_bf16 v[152:155], a[28:31], a[56:59], v[152:155]
    v_mfma_f32_16x16x32_bf16 v[208:211], a[24:27], a[44:47], v[208:211]
    ds_read_b64_tr_b16 a[22:23], v229 offset:18336
    v_mfma_f32_16x16x32_bf16 v[208:211], a[28:31], a[60:63], v[208:211]
    buffer_load_dwordx4 a[100:103], v228, s[44:47], s9 offen offset:1024 sc1
    s_waitcnt lgkmcnt(8)
    v_mfma_f32_16x16x32_bf16 v[16:19], a[0:3], a[32:35], v[16:19]
    ds_read_b64_tr_b16 a[24:25], v229 offset:8352
    v_mfma_f32_16x16x32_bf16 v[16:19], a[4:7], a[48:51], v[16:19]
    v_mfma_f32_16x16x32_bf16 v[72:75], a[0:3], a[36:39], v[72:75]
    ds_read_b64_tr_b16 a[26:27], v229 offset:10144
    v_mfma_f32_16x16x32_bf16 v[72:75], a[4:7], a[52:55], v[72:75]
    v_mfma_f32_16x16x32_bf16 v[128:131], a[0:3], a[40:43], v[128:131]
    ds_read_b64_tr_b16 a[28:29], v229 offset:24736
    v_mfma_f32_16x16x32_bf16 v[128:131], a[4:7], a[56:59], v[128:131]
    buffer_load_dwordx4 a[104:107], v228, s[44:47], s9 offen offset:2048 sc1
    v_mfma_f32_16x16x32_bf16 v[184:187], a[0:3], a[44:47], v[184:187]
    ds_read_b64_tr_b16 a[30:31], v229 offset:26528
    v_mfma_f32_16x16x32_bf16 v[184:187], a[4:7], a[60:63], v[184:187]
    s_waitcnt lgkmcnt(8)
    v_mfma_f32_16x16x32_bf16 v[44:47], a[8:11], a[32:35], v[44:47]
    ds_read_b64_tr_b16 a[0:1], v229 offset:192
    v_mfma_f32_16x16x32_bf16 v[44:47], a[12:15], a[48:51], v[44:47]
    v_mfma_f32_16x16x32_bf16 v[100:103], a[8:11], a[36:39], v[100:103]
    ds_read_b64_tr_b16 a[2:3], v229 offset:1984
    v_mfma_f32_16x16x32_bf16 v[100:103], a[12:15], a[52:55], v[100:103]
    buffer_load_dwordx4 a[108:111], v228, s[44:47], s9 offen offset:3072 sc1
    s_mov_b32 s9, 1703936
    v_mfma_f32_16x16x32_bf16 v[156:159], a[8:11], a[40:43], v[156:159]
    ds_read_b64_tr_b16 a[4:5], v229 offset:16576
    v_mfma_f32_16x16x32_bf16 v[156:159], a[12:15], a[56:59], v[156:159]
    v_mfma_f32_16x16x32_bf16 v[212:215], a[8:11], a[44:47], v[212:215]
    ds_read_b64_tr_b16 a[6:7], v229 offset:18368
    v_mfma_f32_16x16x32_bf16 v[212:215], a[12:15], a[60:63], v[212:215]
    s_waitcnt lgkmcnt(8)
    v_mfma_f32_16x16x32_bf16 v[20:23], a[16:19], a[32:35], v[20:23]
    ds_read_b64_tr_b16 a[8:9], v229 offset:8384
    v_mfma_f32_16x16x32_bf16 v[20:23], a[20:23], a[48:51], v[20:23]
    buffer_load_dwordx4 a[112:115], v228, s[44:47], s9 offen offset:0 sc1
    v_mfma_f32_16x16x32_bf16 v[76:79], a[16:19], a[36:39], v[76:79]
    s_branch L_fused_kernel_pc5
L_fused_kernel_isl0_5:
    s_branch L_fused_kernel_isl0_9
L_fused_kernel_pc5:
    ds_read_b64_tr_b16 a[10:11], v229 offset:10176
    v_mfma_f32_16x16x32_bf16 v[76:79], a[20:23], a[52:55], v[76:79]
    v_mfma_f32_16x16x32_bf16 v[132:135], a[16:19], a[40:43], v[132:135]
    ds_read_b64_tr_b16 a[12:13], v229 offset:24768
    v_mfma_f32_16x16x32_bf16 v[132:135], a[20:23], a[56:59], v[132:135]
    v_mfma_f32_16x16x32_bf16 v[188:191], a[16:19], a[44:47], v[188:191]
    ds_read_b64_tr_b16 a[14:15], v229 offset:26560
    v_mfma_f32_16x16x32_bf16 v[188:191], a[20:23], a[60:63], v[188:191]
    buffer_load_dwordx4 a[116:119], v228, s[44:47], s9 offen offset:1024 sc1
    s_waitcnt vmcnt(25) lgkmcnt(8)
    s_barrier
    v_mfma_f32_16x16x32_bf16 v[48:51], a[24:27], a[32:35], v[48:51]
    ds_read_b64_tr_b16 a[16:17], v229 offset:32768
    v_mfma_f32_16x16x32_bf16 v[48:51], a[28:31], a[48:51], v[48:51]
    v_mfma_f32_16x16x32_bf16 v[104:107], a[24:27], a[36:39], v[104:107]
    ds_read_b64_tr_b16 a[18:19], v229 offset:34560
    v_mfma_f32_16x16x32_bf16 v[104:107], a[28:31], a[52:55], v[104:107]
    v_mfma_f32_16x16x32_bf16 v[160:163], a[24:27], a[40:43], v[160:163]
    ds_read_b64_tr_b16 a[20:21], v229 offset:49152
    v_mfma_f32_16x16x32_bf16 v[160:163], a[28:31], a[56:59], v[160:163]
    buffer_load_dwordx4 a[120:123], v228, s[44:47], s9 offen offset:2048 sc1
    v_mfma_f32_16x16x32_bf16 v[216:219], a[24:27], a[44:47], v[216:219]
    ds_read_b64_tr_b16 a[22:23], v229 offset:50944
    v_mfma_f32_16x16x32_bf16 v[216:219], a[28:31], a[60:63], v[216:219]
    s_waitcnt lgkmcnt(8)
    v_mfma_f32_16x16x32_bf16 v[24:27], a[0:3], a[32:35], v[24:27]
    ds_read_b64_tr_b16 a[24:25], v229 offset:40960
    v_mfma_f32_16x16x32_bf16 v[24:27], a[4:7], a[48:51], v[24:27]
    v_mfma_f32_16x16x32_bf16 v[80:83], a[0:3], a[36:39], v[80:83]
    ds_read_b64_tr_b16 a[26:27], v229 offset:42752
    v_mfma_f32_16x16x32_bf16 v[80:83], a[4:7], a[52:55], v[80:83]
    buffer_load_dwordx4 a[124:127], v228, s[44:47], s9 offen offset:3072 sc1
    s_add_u32 s8, s7, 3211264
    s_add_u32 m0, s6, 98304
    v_mfma_f32_16x16x32_bf16 v[136:139], a[0:3], a[40:43], v[136:139]
    ds_read_b64_tr_b16 a[28:29], v229 offset:57344
    v_mfma_f32_16x16x32_bf16 v[136:139], a[4:7], a[56:59], v[136:139]
    v_mfma_f32_16x16x32_bf16 v[192:195], a[0:3], a[44:47], v[192:195]
    ds_read_b64_tr_b16 a[30:31], v229 offset:59136
    v_mfma_f32_16x16x32_bf16 v[192:195], a[4:7], a[60:63], v[192:195]
    s_waitcnt lgkmcnt(8)
    v_mfma_f32_16x16x32_bf16 v[52:55], a[8:11], a[32:35], v[52:55]
    ds_read_b64_tr_b16 a[0:1], v229 offset:32800
    v_mfma_f32_16x16x32_bf16 v[52:55], a[12:15], a[48:51], v[52:55]
    buffer_load_dwordx4 v224, s[52:55], s8 offen offset:0  lds
    v_mfma_f32_16x16x32_bf16 v[108:111], a[8:11], a[36:39], v[108:111]
    ds_read_b64_tr_b16 a[2:3], v229 offset:34592
    v_mfma_f32_16x16x32_bf16 v[108:111], a[12:15], a[52:55], v[108:111]
    v_mfma_f32_16x16x32_bf16 v[164:167], a[8:11], a[40:43], v[164:167]
    ds_read_b64_tr_b16 a[4:5], v229 offset:49184
    v_mfma_f32_16x16x32_bf16 v[164:167], a[12:15], a[56:59], v[164:167]
    v_mfma_f32_16x16x32_bf16 v[220:223], a[8:11], a[44:47], v[220:223]
    ds_read_b64_tr_b16 a[6:7], v229 offset:50976
    v_mfma_f32_16x16x32_bf16 v[220:223], a[12:15], a[60:63], v[220:223]
    buffer_load_dwordx4 v225, s[52:55], s8 offen offset:1024  lds
    s_waitcnt vmcnt(19) lgkmcnt(8)
    v_mfma_f32_16x16x32_bf16 v[0:3], a[16:19], a[64:67], v[0:3]
    ds_read_b64_tr_b16 a[8:9], v229 offset:40992
    v_mfma_f32_16x16x32_bf16 v[0:3], a[20:23], a[80:83], v[0:3]
    v_mfma_f32_16x16x32_bf16 v[56:59], a[16:19], a[68:71], v[56:59]
    ds_read_b64_tr_b16 a[10:11], v229 offset:42784
    v_mfma_f32_16x16x32_bf16 v[56:59], a[20:23], a[84:87], v[56:59]
    v_mfma_f32_16x16x32_bf16 v[112:115], a[16:19], a[72:75], v[112:115]
    ds_read_b64_tr_b16 a[12:13], v229 offset:57376
    v_mfma_f32_16x16x32_bf16 v[112:115], a[20:23], a[88:91], v[112:115]
    buffer_load_dwordx4 v226, s[52:55], s8 offen offset:2048  lds
    v_mfma_f32_16x16x32_bf16 v[168:171], a[16:19], a[76:79], v[168:171]
    ds_read_b64_tr_b16 a[14:15], v229 offset:59168
    v_mfma_f32_16x16x32_bf16 v[168:171], a[20:23], a[92:95], v[168:171]
    s_waitcnt lgkmcnt(8)
    v_mfma_f32_16x16x32_bf16 v[28:31], a[24:27], a[64:67], v[28:31]
    ds_read_b64_tr_b16 a[16:17], v229 offset:32832
    v_mfma_f32_16x16x32_bf16 v[28:31], a[28:31], a[80:83], v[28:31]
    v_mfma_f32_16x16x32_bf16 v[84:87], a[24:27], a[68:71], v[84:87]
    ds_read_b64_tr_b16 a[18:19], v229 offset:34624
    v_mfma_f32_16x16x32_bf16 v[84:87], a[28:31], a[84:87], v[84:87]
    buffer_load_dwordx4 v227, s[52:55], s8 offen offset:3072  lds
    s_add_u32 s8, s7, 3440640
    s_add_u32 m0, s6, 114688
    v_mfma_f32_16x16x32_bf16 v[140:143], a[24:27], a[72:75], v[140:143]
    ds_read_b64_tr_b16 a[20:21], v229 offset:49216
    v_mfma_f32_16x16x32_bf16 v[140:143], a[28:31], a[88:91], v[140:143]
    v_mfma_f32_16x16x32_bf16 v[196:199], a[24:27], a[76:79], v[196:199]
    ds_read_b64_tr_b16 a[22:23], v229 offset:51008
    v_mfma_f32_16x16x32_bf16 v[196:199], a[28:31], a[92:95], v[196:199]
    s_waitcnt lgkmcnt(8)
    v_mfma_f32_16x16x32_bf16 v[4:7], a[0:3], a[64:67], v[4:7]
    ds_read_b64_tr_b16 a[24:25], v229 offset:41024
    v_mfma_f32_16x16x32_bf16 v[4:7], a[4:7], a[80:83], v[4:7]
    buffer_load_dwordx4 v224, s[52:55], s8 offen offset:0  lds
    v_mfma_f32_16x16x32_bf16 v[60:63], a[0:3], a[68:71], v[60:63]
    ds_read_b64_tr_b16 a[26:27], v229 offset:42816
    v_mfma_f32_16x16x32_bf16 v[60:63], a[4:7], a[84:87], v[60:63]
    v_mfma_f32_16x16x32_bf16 v[116:119], a[0:3], a[72:75], v[116:119]
    ds_read_b64_tr_b16 a[28:29], v229 offset:57408
    v_mfma_f32_16x16x32_bf16 v[116:119], a[4:7], a[88:91], v[116:119]
    v_mfma_f32_16x16x32_bf16 v[172:175], a[0:3], a[76:79], v[172:175]
    ds_read_b64_tr_b16 a[30:31], v229 offset:59200
    v_mfma_f32_16x16x32_bf16 v[172:175], a[4:7], a[92:95], v[172:175]
    buffer_load_dwordx4 v225, s[52:55], s8 offen offset:1024  lds
    s_waitcnt lgkmcnt(8)
    v_mfma_f32_16x16x32_bf16 v[32:35], a[8:11], a[64:67], v[32:35]
    ds_read_b64_tr_b16 a[0:1], v229 offset:32864
    v_mfma_f32_16x16x32_bf16 v[32:35], a[12:15], a[80:83], v[32:35]
    v_mfma_f32_16x16x32_bf16 v[88:91], a[8:11], a[68:71], v[88:91]
    ds_read_b64_tr_b16 a[2:3], v229 offset:34656
    v_mfma_f32_16x16x32_bf16 v[88:91], a[12:15], a[84:87], v[88:91]
    v_mfma_f32_16x16x32_bf16 v[144:147], a[8:11], a[72:75], v[144:147]
    ds_read_b64_tr_b16 a[4:5], v229 offset:49248
    v_mfma_f32_16x16x32_bf16 v[144:147], a[12:15], a[88:91], v[144:147]
    buffer_load_dwordx4 v226, s[52:55], s8 offen offset:2048  lds
    v_mfma_f32_16x16x32_bf16 v[200:203], a[8:11], a[76:79], v[200:203]
    ds_read_b64_tr_b16 a[6:7], v229 offset:51040
    v_mfma_f32_16x16x32_bf16 v[200:203], a[12:15], a[92:95], v[200:203]
    s_waitcnt lgkmcnt(8)
    v_mfma_f32_16x16x32_bf16 v[8:11], a[16:19], a[64:67], v[8:11]
    ds_read_b64_tr_b16 a[8:9], v229 offset:41056
    v_mfma_f32_16x16x32_bf16 v[8:11], a[20:23], a[80:83], v[8:11]
    v_mfma_f32_16x16x32_bf16 v[64:67], a[16:19], a[68:71], v[64:67]
    ds_read_b64_tr_b16 a[10:11], v229 offset:42848
    v_mfma_f32_16x16x32_bf16 v[64:67], a[20:23], a[84:87], v[64:67]
    buffer_load_dwordx4 v227, s[52:55], s8 offen offset:3072  lds
    s_mov_b32 s16, 5046272
    v_mfma_f32_16x16x32_bf16 v[120:123], a[16:19], a[72:75], v[120:123]
    ds_read_b64_tr_b16 a[12:13], v229 offset:57440
    v_mfma_f32_16x16x32_bf16 v[120:123], a[20:23], a[88:91], v[120:123]
    v_mfma_f32_16x16x32_bf16 v[176:179], a[16:19], a[76:79], v[176:179]
    ds_read_b64_tr_b16 a[14:15], v229 offset:59232
    v_mfma_f32_16x16x32_bf16 v[176:179], a[20:23], a[92:95], v[176:179]
    s_waitcnt lgkmcnt(8)
    v_mfma_f32_16x16x32_bf16 v[36:39], a[24:27], a[64:67], v[36:39]
    ds_read_b64_tr_b16 a[16:17], v229 offset:32896
    v_mfma_f32_16x16x32_bf16 v[36:39], a[28:31], a[80:83], v[36:39]
    buffer_load_dword a255, v232, s[52:55], s16 offen
    s_mov_b32 s16, 1024
    v_mfma_f32_16x16x32_bf16 v[92:95], a[24:27], a[68:71], v[92:95]
    ds_read_b64_tr_b16 a[18:19], v229 offset:34688
    v_mfma_f32_16x16x32_bf16 v[92:95], a[28:31], a[84:87], v[92:95]
    v_mfma_f32_16x16x32_bf16 v[148:151], a[24:27], a[72:75], v[148:151]
    ds_read_b64_tr_b16 a[20:21], v229 offset:49280
    v_mfma_f32_16x16x32_bf16 v[148:151], a[28:31], a[88:91], v[148:151]
    v_mfma_f32_16x16x32_bf16 v[204:207], a[24:27], a[76:79], v[204:207]
    ds_read_b64_tr_b16 a[22:23], v229 offset:51072
    v_mfma_f32_16x16x32_bf16 v[204:207], a[28:31], a[92:95], v[204:207]
    buffer_store_dwordx4 v[236:239], v233, s[40:43], s16 offen sc1
    s_mov_b32 s9, 1835008
    s_waitcnt lgkmcnt(8)
    v_mfma_f32_16x16x32_bf16 v[12:15], a[0:3], a[64:67], v[12:15]
    ds_read_b64_tr_b16 a[24:25], v229 offset:41088
    v_mfma_f32_16x16x32_bf16 v[12:15], a[4:7], a[80:83], v[12:15]
    v_mfma_f32_16x16x32_bf16 v[68:71], a[0:3], a[68:71], v[68:71]
    ds_read_b64_tr_b16 a[26:27], v229 offset:42880
    v_mfma_f32_16x16x32_bf16 v[68:71], a[4:7], a[84:87], v[68:71]
    v_mfma_f32_16x16x32_bf16 v[124:127], a[0:3], a[72:75], v[124:127]
    ds_read_b64_tr_b16 a[28:29], v229 offset:57472
    v_mfma_f32_16x16x32_bf16 v[124:127], a[4:7], a[88:91], v[124:127]
    buffer_load_dwordx4 a[128:131], v228, s[44:47], s9 offen offset:0 sc1
    v_mfma_f32_16x16x32_bf16 v[180:183], a[0:3], a[76:79], v[180:183]
    ds_read_b64_tr_b16 a[30:31], v229 offset:59264
    v_mfma_f32_16x16x32_bf16 v[180:183], a[4:7], a[92:95], v[180:183]
    s_waitcnt lgkmcnt(8)
    v_mfma_f32_16x16x32_bf16 v[40:43], a[8:11], a[64:67], v[40:43]
    ds_read_b64_tr_b16 a[0:1], v229 offset:32928
    v_mfma_f32_16x16x32_bf16 v[40:43], a[12:15], a[80:83], v[40:43]
    v_mfma_f32_16x16x32_bf16 v[96:99], a[8:11], a[68:71], v[96:99]
    ds_read_b64_tr_b16 a[2:3], v229 offset:34720
    v_mfma_f32_16x16x32_bf16 v[96:99], a[12:15], a[84:87], v[96:99]
    buffer_load_dwordx4 a[132:135], v228, s[44:47], s9 offen offset:1024 sc1
    v_mfma_f32_16x16x32_bf16 v[152:155], a[8:11], a[72:75], v[152:155]
    ds_read_b64_tr_b16 a[4:5], v229 offset:49312
    v_mfma_f32_16x16x32_bf16 v[152:155], a[12:15], a[88:91], v[152:155]
    v_mfma_f32_16x16x32_bf16 v[208:211], a[8:11], a[76:79], v[208:211]
    ds_read_b64_tr_b16 a[6:7], v229 offset:51104
    v_mfma_f32_16x16x32_bf16 v[208:211], a[12:15], a[92:95], v[208:211]
    s_waitcnt lgkmcnt(8)
    v_mfma_f32_16x16x32_bf16 v[16:19], a[16:19], a[64:67], v[16:19]
    ds_read_b64_tr_b16 a[8:9], v229 offset:41120
    v_mfma_f32_16x16x32_bf16 v[16:19], a[20:23], a[80:83], v[16:19]
    buffer_load_dwordx4 a[136:139], v228, s[44:47], s9 offen offset:2048 sc1
    v_mfma_f32_16x16x32_bf16 v[72:75], a[16:19], a[68:71], v[72:75]
    ds_read_b64_tr_b16 a[10:11], v229 offset:42912
    v_mfma_f32_16x16x32_bf16 v[72:75], a[20:23], a[84:87], v[72:75]
    v_mfma_f32_16x16x32_bf16 v[128:131], a[16:19], a[72:75], v[128:131]
    ds_read_b64_tr_b16 a[12:13], v229 offset:57504
    v_mfma_f32_16x16x32_bf16 v[128:131], a[20:23], a[88:91], v[128:131]
    v_mfma_f32_16x16x32_bf16 v[184:187], a[16:19], a[76:79], v[184:187]
    ds_read_b64_tr_b16 a[14:15], v229 offset:59296
    v_mfma_f32_16x16x32_bf16 v[184:187], a[20:23], a[92:95], v[184:187]
    buffer_load_dwordx4 a[140:143], v228, s[44:47], s9 offen offset:3072 sc1
    s_mov_b32 s9, 1966080
    s_waitcnt lgkmcnt(8)
    v_mfma_f32_16x16x32_bf16 v[44:47], a[24:27], a[64:67], v[44:47]
    ds_read_b64_tr_b16 a[16:17], v229 offset:32960
    v_mfma_f32_16x16x32_bf16 v[44:47], a[28:31], a[80:83], v[44:47]
    v_mfma_f32_16x16x32_bf16 v[100:103], a[24:27], a[68:71], v[100:103]
    ds_read_b64_tr_b16 a[18:19], v229 offset:34752
    v_mfma_f32_16x16x32_bf16 v[100:103], a[28:31], a[84:87], v[100:103]
    v_mfma_f32_16x16x32_bf16 v[156:159], a[24:27], a[72:75], v[156:159]
    ds_read_b64_tr_b16 a[20:21], v229 offset:49344
    v_mfma_f32_16x16x32_bf16 v[156:159], a[28:31], a[88:91], v[156:159]
    buffer_load_dwordx4 a[144:147], v228, s[44:47], s9 offen offset:0 sc1
    v_mfma_f32_16x16x32_bf16 v[212:215], a[24:27], a[76:79], v[212:215]
    ds_read_b64_tr_b16 a[22:23], v229 offset:51136
    v_mfma_f32_16x16x32_bf16 v[212:215], a[28:31], a[92:95], v[212:215]
    s_waitcnt lgkmcnt(8)
    v_mfma_f32_16x16x32_bf16 v[20:23], a[0:3], a[64:67], v[20:23]
    ds_read_b64_tr_b16 a[24:25], v229 offset:41152
    v_mfma_f32_16x16x32_bf16 v[20:23], a[4:7], a[80:83], v[20:23]
    v_mfma_f32_16x16x32_bf16 v[76:79], a[0:3], a[68:71], v[76:79]
    ds_read_b64_tr_b16 a[26:27], v229 offset:42944
    v_mfma_f32_16x16x32_bf16 v[76:79], a[4:7], a[84:87], v[76:79]
    buffer_load_dwordx4 a[148:151], v228, s[44:47], s9 offen offset:1024 sc1
    v_mfma_f32_16x16x32_bf16 v[132:135], a[0:3], a[72:75], v[132:135]
    ds_read_b64_tr_b16 a[28:29], v229 offset:57536
    v_mfma_f32_16x16x32_bf16 v[132:135], a[4:7], a[88:91], v[132:135]
    v_mfma_f32_16x16x32_bf16 v[188:191], a[0:3], a[76:79], v[188:191]
    ds_read_b64_tr_b16 a[30:31], v229 offset:59328
    v_mfma_f32_16x16x32_bf16 v[188:191], a[4:7], a[92:95], v[188:191]
    s_waitcnt vmcnt(25) lgkmcnt(8)
    s_barrier
    v_mfma_f32_16x16x32_bf16 v[48:51], a[8:11], a[64:67], v[48:51]
    ds_read_b64_tr_b16 a[0:1], v230 offset:0
    v_mfma_f32_16x16x32_bf16 v[48:51], a[12:15], a[80:83], v[48:51]
    buffer_load_dwordx4 a[152:155], v228, s[44:47], s9 offen offset:2048 sc1
    v_mfma_f32_16x16x32_bf16 v[104:107], a[8:11], a[68:71], v[104:107]
    ds_read_b64_tr_b16 a[2:3], v230 offset:1792
    v_mfma_f32_16x16x32_bf16 v[104:107], a[12:15], a[84:87], v[104:107]
    v_mfma_f32_16x16x32_bf16 v[160:163], a[8:11], a[72:75], v[160:163]
    ds_read_b64_tr_b16 a[4:5], v230 offset:16384
    v_mfma_f32_16x16x32_bf16 v[160:163], a[12:15], a[88:91], v[160:163]
    v_mfma_f32_16x16x32_bf16 v[216:219], a[8:11], a[76:79], v[216:219]
    ds_read_b64_tr_b16 a[6:7], v230 offset:18176
    v_mfma_f32_16x16x32_bf16 v[216:219], a[12:15], a[92:95], v[216:219]
    buffer_load_dwordx4 a[156:159], v228, s[44:47], s9 offen offset:3072 sc1
    s_add_u32 s8, s7, 3670016
    s_waitcnt lgkmcnt(8)
    v_mfma_f32_16x16x32_bf16 v[24:27], a[16:19], a[64:67], v[24:27]
    ds_read_b64_tr_b16 a[8:9], v230 offset:8192
    s_add_u32 m0, s6, 0
    v_mfma_f32_16x16x32_bf16 v[24:27], a[20:23], a[80:83], v[24:27]
    v_mfma_f32_16x16x32_bf16 v[80:83], a[16:19], a[68:71], v[80:83]
    ds_read_b64_tr_b16 a[10:11], v230 offset:9984
    v_mfma_f32_16x16x32_bf16 v[80:83], a[20:23], a[84:87], v[80:83]
    v_mfma_f32_16x16x32_bf16 v[136:139], a[16:19], a[72:75], v[136:139]
    ds_read_b64_tr_b16 a[12:13], v230 offset:24576
    v_mfma_f32_16x16x32_bf16 v[136:139], a[20:23], a[88:91], v[136:139]
    buffer_load_dwordx4 v224, s[52:55], s8 offen offset:0  lds
    v_mfma_f32_16x16x32_bf16 v[192:195], a[16:19], a[76:79], v[192:195]
    ds_read_b64_tr_b16 a[14:15], v230 offset:26368
    v_mfma_f32_16x16x32_bf16 v[192:195], a[20:23], a[92:95], v[192:195]
    s_waitcnt lgkmcnt(8)
    v_mfma_f32_16x16x32_bf16 v[52:55], a[24:27], a[64:67], v[52:55]
    ds_read_b64_tr_b16 a[16:17], v230 offset:32
    v_mfma_f32_16x16x32_bf16 v[52:55], a[28:31], a[80:83], v[52:55]
    v_mfma_f32_16x16x32_bf16 v[108:111], a[24:27], a[68:71], v[108:111]
    ds_read_b64_tr_b16 a[18:19], v230 offset:1824
    v_mfma_f32_16x16x32_bf16 v[108:111], a[28:31], a[84:87], v[108:111]
    buffer_load_dwordx4 v225, s[52:55], s8 offen offset:1024  lds
    v_mfma_f32_16x16x32_bf16 v[164:167], a[24:27], a[72:75], v[164:167]
    ds_read_b64_tr_b16 a[20:21], v230 offset:16416
    v_mfma_f32_16x16x32_bf16 v[164:167], a[28:31], a[88:91], v[164:167]
    v_mfma_f32_16x16x32_bf16 v[220:223], a[24:27], a[76:79], v[220:223]
    ds_read_b64_tr_b16 a[22:23], v230 offset:18208
    v_mfma_f32_16x16x32_bf16 v[220:223], a[28:31], a[92:95], v[220:223]
    s_waitcnt vmcnt(20) lgkmcnt(8)
    v_mfma_f32_16x16x32_bf16 v[0:3], a[0:3], a[96:99], v[0:3]
    ds_read_b64_tr_b16 a[24:25], v230 offset:8224
    v_mfma_f32_16x16x32_bf16 v[0:3], a[4:7], a[112:115], v[0:3]
    buffer_load_dwordx4 v226, s[52:55], s8 offen offset:2048  lds
    v_mfma_f32_16x16x32_bf16 v[56:59], a[0:3], a[100:103], v[56:59]
    ds_read_b64_tr_b16 a[26:27], v230 offset:10016
    v_mfma_f32_16x16x32_bf16 v[56:59], a[4:7], a[116:119], v[56:59]
    v_mfma_f32_16x16x32_bf16 v[112:115], a[0:3], a[104:107], v[112:115]
    ds_read_b64_tr_b16 a[28:29], v230 offset:24608
    v_mfma_f32_16x16x32_bf16 v[112:115], a[4:7], a[120:123], v[112:115]
    v_mfma_f32_16x16x32_bf16 v[168:171], a[0:3], a[108:111], v[168:171]
    ds_read_b64_tr_b16 a[30:31], v230 offset:26400
    v_mfma_f32_16x16x32_bf16 v[168:171], a[4:7], a[124:127], v[168:171]
    buffer_load_dwordx4 v227, s[52:55], s8 offen offset:3072  lds
    s_add_u32 s8, s7, 3899392
    s_waitcnt lgkmcnt(8)
    v_mfma_f32_16x16x32_bf16 v[28:31], a[8:11], a[96:99], v[28:31]
    ds_read_b64_tr_b16 a[0:1], v230 offset:64
    s_add_u32 m0, s6, 16384
    v_mfma_f32_16x16x32_bf16 v[28:31], a[12:15], a[112:115], v[28:31]
    v_mfma_f32_16x16x32_bf16 v[84:87], a[8:11], a[100:103], v[84:87]
    ds_read_b64_tr_b16 a[2:3], v230 offset:1856
    v_mfma_f32_16x16x32_bf16 v[84:87], a[12:15], a[116:119], v[84:87]
    v_mfma_f32_16x16x32_bf16 v[140:143], a[8:11], a[104:107], v[140:143]
    ds_read_b64_tr_b16 a[4:5], v230 offset:16448
    v_mfma_f32_16x16x32_bf16 v[140:143], a[12:15], a[120:123], v[140:143]
    buffer_load_dwordx4 v224, s[52:55], s8 offen offset:0  lds
    v_mfma_f32_16x16x32_bf16 v[196:199], a[8:11], a[108:111], v[196:199]
    ds_read_b64_tr_b16 a[6:7], v230 offset:18240
    v_mfma_f32_16x16x32_bf16 v[196:199], a[12:15], a[124:127], v[196:199]
    s_waitcnt lgkmcnt(8)
    v_mfma_f32_16x16x32_bf16 v[4:7], a[16:19], a[96:99], v[4:7]
    ds_read_b64_tr_b16 a[8:9], v230 offset:8256
    v_mfma_f32_16x16x32_bf16 v[4:7], a[20:23], a[112:115], v[4:7]
    v_mfma_f32_16x16x32_bf16 v[60:63], a[16:19], a[100:103], v[60:63]
    ds_read_b64_tr_b16 a[10:11], v230 offset:10048
    v_mfma_f32_16x16x32_bf16 v[60:63], a[20:23], a[116:119], v[60:63]
    buffer_load_dwordx4 v225, s[52:55], s8 offen offset:1024  lds
    v_mfma_f32_16x16x32_bf16 v[116:119], a[16:19], a[104:107], v[116:119]
    ds_read_b64_tr_b16 a[12:13], v230 offset:24640
    v_mfma_f32_16x16x32_bf16 v[116:119], a[20:23], a[120:123], v[116:119]
    v_mfma_f32_16x16x32_bf16 v[172:175], a[16:19], a[108:111], v[172:175]
    ds_read_b64_tr_b16 a[14:15], v230 offset:26432
    v_mfma_f32_16x16x32_bf16 v[172:175], a[20:23], a[124:127], v[172:175]
    s_waitcnt lgkmcnt(8)
    v_mfma_f32_16x16x32_bf16 v[32:35], a[24:27], a[96:99], v[32:35]
    ds_read_b64_tr_b16 a[16:17], v230 offset:96
    v_mfma_f32_16x16x32_bf16 v[32:35], a[28:31], a[112:115], v[32:35]
    buffer_load_dwordx4 v226, s[52:55], s8 offen offset:2048  lds
    v_mfma_f32_16x16x32_bf16 v[88:91], a[24:27], a[100:103], v[88:91]
    ds_read_b64_tr_b16 a[18:19], v230 offset:1888
    v_mfma_f32_16x16x32_bf16 v[88:91], a[28:31], a[116:119], v[88:91]
    v_mfma_f32_16x16x32_bf16 v[144:147], a[24:27], a[104:107], v[144:147]
    ds_read_b64_tr_b16 a[20:21], v230 offset:16480
    v_mfma_f32_16x16x32_bf16 v[144:147], a[28:31], a[120:123], v[144:147]
    v_mfma_f32_16x16x32_bf16 v[200:203], a[24:27], a[108:111], v[200:203]
    ds_read_b64_tr_b16 a[22:23], v230 offset:18272
    v_mfma_f32_16x16x32_bf16 v[200:203], a[28:31], a[124:127], v[200:203]
    buffer_load_dwordx4 v227, s[52:55], s8 offen offset:3072  lds
    s_mov_b32 s9, 2097152
    s_waitcnt lgkmcnt(8)
    v_mfma_f32_16x16x32_bf16 v[8:11], a[0:3], a[96:99], v[8:11]
    ds_read_b64_tr_b16 a[24:25], v230 offset:8288
    v_mfma_f32_16x16x32_bf16 v[8:11], a[4:7], a[112:115], v[8:11]
    v_mfma_f32_16x16x32_bf16 v[64:67], a[0:3], a[100:103], v[64:67]
    ds_read_b64_tr_b16 a[26:27], v230 offset:10080
    v_mfma_f32_16x16x32_bf16 v[64:67], a[4:7], a[116:119], v[64:67]
    v_mfma_f32_16x16x32_bf16 v[120:123], a[0:3], a[104:107], v[120:123]
    ds_read_b64_tr_b16 a[28:29], v230 offset:24672
    v_mfma_f32_16x16x32_bf16 v[120:123], a[4:7], a[120:123], v[120:123]
    buffer_load_dwordx4 a[32:35], v228, s[44:47], s9 offen offset:0 sc1
    v_mfma_f32_16x16x32_bf16 v[176:179], a[0:3], a[108:111], v[176:179]
    ds_read_b64_tr_b16 a[30:31], v230 offset:26464
    v_mfma_f32_16x16x32_bf16 v[176:179], a[4:7], a[124:127], v[176:179]
    s_waitcnt lgkmcnt(8)
    v_mfma_f32_16x16x32_bf16 v[36:39], a[8:11], a[96:99], v[36:39]
    ds_read_b64_tr_b16 a[0:1], v230 offset:128
    v_mfma_f32_16x16x32_bf16 v[36:39], a[12:15], a[112:115], v[36:39]
    v_mfma_f32_16x16x32_bf16 v[92:95], a[8:11], a[100:103], v[92:95]
    ds_read_b64_tr_b16 a[2:3], v230 offset:1920
    v_mfma_f32_16x16x32_bf16 v[92:95], a[12:15], a[116:119], v[92:95]
    buffer_load_dwordx4 a[36:39], v228, s[44:47], s9 offen offset:1024 sc1
    v_mfma_f32_16x16x32_bf16 v[148:151], a[8:11], a[104:107], v[148:151]
    ds_read_b64_tr_b16 a[4:5], v230 offset:16512
    v_mfma_f32_16x16x32_bf16 v[148:151], a[12:15], a[120:123], v[148:151]
    v_mfma_f32_16x16x32_bf16 v[204:207], a[8:11], a[108:111], v[204:207]
    ds_read_b64_tr_b16 a[6:7], v230 offset:18304
    v_mfma_f32_16x16x32_bf16 v[204:207], a[12:15], a[124:127], v[204:207]
    s_waitcnt lgkmcnt(8)
    v_mfma_f32_16x16x32_bf16 v[12:15], a[16:19], a[96:99], v[12:15]
    ds_read_b64_tr_b16 a[8:9], v230 offset:8320
    v_mfma_f32_16x16x32_bf16 v[12:15], a[20:23], a[112:115], v[12:15]
    buffer_load_dwordx4 a[40:43], v228, s[44:47], s9 offen offset:2048 sc1
    v_mfma_f32_16x16x32_bf16 v[68:71], a[16:19], a[100:103], v[68:71]
    ds_read_b64_tr_b16 a[10:11], v230 offset:10112
    v_mfma_f32_16x16x32_bf16 v[68:71], a[20:23], a[116:119], v[68:71]
    v_mfma_f32_16x16x32_bf16 v[124:127], a[16:19], a[104:107], v[124:127]
    ds_read_b64_tr_b16 a[12:13], v230 offset:24704
    v_mfma_f32_16x16x32_bf16 v[124:127], a[20:23], a[120:123], v[124:127]
    v_mfma_f32_16x16x32_bf16 v[180:183], a[16:19], a[108:111], v[180:183]
    ds_read_b64_tr_b16 a[14:15], v230 offset:26496
    v_mfma_f32_16x16x32_bf16 v[180:183], a[20:23], a[124:127], v[180:183]
    buffer_load_dwordx4 a[44:47], v228, s[44:47], s9 offen offset:3072 sc1
    s_mov_b32 s16, 5505024
    s_waitcnt lgkmcnt(8)
    v_mfma_f32_16x16x32_bf16 v[40:43], a[24:27], a[96:99], v[40:43]
    ds_read_b64_tr_b16 a[16:17], v230 offset:160
    v_mfma_f32_16x16x32_bf16 v[40:43], a[28:31], a[112:115], v[40:43]
    v_mfma_f32_16x16x32_bf16 v[96:99], a[24:27], a[100:103], v[96:99]
    ds_read_b64_tr_b16 a[18:19], v230 offset:1952
    v_mfma_f32_16x16x32_bf16 v[96:99], a[28:31], a[116:119], v[96:99]
    v_mfma_f32_16x16x32_bf16 v[152:155], a[24:27], a[104:107], v[152:155]
    ds_read_b64_tr_b16 a[20:21], v230 offset:16544
    v_mfma_f32_16x16x32_bf16 v[152:155], a[28:31], a[120:123], v[152:155]
    buffer_load_dword a255, v232, s[52:55], s16 offen
    s_mov_b32 s9, 2228224
    v_mfma_f32_16x16x32_bf16 v[208:211], a[24:27], a[108:111], v[208:211]
    ds_read_b64_tr_b16 a[22:23], v230 offset:18336
    v_mfma_f32_16x16x32_bf16 v[208:211], a[28:31], a[124:127], v[208:211]
    s_waitcnt lgkmcnt(8)
    v_mfma_f32_16x16x32_bf16 v[16:19], a[0:3], a[96:99], v[16:19]
    ds_read_b64_tr_b16 a[24:25], v230 offset:8352
    v_mfma_f32_16x16x32_bf16 v[16:19], a[4:7], a[112:115], v[16:19]
    v_mfma_f32_16x16x32_bf16 v[72:75], a[0:3], a[100:103], v[72:75]
    ds_read_b64_tr_b16 a[26:27], v230 offset:10144
    v_mfma_f32_16x16x32_bf16 v[72:75], a[4:7], a[116:119], v[72:75]
    buffer_load_dwordx4 a[48:51], v228, s[44:47], s9 offen offset:0 sc1
    v_mfma_f32_16x16x32_bf16 v[128:131], a[0:3], a[104:107], v[128:131]
    ds_read_b64_tr_b16 a[28:29], v230 offset:24736
    v_mfma_f32_16x16x32_bf16 v[128:131], a[4:7], a[120:123], v[128:131]
    v_mfma_f32_16x16x32_bf16 v[184:187], a[0:3], a[108:111], v[184:187]
    ds_read_b64_tr_b16 a[30:31], v230 offset:26528
    v_mfma_f32_16x16x32_bf16 v[184:187], a[4:7], a[124:127], v[184:187]
    s_waitcnt lgkmcnt(8)
    v_mfma_f32_16x16x32_bf16 v[44:47], a[8:11], a[96:99], v[44:47]
    ds_read_b64_tr_b16 a[0:1], v230 offset:192
    v_mfma_f32_16x16x32_bf16 v[44:47], a[12:15], a[112:115], v[44:47]
    buffer_load_dwordx4 a[52:55], v228, s[44:47], s9 offen offset:1024 sc1
    v_mfma_f32_16x16x32_bf16 v[100:103], a[8:11], a[100:103], v[100:103]
    ds_read_b64_tr_b16 a[2:3], v230 offset:1984
    v_mfma_f32_16x16x32_bf16 v[100:103], a[12:15], a[116:119], v[100:103]
    v_mfma_f32_16x16x32_bf16 v[156:159], a[8:11], a[104:107], v[156:159]
    ds_read_b64_tr_b16 a[4:5], v230 offset:16576
    v_mfma_f32_16x16x32_bf16 v[156:159], a[12:15], a[120:123], v[156:159]
    v_mfma_f32_16x16x32_bf16 v[212:215], a[8:11], a[108:111], v[212:215]
    ds_read_b64_tr_b16 a[6:7], v230 offset:18368
    v_mfma_f32_16x16x32_bf16 v[212:215], a[12:15], a[124:127], v[212:215]
    buffer_load_dwordx4 a[56:59], v228, s[44:47], s9 offen offset:2048 sc1
    s_waitcnt lgkmcnt(8)
    v_mfma_f32_16x16x32_bf16 v[20:23], a[16:19], a[96:99], v[20:23]
    ds_read_b64_tr_b16 a[8:9], v230 offset:8384
    v_mfma_f32_16x16x32_bf16 v[20:23], a[20:23], a[112:115], v[20:23]
    v_mfma_f32_16x16x32_bf16 v[76:79], a[16:19], a[100:103], v[76:79]
    ds_read_b64_tr_b16 a[10:11], v230 offset:10176
    v_mfma_f32_16x16x32_bf16 v[76:79], a[20:23], a[116:119], v[76:79]
    v_mfma_f32_16x16x32_bf16 v[132:135], a[16:19], a[104:107], v[132:135]
    ds_read_b64_tr_b16 a[12:13], v230 offset:24768
    v_mfma_f32_16x16x32_bf16 v[132:135], a[20:23], a[120:123], v[132:135]
    buffer_load_dwordx4 a[60:63], v228, s[44:47], s9 offen offset:3072 sc1
    s_mov_b32 s9, 2359296
    v_mfma_f32_16x16x32_bf16 v[188:191], a[16:19], a[108:111], v[188:191]
    ds_read_b64_tr_b16 a[14:15], v230 offset:26560
    v_mfma_f32_16x16x32_bf16 v[188:191], a[20:23], a[124:127], v[188:191]
    s_waitcnt vmcnt(27) lgkmcnt(8)
    s_barrier
    v_mfma_f32_16x16x32_bf16 v[48:51], a[24:27], a[96:99], v[48:51]
    ds_read_b64_tr_b16 a[16:17], v230 offset:32768
    v_mfma_f32_16x16x32_bf16 v[48:51], a[28:31], a[112:115], v[48:51]
    v_mfma_f32_16x16x32_bf16 v[104:107], a[24:27], a[100:103], v[104:107]
    ds_read_b64_tr_b16 a[18:19], v230 offset:34560
    v_mfma_f32_16x16x32_bf16 v[104:107], a[28:31], a[116:119], v[104:107]
    buffer_load_dwordx4 a[64:67], v228, s[44:47], s9 offen offset:0 sc1
    v_mfma_f32_16x16x32_bf16 v[160:163], a[24:27], a[104:107], v[160:163]
    ds_read_b64_tr_b16 a[20:21], v230 offset:49152
    v_mfma_f32_16x16x32_bf16 v[160:163], a[28:31], a[120:123], v[160:163]
    v_mfma_f32_16x16x32_bf16 v[216:219], a[24:27], a[108:111], v[216:219]
    ds_read_b64_tr_b16 a[22:23], v230 offset:50944
    v_mfma_f32_16x16x32_bf16 v[216:219], a[28:31], a[124:127], v[216:219]
    s_waitcnt lgkmcnt(8)
    v_mfma_f32_16x16x32_bf16 v[24:27], a[0:3], a[96:99], v[24:27]
    ds_read_b64_tr_b16 a[24:25], v230 offset:40960
    v_mfma_f32_16x16x32_bf16 v[24:27], a[4:7], a[112:115], v[24:27]
    buffer_load_dwordx4 a[68:71], v228, s[44:47], s9 offen offset:1024 sc1
    v_mfma_f32_16x16x32_bf16 v[80:83], a[0:3], a[100:103], v[80:83]
    ds_read_b64_tr_b16 a[26:27], v230 offset:42752
    v_mfma_f32_16x16x32_bf16 v[80:83], a[4:7], a[116:119], v[80:83]
    v_mfma_f32_16x16x32_bf16 v[136:139], a[0:3], a[104:107], v[136:139]
    ds_read_b64_tr_b16 a[28:29], v230 offset:57344
    v_mfma_f32_16x16x32_bf16 v[136:139], a[4:7], a[120:123], v[136:139]
    v_mfma_f32_16x16x32_bf16 v[192:195], a[0:3], a[108:111], v[192:195]
    ds_read_b64_tr_b16 a[30:31], v230 offset:59136
    v_mfma_f32_16x16x32_bf16 v[192:195], a[4:7], a[124:127], v[192:195]
    buffer_load_dwordx4 a[72:75], v228, s[44:47], s9 offen offset:2048 sc1
    s_waitcnt lgkmcnt(8)
    v_mfma_f32_16x16x32_bf16 v[52:55], a[8:11], a[96:99], v[52:55]
    ds_read_b64_tr_b16 a[0:1], v230 offset:32800
    v_mfma_f32_16x16x32_bf16 v[52:55], a[12:15], a[112:115], v[52:55]
    v_mfma_f32_16x16x32_bf16 v[108:111], a[8:11], a[100:103], v[108:111]
    ds_read_b64_tr_b16 a[2:3], v230 offset:34592
    v_mfma_f32_16x16x32_bf16 v[108:111], a[12:15], a[116:119], v[108:111]
    v_mfma_f32_16x16x32_bf16 v[164:167], a[8:11], a[104:107], v[164:167]
    ds_read_b64_tr_b16 a[4:5], v230 offset:49184
    v_mfma_f32_16x16x32_bf16 v[164:167], a[12:15], a[120:123], v[164:167]
    buffer_load_dwordx4 a[76:79], v228, s[44:47], s9 offen offset:3072 sc1
    s_add_u32 s8, s7, 4128768
    s_add_u32 m0, s6, 32768
    v_mfma_f32_16x16x32_bf16 v[220:223], a[8:11], a[108:111], v[220:223]
    ds_read_b64_tr_b16 a[6:7], v230 offset:50976
    v_mfma_f32_16x16x32_bf16 v[220:223], a[12:15], a[124:127], v[220:223]
    s_waitcnt vmcnt(21) lgkmcnt(8)
    v_mfma_f32_16x16x32_bf16 v[0:3], a[16:19], a[128:131], v[0:3]
    ds_read_b64_tr_b16 a[8:9], v230 offset:40992
    v_mfma_f32_16x16x32_bf16 v[0:3], a[20:23], a[144:147], v[0:3]
    v_mfma_f32_16x16x32_bf16 v[56:59], a[16:19], a[132:135], v[56:59]
    ds_read_b64_tr_b16 a[10:11], v230 offset:42784
    v_mfma_f32_16x16x32_bf16 v[56:59], a[20:23], a[148:151], v[56:59]
    buffer_load_dwordx4 v224, s[52:55], s8 offen offset:0  lds
    v_mfma_f32_16x16x32_bf16 v[112:115], a[16:19], a[136:139], v[112:115]
    ds_read_b64_tr_b16 a[12:13], v230 offset:57376
    v_mfma_f32_16x16x32_bf16 v[112:115], a[20:23], a[152:155], v[112:115]
    v_mfma_f32_16x16x32_bf16 v[168:171], a[16:19], a[140:143], v[168:171]
    ds_read_b64_tr_b16 a[14:15], v230 offset:59168
    v_mfma_f32_16x16x32_bf16 v[168:171], a[20:23], a[156:159], v[168:171]
    s_waitcnt lgkmcnt(8)
    v_mfma_f32_16x16x32_bf16 v[28:31], a[24:27], a[128:131], v[28:31]
    ds_read_b64_tr_b16 a[16:17], v230 offset:32832
    v_mfma_f32_16x16x32_bf16 v[28:31], a[28:31], a[144:147], v[28:31]
    buffer_load_dwordx4 v225, s[52:55], s8 offen offset:1024  lds
    v_mfma_f32_16x16x32_bf16 v[84:87], a[24:27], a[132:135], v[84:87]
    ds_read_b64_tr_b16 a[18:19], v230 offset:34624
    v_mfma_f32_16x16x32_bf16 v[84:87], a[28:31], a[148:151], v[84:87]
    v_mfma_f32_16x16x32_bf16 v[140:143], a[24:27], a[136:139], v[140:143]
    ds_read_b64_tr_b16 a[20:21], v230 offset:49216
    v_mfma_f32_16x16x32_bf16 v[140:143], a[28:31], a[152:155], v[140:143]
    v_mfma_f32_16x16x32_bf16 v[196:199], a[24:27], a[140:143], v[196:199]
    ds_read_b64_tr_b16 a[22:23], v230 offset:51008
    v_mfma_f32_16x16x32_bf16 v[196:199], a[28:31], a[156:159], v[196:199]
    buffer_load_dwordx4 v226, s[52:55], s8 offen offset:2048  lds
    s_waitcnt lgkmcnt(8)
    v_mfma_f32_16x16x32_bf16 v[4:7], a[0:3], a[128:131], v[4:7]
    ds_read_b64_tr_b16 a[24:25], v230 offset:41024
    v_mfma_f32_16x16x32_bf16 v[4:7], a[4:7], a[144:147], v[4:7]
    v_mfma_f32_16x16x32_bf16 v[60:63], a[0:3], a[132:135], v[60:63]
    ds_read_b64_tr_b16 a[26:27], v230 offset:42816
    v_mfma_f32_16x16x32_bf16 v[60:63], a[4:7], a[148:151], v[60:63]
    v_mfma_f32_16x16x32_bf16 v[116:119], a[0:3], a[136:139], v[116:119]
    ds_read_b64_tr_b16 a[28:29], v230 offset:57408
    v_mfma_f32_16x16x32_bf16 v[116:119], a[4:7], a[152:155], v[116:119]
    buffer_load_dwordx4 v227, s[52:55], s8 offen offset:3072  lds
    s_add_u32 s8, s7, 4358144
    s_add_u32 m0, s6, 49152
    v_mfma_f32_16x16x32_bf16 v[172:175], a[0:3], a[140:143], v[172:175]
    ds_read_b64_tr_b16 a[30:31], v230 offset:59200
    v_mfma_f32_16x16x32_bf16 v[172:175], a[4:7], a[156:159], v[172:175]
    s_waitcnt lgkmcnt(8)
    v_mfma_f32_16x16x32_bf16 v[32:35], a[8:11], a[128:131], v[32:35]
    ds_read_b64_tr_b16 a[0:1], v230 offset:32864
    v_mfma_f32_16x16x32_bf16 v[32:35], a[12:15], a[144:147], v[32:35]
    v_mfma_f32_16x16x32_bf16 v[88:91], a[8:11], a[132:135], v[88:91]
    ds_read_b64_tr_b16 a[2:3], v230 offset:34656
    v_mfma_f32_16x16x32_bf16 v[88:91], a[12:15], a[148:151], v[88:91]
    buffer_load_dwordx4 v224, s[52:55], s8 offen offset:0  lds
    v_mfma_f32_16x16x32_bf16 v[144:147], a[8:11], a[136:139], v[144:147]
    ds_read_b64_tr_b16 a[4:5], v230 offset:49248
    v_mfma_f32_16x16x32_bf16 v[144:147], a[12:15], a[152:155], v[144:147]
    s_branch L_fused_kernel_pc6
L_fused_kernel_isl0_6:
    s_branch L_fused_kernel_isl0_10
L_fused_kernel_pc6:
    v_mfma_f32_16x16x32_bf16 v[200:203], a[8:11], a[140:143], v[200:203]
    ds_read_b64_tr_b16 a[6:7], v230 offset:51040
    v_mfma_f32_16x16x32_bf16 v[200:203], a[12:15], a[156:159], v[200:203]
    s_waitcnt lgkmcnt(8)
    v_mfma_f32_16x16x32_bf16 v[8:11], a[16:19], a[128:131], v[8:11]
    ds_read_b64_tr_b16 a[8:9], v230 offset:41056
    v_mfma_f32_16x16x32_bf16 v[8:11], a[20:23], a[144:147], v[8:11]
    buffer_load_dwordx4 v225, s[52:55], s8 offen offset:1024  lds
    v_mfma_f32_16x16x32_bf16 v[64:67], a[16:19], a[132:135], v[64:67]
    ds_read_b64_tr_b16 a[10:11], v230 offset:42848
    v_mfma_f32_16x16x32_bf16 v[64:67], a[20:23], a[148:151], v[64:67]
    v_mfma_f32_16x16x32_bf16 v[120:123], a[16:19], a[136:139], v[120:123]
    ds_read_b64_tr_b16 a[12:13], v230 offset:57440
    v_mfma_f32_16x16x32_bf16 v[120:123], a[20:23], a[152:155], v[120:123]
    v_mfma_f32_16x16x32_bf16 v[176:179], a[16:19], a[140:143], v[176:179]
    ds_read_b64_tr_b16 a[14:15], v230 offset:59232
    v_mfma_f32_16x16x32_bf16 v[176:179], a[20:23], a[156:159], v[176:179]
    buffer_load_dwordx4 v226, s[52:55], s8 offen offset:2048  lds
    s_waitcnt lgkmcnt(8)
    v_mfma_f32_16x16x32_bf16 v[36:39], a[24:27], a[128:131], v[36:39]
    ds_read_b64_tr_b16 a[16:17], v230 offset:32896
    v_mfma_f32_16x16x32_bf16 v[36:39], a[28:31], a[144:147], v[36:39]
    v_mfma_f32_16x16x32_bf16 v[92:95], a[24:27], a[132:135], v[92:95]
    ds_read_b64_tr_b16 a[18:19], v230 offset:34688
    v_mfma_f32_16x16x32_bf16 v[92:95], a[28:31], a[148:151], v[92:95]
    v_mfma_f32_16x16x32_bf16 v[148:151], a[24:27], a[136:139], v[148:151]
    ds_read_b64_tr_b16 a[20:21], v230 offset:49280
    v_mfma_f32_16x16x32_bf16 v[148:151], a[28:31], a[152:155], v[148:151]
    buffer_load_dwordx4 v227, s[52:55], s8 offen offset:3072  lds
    s_mov_b32 s16, 5963776
    v_mfma_f32_16x16x32_bf16 v[204:207], a[24:27], a[140:143], v[204:207]
    ds_read_b64_tr_b16 a[22:23], v230 offset:51072
    v_mfma_f32_16x16x32_bf16 v[204:207], a[28:31], a[156:159], v[204:207]
    s_waitcnt lgkmcnt(8)
    v_mfma_f32_16x16x32_bf16 v[12:15], a[0:3], a[128:131], v[12:15]
    ds_read_b64_tr_b16 a[24:25], v230 offset:41088
    v_mfma_f32_16x16x32_bf16 v[12:15], a[4:7], a[144:147], v[12:15]
    v_mfma_f32_16x16x32_bf16 v[68:71], a[0:3], a[132:135], v[68:71]
    ds_read_b64_tr_b16 a[26:27], v230 offset:42880
    v_mfma_f32_16x16x32_bf16 v[68:71], a[4:7], a[148:151], v[68:71]
    buffer_load_dword a255, v232, s[52:55], s16 offen
    s_mov_b32 s16, 2048
    v_mfma_f32_16x16x32_bf16 v[124:127], a[0:3], a[136:139], v[124:127]
    ds_read_b64_tr_b16 a[28:29], v230 offset:57472
    v_mfma_f32_16x16x32_bf16 v[124:127], a[4:7], a[152:155], v[124:127]
    v_mfma_f32_16x16x32_bf16 v[180:183], a[0:3], a[140:143], v[180:183]
    ds_read_b64_tr_b16 a[30:31], v230 offset:59264
    v_mfma_f32_16x16x32_bf16 v[180:183], a[4:7], a[156:159], v[180:183]
    s_waitcnt lgkmcnt(8)
    v_mfma_f32_16x16x32_bf16 v[40:43], a[8:11], a[128:131], v[40:43]
    ds_read_b64_tr_b16 a[0:1], v230 offset:32928
    v_mfma_f32_16x16x32_bf16 v[40:43], a[12:15], a[144:147], v[40:43]
    buffer_store_dwordx4 v[236:239], v233, s[40:43], s16 offen sc1
    s_mov_b32 s9, 2490368
    v_mfma_f32_16x16x32_bf16 v[96:99], a[8:11], a[132:135], v[96:99]
    ds_read_b64_tr_b16 a[2:3], v230 offset:34720
    v_mfma_f32_16x16x32_bf16 v[96:99], a[12:15], a[148:151], v[96:99]
    v_mfma_f32_16x16x32_bf16 v[152:155], a[8:11], a[136:139], v[152:155]
    ds_read_b64_tr_b16 a[4:5], v230 offset:49312
    v_mfma_f32_16x16x32_bf16 v[152:155], a[12:15], a[152:155], v[152:155]
    v_mfma_f32_16x16x32_bf16 v[208:211], a[8:11], a[140:143], v[208:211]
    ds_read_b64_tr_b16 a[6:7], v230 offset:51104
    v_mfma_f32_16x16x32_bf16 v[208:211], a[12:15], a[156:159], v[208:211]
    buffer_load_dwordx4 a[80:83], v228, s[44:47], s9 offen offset:0 sc1
    s_waitcnt lgkmcnt(8)
    v_mfma_f32_16x16x32_bf16 v[16:19], a[16:19], a[128:131], v[16:19]
    ds_read_b64_tr_b16 a[8:9], v230 offset:41120
    v_mfma_f32_16x16x32_bf16 v[16:19], a[20:23], a[144:147], v[16:19]
    v_mfma_f32_16x16x32_bf16 v[72:75], a[16:19], a[132:135], v[72:75]
    ds_read_b64_tr_b16 a[10:11], v230 offset:42912
    v_mfma_f32_16x16x32_bf16 v[72:75], a[20:23], a[148:151], v[72:75]
    v_mfma_f32_16x16x32_bf16 v[128:131], a[16:19], a[136:139], v[128:131]
    ds_read_b64_tr_b16 a[12:13], v230 offset:57504
    v_mfma_f32_16x16x32_bf16 v[128:131], a[20:23], a[152:155], v[128:131]
    buffer_load_dwordx4 a[84:87], v228, s[44:47], s9 offen offset:1024 sc1
    v_mfma_f32_16x16x32_bf16 v[184:187], a[16:19], a[140:143], v[184:187]
    ds_read_b64_tr_b16 a[14:15], v230 offset:59296
    v_mfma_f32_16x16x32_bf16 v[184:187], a[20:23], a[156:159], v[184:187]
    s_waitcnt lgkmcnt(8)
    v_mfma_f32_16x16x32_bf16 v[44:47], a[24:27], a[128:131], v[44:47]
    ds_read_b64_tr_b16 a[16:17], v230 offset:32960
    v_mfma_f32_16x16x32_bf16 v[44:47], a[28:31], a[144:147], v[44:47]
    v_mfma_f32_16x16x32_bf16 v[100:103], a[24:27], a[132:135], v[100:103]
    ds_read_b64_tr_b16 a[18:19], v230 offset:34752
    v_mfma_f32_16x16x32_bf16 v[100:103], a[28:31], a[148:151], v[100:103]
    buffer_load_dwordx4 a[88:91], v228, s[44:47], s9 offen offset:2048 sc1
    v_mfma_f32_16x16x32_bf16 v[156:159], a[24:27], a[136:139], v[156:159]
    ds_read_b64_tr_b16 a[20:21], v230 offset:49344
    v_mfma_f32_16x16x32_bf16 v[156:159], a[28:31], a[152:155], v[156:159]
    v_mfma_f32_16x16x32_bf16 v[212:215], a[24:27], a[140:143], v[212:215]
    ds_read_b64_tr_b16 a[22:23], v230 offset:51136
    v_mfma_f32_16x16x32_bf16 v[212:215], a[28:31], a[156:159], v[212:215]
    s_waitcnt lgkmcnt(8)
    v_mfma_f32_16x16x32_bf16 v[20:23], a[0:3], a[128:131], v[20:23]
    ds_read_b64_tr_b16 a[24:25], v230 offset:41152
    v_mfma_f32_16x16x32_bf16 v[20:23], a[4:7], a[144:147], v[20:23]
    buffer_load_dwordx4 a[92:95], v228, s[44:47], s9 offen offset:3072 sc1
    s_mov_b32 s9, 2621440
    v_mfma_f32_16x16x32_bf16 v[76:79], a[0:3], a[132:135], v[76:79]
    ds_read_b64_tr_b16 a[26:27], v230 offset:42944
    v_mfma_f32_16x16x32_bf16 v[76:79], a[4:7], a[148:151], v[76:79]
    v_mfma_f32_16x16x32_bf16 v[132:135], a[0:3], a[136:139], v[132:135]
    ds_read_b64_tr_b16 a[28:29], v230 offset:57536
    v_mfma_f32_16x16x32_bf16 v[132:135], a[4:7], a[152:155], v[132:135]
    v_mfma_f32_16x16x32_bf16 v[188:191], a[0:3], a[140:143], v[188:191]
    ds_read_b64_tr_b16 a[30:31], v230 offset:59328
    v_mfma_f32_16x16x32_bf16 v[188:191], a[4:7], a[156:159], v[188:191]
    buffer_load_dwordx4 a[96:99], v228, s[44:47], s9 offen offset:0 sc1
    s_waitcnt vmcnt(28) lgkmcnt(8)
    s_barrier
    v_mfma_f32_16x16x32_bf16 v[48:51], a[8:11], a[128:131], v[48:51]
    ds_read_b64_tr_b16 a[0:1], v229 offset:0
    v_mfma_f32_16x16x32_bf16 v[48:51], a[12:15], a[144:147], v[48:51]
    v_mfma_f32_16x16x32_bf16 v[104:107], a[8:11], a[132:135], v[104:107]
    ds_read_b64_tr_b16 a[2:3], v229 offset:1792
    v_mfma_f32_16x16x32_bf16 v[104:107], a[12:15], a[148:151], v[104:107]
    v_mfma_f32_16x16x32_bf16 v[160:163], a[8:11], a[136:139], v[160:163]
    ds_read_b64_tr_b16 a[4:5], v229 offset:16384
    v_mfma_f32_16x16x32_bf16 v[160:163], a[12:15], a[152:155], v[160:163]
    buffer_load_dwordx4 a[100:103], v228, s[44:47], s9 offen offset:1024 sc1
    v_mfma_f32_16x16x32_bf16 v[216:219], a[8:11], a[140:143], v[216:219]
    ds_read_b64_tr_b16 a[6:7], v229 offset:18176
    v_mfma_f32_16x16x32_bf16 v[216:219], a[12:15], a[156:159], v[216:219]
    s_waitcnt lgkmcnt(8)
    v_mfma_f32_16x16x32_bf16 v[24:27], a[16:19], a[128:131], v[24:27]
    ds_read_b64_tr_b16 a[8:9], v229 offset:8192
    v_mfma_f32_16x16x32_bf16 v[24:27], a[20:23], a[144:147], v[24:27]
    v_mfma_f32_16x16x32_bf16 v[80:83], a[16:19], a[132:135], v[80:83]
    ds_read_b64_tr_b16 a[10:11], v229 offset:9984
    v_mfma_f32_16x16x32_bf16 v[80:83], a[20:23], a[148:151], v[80:83]
    buffer_load_dwordx4 a[104:107], v228, s[44:47], s9 offen offset:2048 sc1
    v_mfma_f32_16x16x32_bf16 v[136:139], a[16:19], a[136:139], v[136:139]
    ds_read_b64_tr_b16 a[12:13], v229 offset:24576
    v_mfma_f32_16x16x32_bf16 v[136:139], a[20:23], a[152:155], v[136:139]
    v_mfma_f32_16x16x32_bf16 v[192:195], a[16:19], a[140:143], v[192:195]
    ds_read_b64_tr_b16 a[14:15], v229 offset:26368
    v_mfma_f32_16x16x32_bf16 v[192:195], a[20:23], a[156:159], v[192:195]
    s_waitcnt lgkmcnt(8)
    v_mfma_f32_16x16x32_bf16 v[52:55], a[24:27], a[128:131], v[52:55]
    ds_read_b64_tr_b16 a[16:17], v229 offset:32
    v_mfma_f32_16x16x32_bf16 v[52:55], a[28:31], a[144:147], v[52:55]
    buffer_load_dwordx4 a[108:111], v228, s[44:47], s9 offen offset:3072 sc1
    s_add_u32 s8, s7, 4587520
    s_add_u32 m0, s6, 65536
    v_mfma_f32_16x16x32_bf16 v[108:111], a[24:27], a[132:135], v[108:111]
    ds_read_b64_tr_b16 a[18:19], v229 offset:1824
    v_mfma_f32_16x16x32_bf16 v[108:111], a[28:31], a[148:151], v[108:111]
    v_mfma_f32_16x16x32_bf16 v[164:167], a[24:27], a[136:139], v[164:167]
    ds_read_b64_tr_b16 a[20:21], v229 offset:16416
    v_mfma_f32_16x16x32_bf16 v[164:167], a[28:31], a[152:155], v[164:167]
    v_mfma_f32_16x16x32_bf16 v[220:223], a[24:27], a[140:143], v[220:223]
    ds_read_b64_tr_b16 a[22:23], v229 offset:18208
    v_mfma_f32_16x16x32_bf16 v[220:223], a[28:31], a[156:159], v[220:223]
    buffer_load_dwordx4 v224, s[52:55], s8 offen offset:0  lds
    s_waitcnt vmcnt(23) lgkmcnt(8)
    v_mfma_f32_16x16x32_bf16 v[0:3], a[0:3], a[32:35], v[0:3]
    ds_read_b64_tr_b16 a[24:25], v229 offset:8224
    v_mfma_f32_16x16x32_bf16 v[0:3], a[4:7], a[48:51], v[0:3]
    v_mfma_f32_16x16x32_bf16 v[56:59], a[0:3], a[36:39], v[56:59]
    ds_read_b64_tr_b16 a[26:27], v229 offset:10016
    v_mfma_f32_16x16x32_bf16 v[56:59], a[4:7], a[52:55], v[56:59]
    v_mfma_f32_16x16x32_bf16 v[112:115], a[0:3], a[40:43], v[112:115]
    ds_read_b64_tr_b16 a[28:29], v229 offset:24608
    v_mfma_f32_16x16x32_bf16 v[112:115], a[4:7], a[56:59], v[112:115]
    buffer_load_dwordx4 v225, s[52:55], s8 offen offset:1024  lds
    v_mfma_f32_16x16x32_bf16 v[168:171], a[0:3], a[44:47], v[168:171]
    ds_read_b64_tr_b16 a[30:31], v229 offset:26400
    v_mfma_f32_16x16x32_bf16 v[168:171], a[4:7], a[60:63], v[168:171]
    s_waitcnt lgkmcnt(8)
    v_mfma_f32_16x16x32_bf16 v[28:31], a[8:11], a[32:35], v[28:31]
    ds_read_b64_tr_b16 a[0:1], v229 offset:64
    v_mfma_f32_16x16x32_bf16 v[28:31], a[12:15], a[48:51], v[28:31]
    v_mfma_f32_16x16x32_bf16 v[84:87], a[8:11], a[36:39], v[84:87]
    ds_read_b64_tr_b16 a[2:3], v229 offset:1856
    v_mfma_f32_16x16x32_bf16 v[84:87], a[12:15], a[52:55], v[84:87]
    buffer_load_dwordx4 v226, s[52:55], s8 offen offset:2048  lds
    v_mfma_f32_16x16x32_bf16 v[140:143], a[8:11], a[40:43], v[140:143]
    ds_read_b64_tr_b16 a[4:5], v229 offset:16448
    v_mfma_f32_16x16x32_bf16 v[140:143], a[12:15], a[56:59], v[140:143]
    v_mfma_f32_16x16x32_bf16 v[196:199], a[8:11], a[44:47], v[196:199]
    ds_read_b64_tr_b16 a[6:7], v229 offset:18240
    v_mfma_f32_16x16x32_bf16 v[196:199], a[12:15], a[60:63], v[196:199]
    s_waitcnt lgkmcnt(8)
    v_mfma_f32_16x16x32_bf16 v[4:7], a[16:19], a[32:35], v[4:7]
    ds_read_b64_tr_b16 a[8:9], v229 offset:8256
    v_mfma_f32_16x16x32_bf16 v[4:7], a[20:23], a[48:51], v[4:7]
    buffer_load_dwordx4 v227, s[52:55], s8 offen offset:3072  lds
    s_add_u32 s8, s7, 4816896
    s_add_u32 m0, s6, 81920
    v_mfma_f32_16x16x32_bf16 v[60:63], a[16:19], a[36:39], v[60:63]
    ds_read_b64_tr_b16 a[10:11], v229 offset:10048
    v_mfma_f32_16x16x32_bf16 v[60:63], a[20:23], a[52:55], v[60:63]
    v_mfma_f32_16x16x32_bf16 v[116:119], a[16:19], a[40:43], v[116:119]
    ds_read_b64_tr_b16 a[12:13], v229 offset:24640
    v_mfma_f32_16x16x32_bf16 v[116:119], a[20:23], a[56:59], v[116:119]
    v_mfma_f32_16x16x32_bf16 v[172:175], a[16:19], a[44:47], v[172:175]
    ds_read_b64_tr_b16 a[14:15], v229 offset:26432
    v_mfma_f32_16x16x32_bf16 v[172:175], a[20:23], a[60:63], v[172:175]
    buffer_load_dwordx4 v224, s[52:55], s8 offen offset:0  lds
    s_waitcnt lgkmcnt(8)
    v_mfma_f32_16x16x32_bf16 v[32:35], a[24:27], a[32:35], v[32:35]
    ds_read_b64_tr_b16 a[16:17], v229 offset:96
    v_mfma_f32_16x16x32_bf16 v[32:35], a[28:31], a[48:51], v[32:35]
    v_mfma_f32_16x16x32_bf16 v[88:91], a[24:27], a[36:39], v[88:91]
    ds_read_b64_tr_b16 a[18:19], v229 offset:1888
    v_mfma_f32_16x16x32_bf16 v[88:91], a[28:31], a[52:55], v[88:91]
    v_mfma_f32_16x16x32_bf16 v[144:147], a[24:27], a[40:43], v[144:147]
    ds_read_b64_tr_b16 a[20:21], v229 offset:16480
    v_mfma_f32_16x16x32_bf16 v[144:147], a[28:31], a[56:59], v[144:147]
    buffer_load_dwordx4 v225, s[52:55], s8 offen offset:1024  lds
    v_mfma_f32_16x16x32_bf16 v[200:203], a[24:27], a[44:47], v[200:203]
    ds_read_b64_tr_b16 a[22:23], v229 offset:18272
    v_mfma_f32_16x16x32_bf16 v[200:203], a[28:31], a[60:63], v[200:203]
    s_waitcnt lgkmcnt(8)
    v_mfma_f32_16x16x32_bf16 v[8:11], a[0:3], a[32:35], v[8:11]
    ds_read_b64_tr_b16 a[24:25], v229 offset:8288
    v_mfma_f32_16x16x32_bf16 v[8:11], a[4:7], a[48:51], v[8:11]
    v_mfma_f32_16x16x32_bf16 v[64:67], a[0:3], a[36:39], v[64:67]
    ds_read_b64_tr_b16 a[26:27], v229 offset:10080
    v_mfma_f32_16x16x32_bf16 v[64:67], a[4:7], a[52:55], v[64:67]
    buffer_load_dwordx4 v226, s[52:55], s8 offen offset:2048  lds
    v_mfma_f32_16x16x32_bf16 v[120:123], a[0:3], a[40:43], v[120:123]
    ds_read_b64_tr_b16 a[28:29], v229 offset:24672
    v_mfma_f32_16x16x32_bf16 v[120:123], a[4:7], a[56:59], v[120:123]
    v_mfma_f32_16x16x32_bf16 v[176:179], a[0:3], a[44:47], v[176:179]
    ds_read_b64_tr_b16 a[30:31], v229 offset:26464
    v_mfma_f32_16x16x32_bf16 v[176:179], a[4:7], a[60:63], v[176:179]
    s_waitcnt lgkmcnt(8)
    v_mfma_f32_16x16x32_bf16 v[36:39], a[8:11], a[32:35], v[36:39]
    ds_read_b64_tr_b16 a[0:1], v229 offset:128
    v_mfma_f32_16x16x32_bf16 v[36:39], a[12:15], a[48:51], v[36:39]
    buffer_load_dwordx4 v227, s[52:55], s8 offen offset:3072  lds
    s_mov_b32 s16, 6422528
    v_mfma_f32_16x16x32_bf16 v[92:95], a[8:11], a[36:39], v[92:95]
    ds_read_b64_tr_b16 a[2:3], v229 offset:1920
    v_mfma_f32_16x16x32_bf16 v[92:95], a[12:15], a[52:55], v[92:95]
    v_mfma_f32_16x16x32_bf16 v[148:151], a[8:11], a[40:43], v[148:151]
    ds_read_b64_tr_b16 a[4:5], v229 offset:16512
    v_mfma_f32_16x16x32_bf16 v[148:151], a[12:15], a[56:59], v[148:151]
    v_mfma_f32_16x16x32_bf16 v[204:207], a[8:11], a[44:47], v[204:207]
    ds_read_b64_tr_b16 a[6:7], v229 offset:18304
    v_mfma_f32_16x16x32_bf16 v[204:207], a[12:15], a[60:63], v[204:207]
    buffer_load_dword a255, v232, s[52:55], s16 offen
    s_mov_b32 s9, 2752512
    s_waitcnt lgkmcnt(8)
    v_mfma_f32_16x16x32_bf16 v[12:15], a[16:19], a[32:35], v[12:15]
    ds_read_b64_tr_b16 a[8:9], v229 offset:8320
    v_mfma_f32_16x16x32_bf16 v[12:15], a[20:23], a[48:51], v[12:15]
    v_mfma_f32_16x16x32_bf16 v[68:71], a[16:19], a[36:39], v[68:71]
    ds_read_b64_tr_b16 a[10:11], v229 offset:10112
    v_mfma_f32_16x16x32_bf16 v[68:71], a[20:23], a[52:55], v[68:71]
    v_mfma_f32_16x16x32_bf16 v[124:127], a[16:19], a[40:43], v[124:127]
    ds_read_b64_tr_b16 a[12:13], v229 offset:24704
    v_mfma_f32_16x16x32_bf16 v[124:127], a[20:23], a[56:59], v[124:127]
    buffer_load_dwordx4 a[112:115], v228, s[44:47], s9 offen offset:0 sc1
    v_mfma_f32_16x16x32_bf16 v[180:183], a[16:19], a[44:47], v[180:183]
    ds_read_b64_tr_b16 a[14:15], v229 offset:26496
    v_mfma_f32_16x16x32_bf16 v[180:183], a[20:23], a[60:63], v[180:183]
    s_waitcnt lgkmcnt(8)
    v_mfma_f32_16x16x32_bf16 v[40:43], a[24:27], a[32:35], v[40:43]
    ds_read_b64_tr_b16 a[16:17], v229 offset:160
    v_mfma_f32_16x16x32_bf16 v[40:43], a[28:31], a[48:51], v[40:43]
    v_mfma_f32_16x16x32_bf16 v[96:99], a[24:27], a[36:39], v[96:99]
    ds_read_b64_tr_b16 a[18:19], v229 offset:1952
    v_mfma_f32_16x16x32_bf16 v[96:99], a[28:31], a[52:55], v[96:99]
    buffer_load_dwordx4 a[116:119], v228, s[44:47], s9 offen offset:1024 sc1
    v_mfma_f32_16x16x32_bf16 v[152:155], a[24:27], a[40:43], v[152:155]
    ds_read_b64_tr_b16 a[20:21], v229 offset:16544
    v_mfma_f32_16x16x32_bf16 v[152:155], a[28:31], a[56:59], v[152:155]
    v_mfma_f32_16x16x32_bf16 v[208:211], a[24:27], a[44:47], v[208:211]
    ds_read_b64_tr_b16 a[22:23], v229 offset:18336
    v_mfma_f32_16x16x32_bf16 v[208:211], a[28:31], a[60:63], v[208:211]
    s_waitcnt lgkmcnt(8)
    v_mfma_f32_16x16x32_bf16 v[16:19], a[0:3], a[32:35], v[16:19]
    ds_read_b64_tr_b16 a[24:25], v229 offset:8352
    v_mfma_f32_16x16x32_bf16 v[16:19], a[4:7], a[48:51], v[16:19]
    buffer_load_dwordx4 a[120:123], v228, s[44:47], s9 offen offset:2048 sc1
    v_mfma_f32_16x16x32_bf16 v[72:75], a[0:3], a[36:39], v[72:75]
    ds_read_b64_tr_b16 a[26:27], v229 offset:10144
    v_mfma_f32_16x16x32_bf16 v[72:75], a[4:7], a[52:55], v[72:75]
    v_mfma_f32_16x16x32_bf16 v[128:131], a[0:3], a[40:43], v[128:131]
    ds_read_b64_tr_b16 a[28:29], v229 offset:24736
    v_mfma_f32_16x16x32_bf16 v[128:131], a[4:7], a[56:59], v[128:131]
    v_mfma_f32_16x16x32_bf16 v[184:187], a[0:3], a[44:47], v[184:187]
    ds_read_b64_tr_b16 a[30:31], v229 offset:26528
    v_mfma_f32_16x16x32_bf16 v[184:187], a[4:7], a[60:63], v[184:187]
    buffer_load_dwordx4 a[124:127], v228, s[44:47], s9 offen offset:3072 sc1
    s_mov_b32 s9, 2883584
    s_waitcnt lgkmcnt(8)
    v_mfma_f32_16x16x32_bf16 v[44:47], a[8:11], a[32:35], v[44:47]
    ds_read_b64_tr_b16 a[0:1], v229 offset:192
    v_mfma_f32_16x16x32_bf16 v[44:47], a[12:15], a[48:51], v[44:47]
    v_mfma_f32_16x16x32_bf16 v[100:103], a[8:11], a[36:39], v[100:103]
    ds_read_b64_tr_b16 a[2:3], v229 offset:1984
    v_mfma_f32_16x16x32_bf16 v[100:103], a[12:15], a[52:55], v[100:103]
    v_mfma_f32_16x16x32_bf16 v[156:159], a[8:11], a[40:43], v[156:159]
    ds_read_b64_tr_b16 a[4:5], v229 offset:16576
    v_mfma_f32_16x16x32_bf16 v[156:159], a[12:15], a[56:59], v[156:159]
    buffer_load_dwordx4 a[128:131], v228, s[44:47], s9 offen offset:0 sc1
    v_mfma_f32_16x16x32_bf16 v[212:215], a[8:11], a[44:47], v[212:215]
    ds_read_b64_tr_b16 a[6:7], v229 offset:18368
    v_mfma_f32_16x16x32_bf16 v[212:215], a[12:15], a[60:63], v[212:215]
    s_waitcnt lgkmcnt(8)
    v_mfma_f32_16x16x32_bf16 v[20:23], a[16:19], a[32:35], v[20:23]
    ds_read_b64_tr_b16 a[8:9], v229 offset:8384
    v_mfma_f32_16x16x32_bf16 v[20:23], a[20:23], a[48:51], v[20:23]
    v_mfma_f32_16x16x32_bf16 v[76:79], a[16:19], a[36:39], v[76:79]
    ds_read_b64_tr_b16 a[10:11], v229 offset:10176
    v_mfma_f32_16x16x32_bf16 v[76:79], a[20:23], a[52:55], v[76:79]
    buffer_load_dwordx4 a[132:135], v228, s[44:47], s9 offen offset:1024 sc1
    v_mfma_f32_16x16x32_bf16 v[132:135], a[16:19], a[40:43], v[132:135]
    ds_read_b64_tr_b16 a[12:13], v229 offset:24768
    v_mfma_f32_16x16x32_bf16 v[132:135], a[20:23], a[56:59], v[132:135]
    v_mfma_f32_16x16x32_bf16 v[188:191], a[16:19], a[44:47], v[188:191]
    ds_read_b64_tr_b16 a[14:15], v229 offset:26560
    v_mfma_f32_16x16x32_bf16 v[188:191], a[20:23], a[60:63], v[188:191]
    s_waitcnt vmcnt(25) lgkmcnt(8)
    s_barrier
    v_mfma_f32_16x16x32_bf16 v[48:51], a[24:27], a[32:35], v[48:51]
    ds_read_b64_tr_b16 a[16:17], v229 offset:32768
    v_mfma_f32_16x16x32_bf16 v[48:51], a[28:31], a[48:51], v[48:51]
    buffer_load_dwordx4 a[136:139], v228, s[44:47], s9 offen offset:2048 sc1
    v_mfma_f32_16x16x32_bf16 v[104:107], a[24:27], a[36:39], v[104:107]
    ds_read_b64_tr_b16 a[18:19], v229 offset:34560
    v_mfma_f32_16x16x32_bf16 v[104:107], a[28:31], a[52:55], v[104:107]
    v_mfma_f32_16x16x32_bf16 v[160:163], a[24:27], a[40:43], v[160:163]
    ds_read_b64_tr_b16 a[20:21], v229 offset:49152
    v_mfma_f32_16x16x32_bf16 v[160:163], a[28:31], a[56:59], v[160:163]
    v_mfma_f32_16x16x32_bf16 v[216:219], a[24:27], a[44:47], v[216:219]
    ds_read_b64_tr_b16 a[22:23], v229 offset:50944
    v_mfma_f32_16x16x32_bf16 v[216:219], a[28:31], a[60:63], v[216:219]
    buffer_load_dwordx4 a[140:143], v228, s[44:47], s9 offen offset:3072 sc1
    s_add_u32 s8, s7, 5046272
    s_waitcnt lgkmcnt(8)
    v_mfma_f32_16x16x32_bf16 v[24:27], a[0:3], a[32:35], v[24:27]
    ds_read_b64_tr_b16 a[24:25], v229 offset:40960
    s_add_u32 m0, s6, 98304
    v_mfma_f32_16x16x32_bf16 v[24:27], a[4:7], a[48:51], v[24:27]
    v_mfma_f32_16x16x32_bf16 v[80:83], a[0:3], a[36:39], v[80:83]
    ds_read_b64_tr_b16 a[26:27], v229 offset:42752
    v_mfma_f32_16x16x32_bf16 v[80:83], a[4:7], a[52:55], v[80:83]
    v_mfma_f32_16x16x32_bf16 v[136:139], a[0:3], a[40:43], v[136:139]
    ds_read_b64_tr_b16 a[28:29], v229 offset:57344
    v_mfma_f32_16x16x32_bf16 v[136:139], a[4:7], a[56:59], v[136:139]
    buffer_load_dwordx4 v224, s[52:55], s8 offen offset:0  lds
    v_mfma_f32_16x16x32_bf16 v[192:195], a[0:3], a[44:47], v[192:195]
    ds_read_b64_tr_b16 a[30:31], v229 offset:59136
    v_mfma_f32_16x16x32_bf16 v[192:195], a[4:7], a[60:63], v[192:195]
    s_waitcnt lgkmcnt(8)
    v_mfma_f32_16x16x32_bf16 v[52:55], a[8:11], a[32:35], v[52:55]
    ds_read_b64_tr_b16 a[0:1], v229 offset:32800
    v_mfma_f32_16x16x32_bf16 v[52:55], a[12:15], a[48:51], v[52:55]
    v_mfma_f32_16x16x32_bf16 v[108:111], a[8:11], a[36:39], v[108:111]
    ds_read_b64_tr_b16 a[2:3], v229 offset:34592
    v_mfma_f32_16x16x32_bf16 v[108:111], a[12:15], a[52:55], v[108:111]
    buffer_load_dwordx4 v225, s[52:55], s8 offen offset:1024  lds
    v_mfma_f32_16x16x32_bf16 v[164:167], a[8:11], a[40:43], v[164:167]
    ds_read_b64_tr_b16 a[4:5], v229 offset:49184
    v_mfma_f32_16x16x32_bf16 v[164:167], a[12:15], a[56:59], v[164:167]
    v_mfma_f32_16x16x32_bf16 v[220:223], a[8:11], a[44:47], v[220:223]
    ds_read_b64_tr_b16 a[6:7], v229 offset:50976
    v_mfma_f32_16x16x32_bf16 v[220:223], a[12:15], a[60:63], v[220:223]
    s_waitcnt vmcnt(23) lgkmcnt(8)
    v_mfma_f32_16x16x32_bf16 v[0:3], a[16:19], a[64:67], v[0:3]
    ds_read_b64_tr_b16 a[8:9], v229 offset:40992
    v_mfma_f32_16x16x32_bf16 v[0:3], a[20:23], a[80:83], v[0:3]
    buffer_load_dwordx4 v226, s[52:55], s8 offen offset:2048  lds
    v_mfma_f32_16x16x32_bf16 v[56:59], a[16:19], a[68:71], v[56:59]
    ds_read_b64_tr_b16 a[10:11], v229 offset:42784
    v_mfma_f32_16x16x32_bf16 v[56:59], a[20:23], a[84:87], v[56:59]
    v_mfma_f32_16x16x32_bf16 v[112:115], a[16:19], a[72:75], v[112:115]
    ds_read_b64_tr_b16 a[12:13], v229 offset:57376
    v_mfma_f32_16x16x32_bf16 v[112:115], a[20:23], a[88:91], v[112:115]
    v_mfma_f32_16x16x32_bf16 v[168:171], a[16:19], a[76:79], v[168:171]
    ds_read_b64_tr_b16 a[14:15], v229 offset:59168
    v_mfma_f32_16x16x32_bf16 v[168:171], a[20:23], a[92:95], v[168:171]
    buffer_load_dwordx4 v227, s[52:55], s8 offen offset:3072  lds
    s_add_u32 s8, s7, 5275648
    s_waitcnt lgkmcnt(8)
    v_mfma_f32_16x16x32_bf16 v[28:31], a[24:27], a[64:67], v[28:31]
    ds_read_b64_tr_b16 a[16:17], v229 offset:32832
    s_add_u32 m0, s6, 114688
    v_mfma_f32_16x16x32_bf16 v[28:31], a[28:31], a[80:83], v[28:31]
    v_mfma_f32_16x16x32_bf16 v[84:87], a[24:27], a[68:71], v[84:87]
    ds_read_b64_tr_b16 a[18:19], v229 offset:34624
    v_mfma_f32_16x16x32_bf16 v[84:87], a[28:31], a[84:87], v[84:87]
    v_mfma_f32_16x16x32_bf16 v[140:143], a[24:27], a[72:75], v[140:143]
    ds_read_b64_tr_b16 a[20:21], v229 offset:49216
    v_mfma_f32_16x16x32_bf16 v[140:143], a[28:31], a[88:91], v[140:143]
    buffer_load_dwordx4 v224, s[52:55], s8 offen offset:0  lds
    v_mfma_f32_16x16x32_bf16 v[196:199], a[24:27], a[76:79], v[196:199]
    ds_read_b64_tr_b16 a[22:23], v229 offset:51008
    v_mfma_f32_16x16x32_bf16 v[196:199], a[28:31], a[92:95], v[196:199]
    s_waitcnt lgkmcnt(8)
    v_mfma_f32_16x16x32_bf16 v[4:7], a[0:3], a[64:67], v[4:7]
    ds_read_b64_tr_b16 a[24:25], v229 offset:41024
    v_mfma_f32_16x16x32_bf16 v[4:7], a[4:7], a[80:83], v[4:7]
    v_mfma_f32_16x16x32_bf16 v[60:63], a[0:3], a[68:71], v[60:63]
    ds_read_b64_tr_b16 a[26:27], v229 offset:42816
    v_mfma_f32_16x16x32_bf16 v[60:63], a[4:7], a[84:87], v[60:63]
    buffer_load_dwordx4 v225, s[52:55], s8 offen offset:1024  lds
    v_mfma_f32_16x16x32_bf16 v[116:119], a[0:3], a[72:75], v[116:119]
    ds_read_b64_tr_b16 a[28:29], v229 offset:57408
    v_mfma_f32_16x16x32_bf16 v[116:119], a[4:7], a[88:91], v[116:119]
    v_mfma_f32_16x16x32_bf16 v[172:175], a[0:3], a[76:79], v[172:175]
    ds_read_b64_tr_b16 a[30:31], v229 offset:59200
    v_mfma_f32_16x16x32_bf16 v[172:175], a[4:7], a[92:95], v[172:175]
    s_waitcnt lgkmcnt(8)
    v_mfma_f32_16x16x32_bf16 v[32:35], a[8:11], a[64:67], v[32:35]
    ds_read_b64_tr_b16 a[0:1], v229 offset:32864
    v_mfma_f32_16x16x32_bf16 v[32:35], a[12:15], a[80:83], v[32:35]
    buffer_load_dwordx4 v226, s[52:55], s8 offen offset:2048  lds
    v_mfma_f32_16x16x32_bf16 v[88:91], a[8:11], a[68:71], v[88:91]
    ds_read_b64_tr_b16 a[2:3], v229 offset:34656
    v_mfma_f32_16x16x32_bf16 v[88:91], a[12:15], a[84:87], v[88:91]
    v_mfma_f32_16x16x32_bf16 v[144:147], a[8:11], a[72:75], v[144:147]
    ds_read_b64_tr_b16 a[4:5], v229 offset:49248
    v_mfma_f32_16x16x32_bf16 v[144:147], a[12:15], a[88:91], v[144:147]
    v_mfma_f32_16x16x32_bf16 v[200:203], a[8:11], a[76:79], v[200:203]
    ds_read_b64_tr_b16 a[6:7], v229 offset:51040
    v_mfma_f32_16x16x32_bf16 v[200:203], a[12:15], a[92:95], v[200:203]
    buffer_load_dwordx4 v227, s[52:55], s8 offen offset:3072  lds
    s_mov_b32 s9, 3014656
    s_waitcnt lgkmcnt(8)
    v_mfma_f32_16x16x32_bf16 v[8:11], a[16:19], a[64:67], v[8:11]
    ds_read_b64_tr_b16 a[8:9], v229 offset:41056
    v_mfma_f32_16x16x32_bf16 v[8:11], a[20:23], a[80:83], v[8:11]
    v_mfma_f32_16x16x32_bf16 v[64:67], a[16:19], a[68:71], v[64:67]
    ds_read_b64_tr_b16 a[10:11], v229 offset:42848
    v_mfma_f32_16x16x32_bf16 v[64:67], a[20:23], a[84:87], v[64:67]
    v_mfma_f32_16x16x32_bf16 v[120:123], a[16:19], a[72:75], v[120:123]
    ds_read_b64_tr_b16 a[12:13], v229 offset:57440
    v_mfma_f32_16x16x32_bf16 v[120:123], a[20:23], a[88:91], v[120:123]
    buffer_load_dwordx4 a[144:147], v228, s[44:47], s9 offen offset:0 sc1
    v_mfma_f32_16x16x32_bf16 v[176:179], a[16:19], a[76:79], v[176:179]
    ds_read_b64_tr_b16 a[14:15], v229 offset:59232
    v_mfma_f32_16x16x32_bf16 v[176:179], a[20:23], a[92:95], v[176:179]
    s_waitcnt lgkmcnt(8)
    v_mfma_f32_16x16x32_bf16 v[36:39], a[24:27], a[64:67], v[36:39]
    ds_read_b64_tr_b16 a[16:17], v229 offset:32896
    v_mfma_f32_16x16x32_bf16 v[36:39], a[28:31], a[80:83], v[36:39]
    v_mfma_f32_16x16x32_bf16 v[92:95], a[24:27], a[68:71], v[92:95]
    ds_read_b64_tr_b16 a[18:19], v229 offset:34688
    v_mfma_f32_16x16x32_bf16 v[92:95], a[28:31], a[84:87], v[92:95]
    buffer_load_dwordx4 a[148:151], v228, s[44:47], s9 offen offset:1024 sc1
    v_mfma_f32_16x16x32_bf16 v[148:151], a[24:27], a[72:75], v[148:151]
    ds_read_b64_tr_b16 a[20:21], v229 offset:49280
    v_mfma_f32_16x16x32_bf16 v[148:151], a[28:31], a[88:91], v[148:151]
    v_mfma_f32_16x16x32_bf16 v[204:207], a[24:27], a[76:79], v[204:207]
    ds_read_b64_tr_b16 a[22:23], v229 offset:51072
    v_mfma_f32_16x16x32_bf16 v[204:207], a[28:31], a[92:95], v[204:207]
    s_waitcnt lgkmcnt(8)
    v_mfma_f32_16x16x32_bf16 v[12:15], a[0:3], a[64:67], v[12:15]
    ds_read_b64_tr_b16 a[24:25], v229 offset:41088
    v_mfma_f32_16x16x32_bf16 v[12:15], a[4:7], a[80:83], v[12:15]
    buffer_load_dwordx4 a[152:155], v228, s[44:47], s9 offen offset:2048 sc1
    v_mfma_f32_16x16x32_bf16 v[68:71], a[0:3], a[68:71], v[68:71]
    ds_read_b64_tr_b16 a[26:27], v229 offset:42880
    v_mfma_f32_16x16x32_bf16 v[68:71], a[4:7], a[84:87], v[68:71]
    v_mfma_f32_16x16x32_bf16 v[124:127], a[0:3], a[72:75], v[124:127]
    ds_read_b64_tr_b16 a[28:29], v229 offset:57472
    v_mfma_f32_16x16x32_bf16 v[124:127], a[4:7], a[88:91], v[124:127]
    v_mfma_f32_16x16x32_bf16 v[180:183], a[0:3], a[76:79], v[180:183]
    ds_read_b64_tr_b16 a[30:31], v229 offset:59264
    v_mfma_f32_16x16x32_bf16 v[180:183], a[4:7], a[92:95], v[180:183]
    buffer_load_dwordx4 a[156:159], v228, s[44:47], s9 offen offset:3072 sc1
    s_mov_b32 s16, 6881280
    s_waitcnt lgkmcnt(8)
    v_mfma_f32_16x16x32_bf16 v[40:43], a[8:11], a[64:67], v[40:43]
    ds_read_b64_tr_b16 a[0:1], v229 offset:32928
    v_mfma_f32_16x16x32_bf16 v[40:43], a[12:15], a[80:83], v[40:43]
    v_mfma_f32_16x16x32_bf16 v[96:99], a[8:11], a[68:71], v[96:99]
    ds_read_b64_tr_b16 a[2:3], v229 offset:34720
    v_mfma_f32_16x16x32_bf16 v[96:99], a[12:15], a[84:87], v[96:99]
    v_mfma_f32_16x16x32_bf16 v[152:155], a[8:11], a[72:75], v[152:155]
    ds_read_b64_tr_b16 a[4:5], v229 offset:49312
    v_mfma_f32_16x16x32_bf16 v[152:155], a[12:15], a[88:91], v[152:155]
    buffer_load_dword a255, v232, s[52:55], s16 offen
    s_mov_b32 s16, 3072
    v_mfma_f32_16x16x32_bf16 v[208:211], a[8:11], a[76:79], v[208:211]
    ds_read_b64_tr_b16 a[6:7], v229 offset:51104
    v_mfma_f32_16x16x32_bf16 v[208:211], a[12:15], a[92:95], v[208:211]
    s_waitcnt lgkmcnt(8)
    v_mfma_f32_16x16x32_bf16 v[16:19], a[16:19], a[64:67], v[16:19]
    ds_read_b64_tr_b16 a[8:9], v229 offset:41120
    v_mfma_f32_16x16x32_bf16 v[16:19], a[20:23], a[80:83], v[16:19]
    v_mfma_f32_16x16x32_bf16 v[72:75], a[16:19], a[68:71], v[72:75]
    ds_read_b64_tr_b16 a[10:11], v229 offset:42912
    v_mfma_f32_16x16x32_bf16 v[72:75], a[20:23], a[84:87], v[72:75]
    buffer_store_dwordx4 v[236:239], v233, s[40:43], s16 offen sc1
    s_mov_b32 s9, 3145728
    v_mfma_f32_16x16x32_bf16 v[128:131], a[16:19], a[72:75], v[128:131]
    ds_read_b64_tr_b16 a[12:13], v229 offset:57504
    v_mfma_f32_16x16x32_bf16 v[128:131], a[20:23], a[88:91], v[128:131]
    v_mfma_f32_16x16x32_bf16 v[184:187], a[16:19], a[76:79], v[184:187]
    ds_read_b64_tr_b16 a[14:15], v229 offset:59296
    v_mfma_f32_16x16x32_bf16 v[184:187], a[20:23], a[92:95], v[184:187]
    s_waitcnt lgkmcnt(8)
    v_mfma_f32_16x16x32_bf16 v[44:47], a[24:27], a[64:67], v[44:47]
    ds_read_b64_tr_b16 a[16:17], v229 offset:32960
    v_mfma_f32_16x16x32_bf16 v[44:47], a[28:31], a[80:83], v[44:47]
    buffer_load_dwordx4 a[32:35], v228, s[44:47], s9 offen offset:0 sc1
    v_mfma_f32_16x16x32_bf16 v[100:103], a[24:27], a[68:71], v[100:103]
    ds_read_b64_tr_b16 a[18:19], v229 offset:34752
    v_mfma_f32_16x16x32_bf16 v[100:103], a[28:31], a[84:87], v[100:103]
    v_mfma_f32_16x16x32_bf16 v[156:159], a[24:27], a[72:75], v[156:159]
    ds_read_b64_tr_b16 a[20:21], v229 offset:49344
    v_mfma_f32_16x16x32_bf16 v[156:159], a[28:31], a[88:91], v[156:159]
    v_mfma_f32_16x16x32_bf16 v[212:215], a[24:27], a[76:79], v[212:215]
    ds_read_b64_tr_b16 a[22:23], v229 offset:51136
    v_mfma_f32_16x16x32_bf16 v[212:215], a[28:31], a[92:95], v[212:215]
    buffer_load_dwordx4 a[36:39], v228, s[44:47], s9 offen offset:1024 sc1
    s_waitcnt lgkmcnt(8)
    v_mfma_f32_16x16x32_bf16 v[20:23], a[0:3], a[64:67], v[20:23]
    ds_read_b64_tr_b16 a[24:25], v229 offset:41152
    v_mfma_f32_16x16x32_bf16 v[20:23], a[4:7], a[80:83], v[20:23]
    v_mfma_f32_16x16x32_bf16 v[76:79], a[0:3], a[68:71], v[76:79]
    ds_read_b64_tr_b16 a[26:27], v229 offset:42944
    v_mfma_f32_16x16x32_bf16 v[76:79], a[4:7], a[84:87], v[76:79]
    v_mfma_f32_16x16x32_bf16 v[132:135], a[0:3], a[72:75], v[132:135]
    ds_read_b64_tr_b16 a[28:29], v229 offset:57536
    v_mfma_f32_16x16x32_bf16 v[132:135], a[4:7], a[88:91], v[132:135]
    buffer_load_dwordx4 a[40:43], v228, s[44:47], s9 offen offset:2048 sc1
    v_mfma_f32_16x16x32_bf16 v[188:191], a[0:3], a[76:79], v[188:191]
    ds_read_b64_tr_b16 a[30:31], v229 offset:59328
    v_mfma_f32_16x16x32_bf16 v[188:191], a[4:7], a[92:95], v[188:191]
    s_waitcnt vmcnt(26) lgkmcnt(8)
    s_barrier
    v_mfma_f32_16x16x32_bf16 v[48:51], a[8:11], a[64:67], v[48:51]
    ds_read_b64_tr_b16 a[0:1], v230 offset:0
    v_mfma_f32_16x16x32_bf16 v[48:51], a[12:15], a[80:83], v[48:51]
    s_branch L_fused_kernel_pc7
L_fused_kernel_isl0_7:
    s_branch L_fused_kernel_isl0_11
L_fused_kernel_pc7:
    v_mfma_f32_16x16x32_bf16 v[104:107], a[8:11], a[68:71], v[104:107]
    ds_read_b64_tr_b16 a[2:3], v230 offset:1792
    v_mfma_f32_16x16x32_bf16 v[104:107], a[12:15], a[84:87], v[104:107]
    buffer_load_dwordx4 a[44:47], v228, s[44:47], s9 offen offset:3072 sc1
    s_add_u32 s8, s7, 5505024
    s_add_u32 m0, s6, 0
    v_mfma_f32_16x16x32_bf16 v[160:163], a[8:11], a[72:75], v[160:163]
    ds_read_b64_tr_b16 a[4:5], v230 offset:16384
    v_mfma_f32_16x16x32_bf16 v[160:163], a[12:15], a[88:91], v[160:163]
    v_mfma_f32_16x16x32_bf16 v[216:219], a[8:11], a[76:79], v[216:219]
    ds_read_b64_tr_b16 a[6:7], v230 offset:18176
    v_mfma_f32_16x16x32_bf16 v[216:219], a[12:15], a[92:95], v[216:219]
    s_waitcnt lgkmcnt(8)
    v_mfma_f32_16x16x32_bf16 v[24:27], a[16:19], a[64:67], v[24:27]
    ds_read_b64_tr_b16 a[8:9], v230 offset:8192
    v_mfma_f32_16x16x32_bf16 v[24:27], a[20:23], a[80:83], v[24:27]
    buffer_load_dwordx4 v224, s[52:55], s8 offen offset:0  lds
    v_mfma_f32_16x16x32_bf16 v[80:83], a[16:19], a[68:71], v[80:83]
    ds_read_b64_tr_b16 a[10:11], v230 offset:9984
    v_mfma_f32_16x16x32_bf16 v[80:83], a[20:23], a[84:87], v[80:83]
    v_mfma_f32_16x16x32_bf16 v[136:139], a[16:19], a[72:75], v[136:139]
    ds_read_b64_tr_b16 a[12:13], v230 offset:24576
    v_mfma_f32_16x16x32_bf16 v[136:139], a[20:23], a[88:91], v[136:139]
    v_mfma_f32_16x16x32_bf16 v[192:195], a[16:19], a[76:79], v[192:195]
    ds_read_b64_tr_b16 a[14:15], v230 offset:26368
    v_mfma_f32_16x16x32_bf16 v[192:195], a[20:23], a[92:95], v[192:195]
    buffer_load_dwordx4 v225, s[52:55], s8 offen offset:1024  lds
    s_waitcnt lgkmcnt(8)
    v_mfma_f32_16x16x32_bf16 v[52:55], a[24:27], a[64:67], v[52:55]
    ds_read_b64_tr_b16 a[16:17], v230 offset:32
    v_mfma_f32_16x16x32_bf16 v[52:55], a[28:31], a[80:83], v[52:55]
    v_mfma_f32_16x16x32_bf16 v[108:111], a[24:27], a[68:71], v[108:111]
    ds_read_b64_tr_b16 a[18:19], v230 offset:1824
    v_mfma_f32_16x16x32_bf16 v[108:111], a[28:31], a[84:87], v[108:111]
    v_mfma_f32_16x16x32_bf16 v[164:167], a[24:27], a[72:75], v[164:167]
    ds_read_b64_tr_b16 a[20:21], v230 offset:16416
    v_mfma_f32_16x16x32_bf16 v[164:167], a[28:31], a[88:91], v[164:167]
    buffer_load_dwordx4 v226, s[52:55], s8 offen offset:2048  lds
    v_mfma_f32_16x16x32_bf16 v[220:223], a[24:27], a[76:79], v[220:223]
    ds_read_b64_tr_b16 a[22:23], v230 offset:18208
    v_mfma_f32_16x16x32_bf16 v[220:223], a[28:31], a[92:95], v[220:223]
    s_waitcnt vmcnt(25) lgkmcnt(8)
    v_mfma_f32_16x16x32_bf16 v[0:3], a[0:3], a[96:99], v[0:3]
    ds_read_b64_tr_b16 a[24:25], v230 offset:8224
    v_mfma_f32_16x16x32_bf16 v[0:3], a[4:7], a[112:115], v[0:3]
    v_mfma_f32_16x16x32_bf16 v[56:59], a[0:3], a[100:103], v[56:59]
    ds_read_b64_tr_b16 a[26:27], v230 offset:10016
    v_mfma_f32_16x16x32_bf16 v[56:59], a[4:7], a[116:119], v[56:59]
    buffer_load_dwordx4 v227, s[52:55], s8 offen offset:3072  lds
    s_add_u32 s8, s7, 5734400
    s_add_u32 m0, s6, 16384
    v_mfma_f32_16x16x32_bf16 v[112:115], a[0:3], a[104:107], v[112:115]
    ds_read_b64_tr_b16 a[28:29], v230 offset:24608
    v_mfma_f32_16x16x32_bf16 v[112:115], a[4:7], a[120:123], v[112:115]
    v_mfma_f32_16x16x32_bf16 v[168:171], a[0:3], a[108:111], v[168:171]
    ds_read_b64_tr_b16 a[30:31], v230 offset:26400
    v_mfma_f32_16x16x32_bf16 v[168:171], a[4:7], a[124:127], v[168:171]
    s_waitcnt lgkmcnt(8)
    v_mfma_f32_16x16x32_bf16 v[28:31], a[8:11], a[96:99], v[28:31]
    ds_read_b64_tr_b16 a[0:1], v230 offset:64
    v_mfma_f32_16x16x32_bf16 v[28:31], a[12:15], a[112:115], v[28:31]
    buffer_load_dwordx4 v224, s[52:55], s8 offen offset:0  lds
    v_mfma_f32_16x16x32_bf16 v[84:87], a[8:11], a[100:103], v[84:87]
    ds_read_b64_tr_b16 a[2:3], v230 offset:1856
    v_mfma_f32_16x16x32_bf16 v[84:87], a[12:15], a[116:119], v[84:87]
    v_mfma_f32_16x16x32_bf16 v[140:143], a[8:11], a[104:107], v[140:143]
    ds_read_b64_tr_b16 a[4:5], v230 offset:16448
    v_mfma_f32_16x16x32_bf16 v[140:143], a[12:15], a[120:123], v[140:143]
    v_mfma_f32_16x16x32_bf16 v[196:199], a[8:11], a[108:111], v[196:199]
    ds_read_b64_tr_b16 a[6:7], v230 offset:18240
    v_mfma_f32_16x16x32_bf16 v[196:199], a[12:15], a[124:127], v[196:199]
    buffer_load_dwordx4 v225, s[52:55], s8 offen offset:1024  lds
    s_waitcnt lgkmcnt(8)
    v_mfma_f32_16x16x32_bf16 v[4:7], a[16:19], a[96:99], v[4:7]
    ds_read_b64_tr_b16 a[8:9], v230 offset:8256
    v_mfma_f32_16x16x32_bf16 v[4:7], a[20:23], a[112:115], v[4:7]
    v_mfma_f32_16x16x32_bf16 v[60:63], a[16:19], a[100:103], v[60:63]
    ds_read_b64_tr_b16 a[10:11], v230 offset:10048
    v_mfma_f32_16x16x32_bf16 v[60:63], a[20:23], a[116:119], v[60:63]
    v_mfma_f32_16x16x32_bf16 v[116:119], a[16:19], a[104:107], v[116:119]
    ds_read_b64_tr_b16 a[12:13], v230 offset:24640
    v_mfma_f32_16x16x32_bf16 v[116:119], a[20:23], a[120:123], v[116:119]
    buffer_load_dwordx4 v226, s[52:55], s8 offen offset:2048  lds
    v_mfma_f32_16x16x32_bf16 v[172:175], a[16:19], a[108:111], v[172:175]
    ds_read_b64_tr_b16 a[14:15], v230 offset:26432
    v_mfma_f32_16x16x32_bf16 v[172:175], a[20:23], a[124:127], v[172:175]
    s_waitcnt lgkmcnt(8)
    v_mfma_f32_16x16x32_bf16 v[32:35], a[24:27], a[96:99], v[32:35]
    ds_read_b64_tr_b16 a[16:17], v230 offset:96
    v_mfma_f32_16x16x32_bf16 v[32:35], a[28:31], a[112:115], v[32:35]
    v_mfma_f32_16x16x32_bf16 v[88:91], a[24:27], a[100:103], v[88:91]
    ds_read_b64_tr_b16 a[18:19], v230 offset:1888
    v_mfma_f32_16x16x32_bf16 v[88:91], a[28:31], a[116:119], v[88:91]
    buffer_load_dwordx4 v227, s[52:55], s8 offen offset:3072  lds
    s_mov_b32 s9, 3276800
    v_mfma_f32_16x16x32_bf16 v[144:147], a[24:27], a[104:107], v[144:147]
    ds_read_b64_tr_b16 a[20:21], v230 offset:16480
    v_mfma_f32_16x16x32_bf16 v[144:147], a[28:31], a[120:123], v[144:147]
    v_mfma_f32_16x16x32_bf16 v[200:203], a[24:27], a[108:111], v[200:203]
    ds_read_b64_tr_b16 a[22:23], v230 offset:18272
    v_mfma_f32_16x16x32_bf16 v[200:203], a[28:31], a[124:127], v[200:203]
    s_waitcnt lgkmcnt(8)
    v_mfma_f32_16x16x32_bf16 v[8:11], a[0:3], a[96:99], v[8:11]
    ds_read_b64_tr_b16 a[24:25], v230 offset:8288
    v_mfma_f32_16x16x32_bf16 v[8:11], a[4:7], a[112:115], v[8:11]
    buffer_load_dwordx4 a[48:51], v228, s[44:47], s9 offen offset:0 sc1
    v_mfma_f32_16x16x32_bf16 v[64:67], a[0:3], a[100:103], v[64:67]
    ds_read_b64_tr_b16 a[26:27], v230 offset:10080
    v_mfma_f32_16x16x32_bf16 v[64:67], a[4:7], a[116:119], v[64:67]
    v_mfma_f32_16x16x32_bf16 v[120:123], a[0:3], a[104:107], v[120:123]
    ds_read_b64_tr_b16 a[28:29], v230 offset:24672
    v_mfma_f32_16x16x32_bf16 v[120:123], a[4:7], a[120:123], v[120:123]
    v_mfma_f32_16x16x32_bf16 v[176:179], a[0:3], a[108:111], v[176:179]
    ds_read_b64_tr_b16 a[30:31], v230 offset:26464
    v_mfma_f32_16x16x32_bf16 v[176:179], a[4:7], a[124:127], v[176:179]
    buffer_load_dwordx4 a[52:55], v228, s[44:47], s9 offen offset:1024 sc1
    s_waitcnt lgkmcnt(8)
    v_mfma_f32_16x16x32_bf16 v[36:39], a[8:11], a[96:99], v[36:39]
    ds_read_b64_tr_b16 a[0:1], v230 offset:128
    v_mfma_f32_16x16x32_bf16 v[36:39], a[12:15], a[112:115], v[36:39]
    v_mfma_f32_16x16x32_bf16 v[92:95], a[8:11], a[100:103], v[92:95]
    ds_read_b64_tr_b16 a[2:3], v230 offset:1920
    v_mfma_f32_16x16x32_bf16 v[92:95], a[12:15], a[116:119], v[92:95]
    v_mfma_f32_16x16x32_bf16 v[148:151], a[8:11], a[104:107], v[148:151]
    ds_read_b64_tr_b16 a[4:5], v230 offset:16512
    v_mfma_f32_16x16x32_bf16 v[148:151], a[12:15], a[120:123], v[148:151]
    buffer_load_dwordx4 a[56:59], v228, s[44:47], s9 offen offset:2048 sc1
    v_mfma_f32_16x16x32_bf16 v[204:207], a[8:11], a[108:111], v[204:207]
    ds_read_b64_tr_b16 a[6:7], v230 offset:18304
    v_mfma_f32_16x16x32_bf16 v[204:207], a[12:15], a[124:127], v[204:207]
    s_waitcnt lgkmcnt(8)
    v_mfma_f32_16x16x32_bf16 v[12:15], a[16:19], a[96:99], v[12:15]
    ds_read_b64_tr_b16 a[8:9], v230 offset:8320
    v_mfma_f32_16x16x32_bf16 v[12:15], a[20:23], a[112:115], v[12:15]
    v_mfma_f32_16x16x32_bf16 v[68:71], a[16:19], a[100:103], v[68:71]
    ds_read_b64_tr_b16 a[10:11], v230 offset:10112
    v_mfma_f32_16x16x32_bf16 v[68:71], a[20:23], a[116:119], v[68:71]
    buffer_load_dwordx4 a[60:63], v228, s[44:47], s9 offen offset:3072 sc1
    s_mov_b32 s9, 3407872
    v_mfma_f32_16x16x32_bf16 v[124:127], a[16:19], a[104:107], v[124:127]
    ds_read_b64_tr_b16 a[12:13], v230 offset:24704
    v_mfma_f32_16x16x32_bf16 v[124:127], a[20:23], a[120:123], v[124:127]
    v_mfma_f32_16x16x32_bf16 v[180:183], a[16:19], a[108:111], v[180:183]
    ds_read_b64_tr_b16 a[14:15], v230 offset:26496
    v_mfma_f32_16x16x32_bf16 v[180:183], a[20:23], a[124:127], v[180:183]
    s_waitcnt lgkmcnt(8)
    v_mfma_f32_16x16x32_bf16 v[40:43], a[24:27], a[96:99], v[40:43]
    ds_read_b64_tr_b16 a[16:17], v230 offset:160
    v_mfma_f32_16x16x32_bf16 v[40:43], a[28:31], a[112:115], v[40:43]
    buffer_load_dwordx4 a[64:67], v228, s[44:47], s9 offen offset:0 sc1
    v_mfma_f32_16x16x32_bf16 v[96:99], a[24:27], a[100:103], v[96:99]
    ds_read_b64_tr_b16 a[18:19], v230 offset:1952
    v_mfma_f32_16x16x32_bf16 v[96:99], a[28:31], a[116:119], v[96:99]
    v_mfma_f32_16x16x32_bf16 v[152:155], a[24:27], a[104:107], v[152:155]
    ds_read_b64_tr_b16 a[20:21], v230 offset:16544
    v_mfma_f32_16x16x32_bf16 v[152:155], a[28:31], a[120:123], v[152:155]
    v_mfma_f32_16x16x32_bf16 v[208:211], a[24:27], a[108:111], v[208:211]
    ds_read_b64_tr_b16 a[22:23], v230 offset:18336
    v_mfma_f32_16x16x32_bf16 v[208:211], a[28:31], a[124:127], v[208:211]
    buffer_load_dwordx4 a[68:71], v228, s[44:47], s9 offen offset:1024 sc1
    s_waitcnt lgkmcnt(8)
    v_mfma_f32_16x16x32_bf16 v[16:19], a[0:3], a[96:99], v[16:19]
    ds_read_b64_tr_b16 a[24:25], v230 offset:8352
    v_mfma_f32_16x16x32_bf16 v[16:19], a[4:7], a[112:115], v[16:19]
    v_mfma_f32_16x16x32_bf16 v[72:75], a[0:3], a[100:103], v[72:75]
    ds_read_b64_tr_b16 a[26:27], v230 offset:10144
    v_mfma_f32_16x16x32_bf16 v[72:75], a[4:7], a[116:119], v[72:75]
    v_mfma_f32_16x16x32_bf16 v[128:131], a[0:3], a[104:107], v[128:131]
    ds_read_b64_tr_b16 a[28:29], v230 offset:24736
    v_mfma_f32_16x16x32_bf16 v[128:131], a[4:7], a[120:123], v[128:131]
    buffer_load_dwordx4 a[72:75], v228, s[44:47], s9 offen offset:2048 sc1
    v_mfma_f32_16x16x32_bf16 v[184:187], a[0:3], a[108:111], v[184:187]
    ds_read_b64_tr_b16 a[30:31], v230 offset:26528
    v_mfma_f32_16x16x32_bf16 v[184:187], a[4:7], a[124:127], v[184:187]
    s_waitcnt lgkmcnt(8)
    v_mfma_f32_16x16x32_bf16 v[44:47], a[8:11], a[96:99], v[44:47]
    ds_read_b64_tr_b16 a[0:1], v230 offset:192
    v_mfma_f32_16x16x32_bf16 v[44:47], a[12:15], a[112:115], v[44:47]
    v_mfma_f32_16x16x32_bf16 v[100:103], a[8:11], a[100:103], v[100:103]
    ds_read_b64_tr_b16 a[2:3], v230 offset:1984
    v_mfma_f32_16x16x32_bf16 v[100:103], a[12:15], a[116:119], v[100:103]
    buffer_load_dwordx4 a[76:79], v228, s[44:47], s9 offen offset:3072 sc1
    s_mov_b32 s9, 3538944
    v_mfma_f32_16x16x32_bf16 v[156:159], a[8:11], a[104:107], v[156:159]
    ds_read_b64_tr_b16 a[4:5], v230 offset:16576
    v_mfma_f32_16x16x32_bf16 v[156:159], a[12:15], a[120:123], v[156:159]
    v_mfma_f32_16x16x32_bf16 v[212:215], a[8:11], a[108:111], v[212:215]
    ds_read_b64_tr_b16 a[6:7], v230 offset:18368
    v_mfma_f32_16x16x32_bf16 v[212:215], a[12:15], a[124:127], v[212:215]
    s_waitcnt lgkmcnt(8)
    v_mfma_f32_16x16x32_bf16 v[20:23], a[16:19], a[96:99], v[20:23]
    ds_read_b64_tr_b16 a[8:9], v230 offset:8384
    v_mfma_f32_16x16x32_bf16 v[20:23], a[20:23], a[112:115], v[20:23]
    buffer_load_dwordx4 a[80:83], v228, s[44:47], s9 offen offset:0 sc1
    v_mfma_f32_16x16x32_bf16 v[76:79], a[16:19], a[100:103], v[76:79]
    ds_read_b64_tr_b16 a[10:11], v230 offset:10176
    v_mfma_f32_16x16x32_bf16 v[76:79], a[20:23], a[116:119], v[76:79]
    v_mfma_f32_16x16x32_bf16 v[132:135], a[16:19], a[104:107], v[132:135]
    ds_read_b64_tr_b16 a[12:13], v230 offset:24768
    v_mfma_f32_16x16x32_bf16 v[132:135], a[20:23], a[120:123], v[132:135]
    v_mfma_f32_16x16x32_bf16 v[188:191], a[16:19], a[108:111], v[188:191]
    ds_read_b64_tr_b16 a[14:15], v230 offset:26560
    v_mfma_f32_16x16x32_bf16 v[188:191], a[20:23], a[124:127], v[188:191]
    buffer_load_dwordx4 a[84:87], v228, s[44:47], s9 offen offset:1024 sc1
    s_waitcnt vmcnt(28) lgkmcnt(8)
    s_barrier
    v_mfma_f32_16x16x32_bf16 v[48:51], a[24:27], a[96:99], v[48:51]
    ds_read_b64_tr_b16 a[16:17], v230 offset:32768
    v_mfma_f32_16x16x32_bf16 v[48:51], a[28:31], a[112:115], v[48:51]
    v_mfma_f32_16x16x32_bf16 v[104:107], a[24:27], a[100:103], v[104:107]
    ds_read_b64_tr_b16 a[18:19], v230 offset:34560
    v_mfma_f32_16x16x32_bf16 v[104:107], a[28:31], a[116:119], v[104:107]
    v_mfma_f32_16x16x32_bf16 v[160:163], a[24:27], a[104:107], v[160:163]
    ds_read_b64_tr_b16 a[20:21], v230 offset:49152
    v_mfma_f32_16x16x32_bf16 v[160:163], a[28:31], a[120:123], v[160:163]
    buffer_load_dwordx4 a[88:91], v228, s[44:47], s9 offen offset:2048 sc1
    v_mfma_f32_16x16x32_bf16 v[216:219], a[24:27], a[108:111], v[216:219]
    ds_read_b64_tr_b16 a[22:23], v230 offset:50944
    v_mfma_f32_16x16x32_bf16 v[216:219], a[28:31], a[124:127], v[216:219]
    s_waitcnt lgkmcnt(8)
    v_mfma_f32_16x16x32_bf16 v[24:27], a[0:3], a[96:99], v[24:27]
    ds_read_b64_tr_b16 a[24:25], v230 offset:40960
    v_mfma_f32_16x16x32_bf16 v[24:27], a[4:7], a[112:115], v[24:27]
    v_mfma_f32_16x16x32_bf16 v[80:83], a[0:3], a[100:103], v[80:83]
    ds_read_b64_tr_b16 a[26:27], v230 offset:42752
    v_mfma_f32_16x16x32_bf16 v[80:83], a[4:7], a[116:119], v[80:83]
    buffer_load_dwordx4 a[92:95], v228, s[44:47], s9 offen offset:3072 sc1
    s_add_u32 s8, s7, 5963776
    s_add_u32 m0, s6, 32768
    v_mfma_f32_16x16x32_bf16 v[136:139], a[0:3], a[104:107], v[136:139]
    ds_read_b64_tr_b16 a[28:29], v230 offset:57344
    v_mfma_f32_16x16x32_bf16 v[136:139], a[4:7], a[120:123], v[136:139]
    v_mfma_f32_16x16x32_bf16 v[192:195], a[0:3], a[108:111], v[192:195]
    ds_read_b64_tr_b16 a[30:31], v230 offset:59136
    v_mfma_f32_16x16x32_bf16 v[192:195], a[4:7], a[124:127], v[192:195]
    s_waitcnt lgkmcnt(8)
    v_mfma_f32_16x16x32_bf16 v[52:55], a[8:11], a[96:99], v[52:55]
    ds_read_b64_tr_b16 a[0:1], v230 offset:32800
    v_mfma_f32_16x16x32_bf16 v[52:55], a[12:15], a[112:115], v[52:55]
    buffer_load_dwordx4 v224, s[52:55], s8 offen offset:0  lds
    v_mfma_f32_16x16x32_bf16 v[108:111], a[8:11], a[100:103], v[108:111]
    ds_read_b64_tr_b16 a[2:3], v230 offset:34592
    v_mfma_f32_16x16x32_bf16 v[108:111], a[12:15], a[116:119], v[108:111]
    v_mfma_f32_16x16x32_bf16 v[164:167], a[8:11], a[104:107], v[164:167]
    ds_read_b64_tr_b16 a[4:5], v230 offset:49184
    v_mfma_f32_16x16x32_bf16 v[164:167], a[12:15], a[120:123], v[164:167]
    v_mfma_f32_16x16x32_bf16 v[220:223], a[8:11], a[108:111], v[220:223]
    ds_read_b64_tr_b16 a[6:7], v230 offset:50976
    v_mfma_f32_16x16x32_bf16 v[220:223], a[12:15], a[124:127], v[220:223]
    buffer_load_dwordx4 v225, s[52:55], s8 offen offset:1024  lds
    s_waitcnt vmcnt(28) lgkmcnt(8)
    v_mfma_f32_16x16x32_bf16 v[0:3], a[16:19], a[128:131], v[0:3]
    ds_read_b64_tr_b16 a[8:9], v230 offset:40992
    v_mfma_f32_16x16x32_bf16 v[0:3], a[20:23], a[144:147], v[0:3]
    v_mfma_f32_16x16x32_bf16 v[56:59], a[16:19], a[132:135], v[56:59]
    ds_read_b64_tr_b16 a[10:11], v230 offset:42784
    v_mfma_f32_16x16x32_bf16 v[56:59], a[20:23], a[148:151], v[56:59]
    v_mfma_f32_16x16x32_bf16 v[112:115], a[16:19], a[136:139], v[112:115]
    ds_read_b64_tr_b16 a[12:13], v230 offset:57376
    v_mfma_f32_16x16x32_bf16 v[112:115], a[20:23], a[152:155], v[112:115]
    buffer_load_dwordx4 v226, s[52:55], s8 offen offset:2048  lds
    v_mfma_f32_16x16x32_bf16 v[168:171], a[16:19], a[140:143], v[168:171]
    ds_read_b64_tr_b16 a[14:15], v230 offset:59168
    v_mfma_f32_16x16x32_bf16 v[168:171], a[20:23], a[156:159], v[168:171]
    s_waitcnt lgkmcnt(8)
    v_mfma_f32_16x16x32_bf16 v[28:31], a[24:27], a[128:131], v[28:31]
    ds_read_b64_tr_b16 a[16:17], v230 offset:32832
    v_mfma_f32_16x16x32_bf16 v[28:31], a[28:31], a[144:147], v[28:31]
    v_mfma_f32_16x16x32_bf16 v[84:87], a[24:27], a[132:135], v[84:87]
    ds_read_b64_tr_b16 a[18:19], v230 offset:34624
    v_mfma_f32_16x16x32_bf16 v[84:87], a[28:31], a[148:151], v[84:87]
    buffer_load_dwordx4 v227, s[52:55], s8 offen offset:3072  lds
    s_add_u32 s8, s7, 6193152
    s_add_u32 m0, s6, 49152
    v_mfma_f32_16x16x32_bf16 v[140:143], a[24:27], a[136:139], v[140:143]
    ds_read_b64_tr_b16 a[20:21], v230 offset:49216
    v_mfma_f32_16x16x32_bf16 v[140:143], a[28:31], a[152:155], v[140:143]
    v_mfma_f32_16x16x32_bf16 v[196:199], a[24:27], a[140:143], v[196:199]
    ds_read_b64_tr_b16 a[22:23], v230 offset:51008
    v_mfma_f32_16x16x32_bf16 v[196:199], a[28:31], a[156:159], v[196:199]
    s_waitcnt lgkmcnt(8)
    v_mfma_f32_16x16x32_bf16 v[4:7], a[0:3], a[128:131], v[4:7]
    ds_read_b64_tr_b16 a[24:25], v230 offset:41024
    v_mfma_f32_16x16x32_bf16 v[4:7], a[4:7], a[144:147], v[4:7]
    buffer_load_dwordx4 v224, s[52:55], s8 offen offset:0  lds
    v_mfma_f32_16x16x32_bf16 v[60:63], a[0:3], a[132:135], v[60:63]
    ds_read_b64_tr_b16 a[26:27], v230 offset:42816
    v_mfma_f32_16x16x32_bf16 v[60:63], a[4:7], a[148:151], v[60:63]
    v_mfma_f32_16x16x32_bf16 v[116:119], a[0:3], a[136:139], v[116:119]
    ds_read_b64_tr_b16 a[28:29], v230 offset:57408
    v_mfma_f32_16x16x32_bf16 v[116:119], a[4:7], a[152:155], v[116:119]
    v_mfma_f32_16x16x32_bf16 v[172:175], a[0:3], a[140:143], v[172:175]
    ds_read_b64_tr_b16 a[30:31], v230 offset:59200
    v_mfma_f32_16x16x32_bf16 v[172:175], a[4:7], a[156:159], v[172:175]
    buffer_load_dwordx4 v225, s[52:55], s8 offen offset:1024  lds
    s_waitcnt lgkmcnt(8)
    v_mfma_f32_16x16x32_bf16 v[32:35], a[8:11], a[128:131], v[32:35]
    ds_read_b64_tr_b16 a[0:1], v230 offset:32864
    v_mfma_f32_16x16x32_bf16 v[32:35], a[12:15], a[144:147], v[32:35]
    v_mfma_f32_16x16x32_bf16 v[88:91], a[8:11], a[132:135], v[88:91]
    ds_read_b64_tr_b16 a[2:3], v230 offset:34656
    v_mfma_f32_16x16x32_bf16 v[88:91], a[12:15], a[148:151], v[88:91]
    v_mfma_f32_16x16x32_bf16 v[144:147], a[8:11], a[136:139], v[144:147]
    ds_read_b64_tr_b16 a[4:5], v230 offset:49248
    v_mfma_f32_16x16x32_bf16 v[144:147], a[12:15], a[152:155], v[144:147]
    buffer_load_dwordx4 v226, s[52:55], s8 offen offset:2048  lds
    v_mfma_f32_16x16x32_bf16 v[200:203], a[8:11], a[140:143], v[200:203]
    ds_read_b64_tr_b16 a[6:7], v230 offset:51040
    v_mfma_f32_16x16x32_bf16 v[200:203], a[12:15], a[156:159], v[200:203]
    s_waitcnt lgkmcnt(8)
    v_mfma_f32_16x16x32_bf16 v[8:11], a[16:19], a[128:131], v[8:11]
    ds_read_b64_tr_b16 a[8:9], v230 offset:41056
    v_mfma_f32_16x16x32_bf16 v[8:11], a[20:23], a[144:147], v[8:11]
    v_mfma_f32_16x16x32_bf16 v[64:67], a[16:19], a[132:135], v[64:67]
    ds_read_b64_tr_b16 a[10:11], v230 offset:42848
    v_mfma_f32_16x16x32_bf16 v[64:67], a[20:23], a[148:151], v[64:67]
    buffer_load_dwordx4 v227, s[52:55], s8 offen offset:3072  lds
    s_mov_b32 s9, 3670016
    v_mfma_f32_16x16x32_bf16 v[120:123], a[16:19], a[136:139], v[120:123]
    ds_read_b64_tr_b16 a[12:13], v230 offset:57440
    v_mfma_f32_16x16x32_bf16 v[120:123], a[20:23], a[152:155], v[120:123]
    v_mfma_f32_16x16x32_bf16 v[176:179], a[16:19], a[140:143], v[176:179]
    ds_read_b64_tr_b16 a[14:15], v230 offset:59232
    v_mfma_f32_16x16x32_bf16 v[176:179], a[20:23], a[156:159], v[176:179]
    s_waitcnt lgkmcnt(8)
    v_mfma_f32_16x16x32_bf16 v[36:39], a[24:27], a[128:131], v[36:39]
    ds_read_b64_tr_b16 a[16:17], v230 offset:32896
    v_mfma_f32_16x16x32_bf16 v[36:39], a[28:31], a[144:147], v[36:39]
    buffer_load_dwordx4 a[96:99], v228, s[44:47], s9 offen offset:0 sc1
    v_mfma_f32_16x16x32_bf16 v[92:95], a[24:27], a[132:135], v[92:95]
    ds_read_b64_tr_b16 a[18:19], v230 offset:34688
    v_mfma_f32_16x16x32_bf16 v[92:95], a[28:31], a[148:151], v[92:95]
    v_mfma_f32_16x16x32_bf16 v[148:151], a[24:27], a[136:139], v[148:151]
    ds_read_b64_tr_b16 a[20:21], v230 offset:49280
    v_mfma_f32_16x16x32_bf16 v[148:151], a[28:31], a[152:155], v[148:151]
    v_mfma_f32_16x16x32_bf16 v[204:207], a[24:27], a[140:143], v[204:207]
    ds_read_b64_tr_b16 a[22:23], v230 offset:51072
    v_mfma_f32_16x16x32_bf16 v[204:207], a[28:31], a[156:159], v[204:207]
    buffer_load_dwordx4 a[100:103], v228, s[44:47], s9 offen offset:1024 sc1
    s_waitcnt lgkmcnt(8)
    v_mfma_f32_16x16x32_bf16 v[12:15], a[0:3], a[128:131], v[12:15]
    ds_read_b64_tr_b16 a[24:25], v230 offset:41088
    v_mfma_f32_16x16x32_bf16 v[12:15], a[4:7], a[144:147], v[12:15]
    v_mfma_f32_16x16x32_bf16 v[68:71], a[0:3], a[132:135], v[68:71]
    ds_read_b64_tr_b16 a[26:27], v230 offset:42880
    v_mfma_f32_16x16x32_bf16 v[68:71], a[4:7], a[148:151], v[68:71]
    v_mfma_f32_16x16x32_bf16 v[124:127], a[0:3], a[136:139], v[124:127]
    ds_read_b64_tr_b16 a[28:29], v230 offset:57472
    v_mfma_f32_16x16x32_bf16 v[124:127], a[4:7], a[152:155], v[124:127]
    buffer_load_dwordx4 a[104:107], v228, s[44:47], s9 offen offset:2048 sc1
    v_mfma_f32_16x16x32_bf16 v[180:183], a[0:3], a[140:143], v[180:183]
    ds_read_b64_tr_b16 a[30:31], v230 offset:59264
    v_mfma_f32_16x16x32_bf16 v[180:183], a[4:7], a[156:159], v[180:183]
    s_waitcnt lgkmcnt(8)
    v_mfma_f32_16x16x32_bf16 v[40:43], a[8:11], a[128:131], v[40:43]
    ds_read_b64_tr_b16 a[0:1], v230 offset:32928
    v_mfma_f32_16x16x32_bf16 v[40:43], a[12:15], a[144:147], v[40:43]
    v_mfma_f32_16x16x32_bf16 v[96:99], a[8:11], a[132:135], v[96:99]
    ds_read_b64_tr_b16 a[2:3], v230 offset:34720
    v_mfma_f32_16x16x32_bf16 v[96:99], a[12:15], a[148:151], v[96:99]
    buffer_load_dwordx4 a[108:111], v228, s[44:47], s9 offen offset:3072 sc1
    s_mov_b32 s9, 3801088
    v_mfma_f32_16x16x32_bf16 v[152:155], a[8:11], a[136:139], v[152:155]
    ds_read_b64_tr_b16 a[4:5], v230 offset:49312
    v_mfma_f32_16x16x32_bf16 v[152:155], a[12:15], a[152:155], v[152:155]
    v_mfma_f32_16x16x32_bf16 v[208:211], a[8:11], a[140:143], v[208:211]
    ds_read_b64_tr_b16 a[6:7], v230 offset:51104
    v_mfma_f32_16x16x32_bf16 v[208:211], a[12:15], a[156:159], v[208:211]
    s_waitcnt lgkmcnt(8)
    v_mfma_f32_16x16x32_bf16 v[16:19], a[16:19], a[128:131], v[16:19]
    ds_read_b64_tr_b16 a[8:9], v230 offset:41120
    v_mfma_f32_16x16x32_bf16 v[16:19], a[20:23], a[144:147], v[16:19]
    buffer_load_dwordx4 a[112:115], v228, s[44:47], s9 offen offset:0 sc1
    v_mfma_f32_16x16x32_bf16 v[72:75], a[16:19], a[132:135], v[72:75]
    ds_read_b64_tr_b16 a[10:11], v230 offset:42912
    v_mfma_f32_16x16x32_bf16 v[72:75], a[20:23], a[148:151], v[72:75]
    v_mfma_f32_16x16x32_bf16 v[128:131], a[16:19], a[136:139], v[128:131]
    ds_read_b64_tr_b16 a[12:13], v230 offset:57504
    v_mfma_f32_16x16x32_bf16 v[128:131], a[20:23], a[152:155], v[128:131]
    v_mfma_f32_16x16x32_bf16 v[184:187], a[16:19], a[140:143], v[184:187]
    ds_read_b64_tr_b16 a[14:15], v230 offset:59296
    v_mfma_f32_16x16x32_bf16 v[184:187], a[20:23], a[156:159], v[184:187]
    buffer_load_dwordx4 a[116:119], v228, s[44:47], s9 offen offset:1024 sc1
    s_waitcnt lgkmcnt(8)
    v_mfma_f32_16x16x32_bf16 v[44:47], a[24:27], a[128:131], v[44:47]
    ds_read_b64_tr_b16 a[16:17], v230 offset:32960
    v_mfma_f32_16x16x32_bf16 v[44:47], a[28:31], a[144:147], v[44:47]
    v_mfma_f32_16x16x32_bf16 v[100:103], a[24:27], a[132:135], v[100:103]
    ds_read_b64_tr_b16 a[18:19], v230 offset:34752
    v_mfma_f32_16x16x32_bf16 v[100:103], a[28:31], a[148:151], v[100:103]
    v_mfma_f32_16x16x32_bf16 v[156:159], a[24:27], a[136:139], v[156:159]
    ds_read_b64_tr_b16 a[20:21], v230 offset:49344
    v_mfma_f32_16x16x32_bf16 v[156:159], a[28:31], a[152:155], v[156:159]
    buffer_load_dwordx4 a[120:123], v228, s[44:47], s9 offen offset:2048 sc1
    v_mfma_f32_16x16x32_bf16 v[212:215], a[24:27], a[140:143], v[212:215]
    ds_read_b64_tr_b16 a[22:23], v230 offset:51136
    v_mfma_f32_16x16x32_bf16 v[212:215], a[28:31], a[156:159], v[212:215]
    s_waitcnt lgkmcnt(8)
    v_mfma_f32_16x16x32_bf16 v[20:23], a[0:3], a[128:131], v[20:23]
    ds_read_b64_tr_b16 a[24:25], v230 offset:41152
    v_mfma_f32_16x16x32_bf16 v[20:23], a[4:7], a[144:147], v[20:23]
    v_mfma_f32_16x16x32_bf16 v[76:79], a[0:3], a[132:135], v[76:79]
    ds_read_b64_tr_b16 a[26:27], v230 offset:42944
    v_mfma_f32_16x16x32_bf16 v[76:79], a[4:7], a[148:151], v[76:79]
    buffer_load_dwordx4 a[124:127], v228, s[44:47], s9 offen offset:3072 sc1
    v_mfma_f32_16x16x32_bf16 v[132:135], a[0:3], a[136:139], v[132:135]
    ds_read_b64_tr_b16 a[28:29], v230 offset:57536
    v_mfma_f32_16x16x32_bf16 v[132:135], a[4:7], a[152:155], v[132:135]
    v_mfma_f32_16x16x32_bf16 v[188:191], a[0:3], a[140:143], v[188:191]
    ds_read_b64_tr_b16 a[30:31], v230 offset:59328
    v_mfma_f32_16x16x32_bf16 v[188:191], a[4:7], a[156:159], v[188:191]
    s_waitcnt vmcnt(28) lgkmcnt(0)
    s_barrier
    v_mfma_f32_16x16x32_bf16 v[48:51], a[8:11], a[128:131], v[48:51]
    ds_read_b64_tr_b16 a[0:1], v229 offset:0
    s_add_u32 s8, s7, 6422528
    v_mfma_f32_16x16x32_bf16 v[48:51], a[12:15], a[144:147], v[48:51]
    s_add_u32 m0, s6, 65536
    v_mfma_f32_16x16x32_bf16 v[104:107], a[8:11], a[132:135], v[104:107]
    ds_read_b64_tr_b16 a[2:3], v229 offset:1792
    buffer_load_dwordx4 v224, s[52:55], s8 offen offset:0  lds
    v_mfma_f32_16x16x32_bf16 v[104:107], a[12:15], a[148:151], v[104:107]
    v_mfma_f32_16x16x32_bf16 v[160:163], a[8:11], a[136:139], v[160:163]
    ds_read_b64_tr_b16 a[4:5], v229 offset:16384
    v_mfma_f32_16x16x32_bf16 v[160:163], a[12:15], a[152:155], v[160:163]
    v_mfma_f32_16x16x32_bf16 v[216:219], a[8:11], a[140:143], v[216:219]
    ds_read_b64_tr_b16 a[6:7], v229 offset:18176
    buffer_load_dwordx4 v225, s[52:55], s8 offen offset:1024  lds
    v_mfma_f32_16x16x32_bf16 v[216:219], a[12:15], a[156:159], v[216:219]
    v_mfma_f32_16x16x32_bf16 v[24:27], a[16:19], a[128:131], v[24:27]
    ds_read_b64_tr_b16 a[8:9], v229 offset:8192
    v_mfma_f32_16x16x32_bf16 v[24:27], a[20:23], a[144:147], v[24:27]
    v_mfma_f32_16x16x32_bf16 v[80:83], a[16:19], a[132:135], v[80:83]
    ds_read_b64_tr_b16 a[10:11], v229 offset:9984
    buffer_load_dwordx4 v226, s[52:55], s8 offen offset:2048  lds
    v_mfma_f32_16x16x32_bf16 v[80:83], a[20:23], a[148:151], v[80:83]
    v_mfma_f32_16x16x32_bf16 v[136:139], a[16:19], a[136:139], v[136:139]
    ds_read_b64_tr_b16 a[12:13], v229 offset:24576
    v_mfma_f32_16x16x32_bf16 v[136:139], a[20:23], a[152:155], v[136:139]
    v_mfma_f32_16x16x32_bf16 v[192:195], a[16:19], a[140:143], v[192:195]
    ds_read_b64_tr_b16 a[14:15], v229 offset:26368
    buffer_load_dwordx4 v227, s[52:55], s8 offen offset:3072  lds
    v_mfma_f32_16x16x32_bf16 v[192:195], a[20:23], a[156:159], v[192:195]
    s_add_u32 s8, s7, 6651904
    s_add_u32 m0, s6, 81920
    v_mfma_f32_16x16x32_bf16 v[52:55], a[24:27], a[128:131], v[52:55]
    ds_read_b64_tr_b16 a[16:17], v229 offset:32
    v_mfma_f32_16x16x32_bf16 v[52:55], a[28:31], a[144:147], v[52:55]
    v_mfma_f32_16x16x32_bf16 v[108:111], a[24:27], a[132:135], v[108:111]
    ds_read_b64_tr_b16 a[18:19], v229 offset:1824
    buffer_load_dwordx4 v224, s[52:55], s8 offen offset:0  lds
    v_mfma_f32_16x16x32_bf16 v[108:111], a[28:31], a[148:151], v[108:111]
    v_mfma_f32_16x16x32_bf16 v[164:167], a[24:27], a[136:139], v[164:167]
    ds_read_b64_tr_b16 a[20:21], v229 offset:16416
    v_mfma_f32_16x16x32_bf16 v[164:167], a[28:31], a[152:155], v[164:167]
    v_mfma_f32_16x16x32_bf16 v[220:223], a[24:27], a[140:143], v[220:223]
    ds_read_b64_tr_b16 a[22:23], v229 offset:18208
    buffer_load_dwordx4 v225, s[52:55], s8 offen offset:1024  lds
    v_mfma_f32_16x16x32_bf16 v[220:223], a[28:31], a[156:159], v[220:223]
    s_waitcnt vmcnt(30) lgkmcnt(8)
    v_mfma_f32_16x16x32_bf16 v[0:3], a[0:3], a[32:35], v[0:3]
    ds_read_b64_tr_b16 a[24:25], v229 offset:8224
    v_mfma_f32_16x16x32_bf16 v[0:3], a[4:7], a[48:51], v[0:3]
    v_mfma_f32_16x16x32_bf16 v[56:59], a[0:3], a[36:39], v[56:59]
    ds_read_b64_tr_b16 a[26:27], v229 offset:10016
    buffer_load_dwordx4 v226, s[52:55], s8 offen offset:2048  lds
    v_mfma_f32_16x16x32_bf16 v[56:59], a[4:7], a[52:55], v[56:59]
    v_mfma_f32_16x16x32_bf16 v[112:115], a[0:3], a[40:43], v[112:115]
    ds_read_b64_tr_b16 a[28:29], v229 offset:24608
    v_mfma_f32_16x16x32_bf16 v[112:115], a[4:7], a[56:59], v[112:115]
    v_mfma_f32_16x16x32_bf16 v[168:171], a[0:3], a[44:47], v[168:171]
    ds_read_b64_tr_b16 a[30:31], v229 offset:26400
    buffer_load_dwordx4 v227, s[52:55], s8 offen offset:3072  lds
    v_mfma_f32_16x16x32_bf16 v[168:171], a[4:7], a[60:63], v[168:171]
    s_add_u32 s8, s7, 6881280
    s_add_u32 m0, s6, 98304
    s_waitcnt lgkmcnt(8)
    v_mfma_f32_16x16x32_bf16 v[28:31], a[8:11], a[32:35], v[28:31]
    ds_read_b64_tr_b16 a[0:1], v229 offset:64
    v_mfma_f32_16x16x32_bf16 v[28:31], a[12:15], a[48:51], v[28:31]
    v_mfma_f32_16x16x32_bf16 v[84:87], a[8:11], a[36:39], v[84:87]
    ds_read_b64_tr_b16 a[2:3], v229 offset:1856
    buffer_load_dwordx4 v224, s[52:55], s8 offen offset:0  lds
    v_mfma_f32_16x16x32_bf16 v[84:87], a[12:15], a[52:55], v[84:87]
    v_mfma_f32_16x16x32_bf16 v[140:143], a[8:11], a[40:43], v[140:143]
    ds_read_b64_tr_b16 a[4:5], v229 offset:16448
    v_mfma_f32_16x16x32_bf16 v[140:143], a[12:15], a[56:59], v[140:143]
    v_mfma_f32_16x16x32_bf16 v[196:199], a[8:11], a[44:47], v[196:199]
    ds_read_b64_tr_b16 a[6:7], v229 offset:18240
    buffer_load_dwordx4 v225, s[52:55], s8 offen offset:1024  lds
    v_mfma_f32_16x16x32_bf16 v[196:199], a[12:15], a[60:63], v[196:199]
    s_waitcnt lgkmcnt(8)
    v_mfma_f32_16x16x32_bf16 v[4:7], a[16:19], a[32:35], v[4:7]
    ds_read_b64_tr_b16 a[8:9], v229 offset:8256
    v_mfma_f32_16x16x32_bf16 v[4:7], a[20:23], a[48:51], v[4:7]
    v_mfma_f32_16x16x32_bf16 v[60:63], a[16:19], a[36:39], v[60:63]
    ds_read_b64_tr_b16 a[10:11], v229 offset:10048
    buffer_load_dwordx4 v226, s[52:55], s8 offen offset:2048  lds
    v_mfma_f32_16x16x32_bf16 v[60:63], a[20:23], a[52:55], v[60:63]
    v_mfma_f32_16x16x32_bf16 v[116:119], a[16:19], a[40:43], v[116:119]
    ds_read_b64_tr_b16 a[12:13], v229 offset:24640
    v_mfma_f32_16x16x32_bf16 v[116:119], a[20:23], a[56:59], v[116:119]
    v_mfma_f32_16x16x32_bf16 v[172:175], a[16:19], a[44:47], v[172:175]
    ds_read_b64_tr_b16 a[14:15], v229 offset:26432
    buffer_load_dwordx4 v227, s[52:55], s8 offen offset:3072  lds
    v_mfma_f32_16x16x32_bf16 v[172:175], a[20:23], a[60:63], v[172:175]
    s_add_u32 s8, s7, 7110656
    s_add_u32 m0, s6, 114688
    s_waitcnt lgkmcnt(8)
    v_mfma_f32_16x16x32_bf16 v[32:35], a[24:27], a[32:35], v[32:35]
    ds_read_b64_tr_b16 a[16:17], v229 offset:96
    v_mfma_f32_16x16x32_bf16 v[32:35], a[28:31], a[48:51], v[32:35]
    v_mfma_f32_16x16x32_bf16 v[88:91], a[24:27], a[36:39], v[88:91]
    ds_read_b64_tr_b16 a[18:19], v229 offset:1888
    buffer_load_dwordx4 v224, s[52:55], s8 offen offset:0  lds
    v_mfma_f32_16x16x32_bf16 v[88:91], a[28:31], a[52:55], v[88:91]
    v_mfma_f32_16x16x32_bf16 v[144:147], a[24:27], a[40:43], v[144:147]
    ds_read_b64_tr_b16 a[20:21], v229 offset:16480
    v_mfma_f32_16x16x32_bf16 v[144:147], a[28:31], a[56:59], v[144:147]
    v_mfma_f32_16x16x32_bf16 v[200:203], a[24:27], a[44:47], v[200:203]
    ds_read_b64_tr_b16 a[22:23], v229 offset:18272
    buffer_load_dwordx4 v225, s[52:55], s8 offen offset:1024  lds
    v_mfma_f32_16x16x32_bf16 v[200:203], a[28:31], a[60:63], v[200:203]
    s_waitcnt lgkmcnt(8)
    v_mfma_f32_16x16x32_bf16 v[8:11], a[0:3], a[32:35], v[8:11]
    ds_read_b64_tr_b16 a[24:25], v229 offset:8288
    v_mfma_f32_16x16x32_bf16 v[8:11], a[4:7], a[48:51], v[8:11]
    v_mfma_f32_16x16x32_bf16 v[64:67], a[0:3], a[36:39], v[64:67]
    ds_read_b64_tr_b16 a[26:27], v229 offset:10080
    s_branch L_fused_kernel_pc8
L_fused_kernel_isl0_8:
    s_branch L_fused_kernel_isl0_12
L_fused_kernel_pc8:
    buffer_load_dwordx4 v226, s[52:55], s8 offen offset:2048  lds
    v_mfma_f32_16x16x32_bf16 v[64:67], a[4:7], a[52:55], v[64:67]
    v_mfma_f32_16x16x32_bf16 v[120:123], a[0:3], a[40:43], v[120:123]
    ds_read_b64_tr_b16 a[28:29], v229 offset:24672
    v_mfma_f32_16x16x32_bf16 v[120:123], a[4:7], a[56:59], v[120:123]
    v_mfma_f32_16x16x32_bf16 v[176:179], a[0:3], a[44:47], v[176:179]
    ds_read_b64_tr_b16 a[30:31], v229 offset:26464
    buffer_load_dwordx4 v227, s[52:55], s8 offen offset:3072  lds
    v_mfma_f32_16x16x32_bf16 v[176:179], a[4:7], a[60:63], v[176:179]
    s_mov_b32 s9, 3932160
    s_waitcnt lgkmcnt(8)
    v_mfma_f32_16x16x32_bf16 v[36:39], a[8:11], a[32:35], v[36:39]
    ds_read_b64_tr_b16 a[0:1], v229 offset:128
    v_mfma_f32_16x16x32_bf16 v[36:39], a[12:15], a[48:51], v[36:39]
    v_mfma_f32_16x16x32_bf16 v[92:95], a[8:11], a[36:39], v[92:95]
    ds_read_b64_tr_b16 a[2:3], v229 offset:1920
    buffer_load_dwordx4 a[128:131], v228, s[44:47], s9 offen offset:0 sc1
    v_mfma_f32_16x16x32_bf16 v[92:95], a[12:15], a[52:55], v[92:95]
    v_mfma_f32_16x16x32_bf16 v[148:151], a[8:11], a[40:43], v[148:151]
    ds_read_b64_tr_b16 a[4:5], v229 offset:16512
    v_mfma_f32_16x16x32_bf16 v[148:151], a[12:15], a[56:59], v[148:151]
    v_mfma_f32_16x16x32_bf16 v[204:207], a[8:11], a[44:47], v[204:207]
    ds_read_b64_tr_b16 a[6:7], v229 offset:18304
    buffer_load_dwordx4 a[132:135], v228, s[44:47], s9 offen offset:1024 sc1
    v_mfma_f32_16x16x32_bf16 v[204:207], a[12:15], a[60:63], v[204:207]
    s_waitcnt lgkmcnt(8)
    v_mfma_f32_16x16x32_bf16 v[12:15], a[16:19], a[32:35], v[12:15]
    ds_read_b64_tr_b16 a[8:9], v229 offset:8320
    v_mfma_f32_16x16x32_bf16 v[12:15], a[20:23], a[48:51], v[12:15]
    v_mfma_f32_16x16x32_bf16 v[68:71], a[16:19], a[36:39], v[68:71]
    ds_read_b64_tr_b16 a[10:11], v229 offset:10112
    buffer_load_dwordx4 a[136:139], v228, s[44:47], s9 offen offset:2048 sc1
    v_mfma_f32_16x16x32_bf16 v[68:71], a[20:23], a[52:55], v[68:71]
    v_mfma_f32_16x16x32_bf16 v[124:127], a[16:19], a[40:43], v[124:127]
    ds_read_b64_tr_b16 a[12:13], v229 offset:24704
    v_mfma_f32_16x16x32_bf16 v[124:127], a[20:23], a[56:59], v[124:127]
    v_mfma_f32_16x16x32_bf16 v[180:183], a[16:19], a[44:47], v[180:183]
    ds_read_b64_tr_b16 a[14:15], v229 offset:26496
    buffer_load_dwordx4 a[140:143], v228, s[44:47], s9 offen offset:3072 sc1
    v_mfma_f32_16x16x32_bf16 v[180:183], a[20:23], a[60:63], v[180:183]
    s_mov_b32 s9, 4063232
    s_waitcnt lgkmcnt(8)
    v_mfma_f32_16x16x32_bf16 v[40:43], a[24:27], a[32:35], v[40:43]
    ds_read_b64_tr_b16 a[16:17], v229 offset:160
    v_mfma_f32_16x16x32_bf16 v[40:43], a[28:31], a[48:51], v[40:43]
    v_mfma_f32_16x16x32_bf16 v[96:99], a[24:27], a[36:39], v[96:99]
    ds_read_b64_tr_b16 a[18:19], v229 offset:1952
    buffer_load_dwordx4 a[144:147], v228, s[44:47], s9 offen offset:0 sc1
    v_mfma_f32_16x16x32_bf16 v[96:99], a[28:31], a[52:55], v[96:99]
    v_mfma_f32_16x16x32_bf16 v[152:155], a[24:27], a[40:43], v[152:155]
    ds_read_b64_tr_b16 a[20:21], v229 offset:16544
    v_mfma_f32_16x16x32_bf16 v[152:155], a[28:31], a[56:59], v[152:155]
    v_mfma_f32_16x16x32_bf16 v[208:211], a[24:27], a[44:47], v[208:211]
    ds_read_b64_tr_b16 a[22:23], v229 offset:18336
    buffer_load_dwordx4 a[148:151], v228, s[44:47], s9 offen offset:1024 sc1
    v_mfma_f32_16x16x32_bf16 v[208:211], a[28:31], a[60:63], v[208:211]
    s_waitcnt lgkmcnt(8)
    v_mfma_f32_16x16x32_bf16 v[16:19], a[0:3], a[32:35], v[16:19]
    ds_read_b64_tr_b16 a[24:25], v229 offset:8352
    v_mfma_f32_16x16x32_bf16 v[16:19], a[4:7], a[48:51], v[16:19]
    v_mfma_f32_16x16x32_bf16 v[72:75], a[0:3], a[36:39], v[72:75]
    ds_read_b64_tr_b16 a[26:27], v229 offset:10144
    buffer_load_dwordx4 a[152:155], v228, s[44:47], s9 offen offset:2048 sc1
    v_mfma_f32_16x16x32_bf16 v[72:75], a[4:7], a[52:55], v[72:75]
    v_mfma_f32_16x16x32_bf16 v[128:131], a[0:3], a[40:43], v[128:131]
    ds_read_b64_tr_b16 a[28:29], v229 offset:24736
    v_mfma_f32_16x16x32_bf16 v[128:131], a[4:7], a[56:59], v[128:131]
    v_mfma_f32_16x16x32_bf16 v[184:187], a[0:3], a[44:47], v[184:187]
    ds_read_b64_tr_b16 a[30:31], v229 offset:26528
    buffer_load_dwordx4 a[156:159], v228, s[44:47], s9 offen offset:3072 sc1
    v_mfma_f32_16x16x32_bf16 v[184:187], a[4:7], a[60:63], v[184:187]
    s_add_u32 s60, s15, 0
    s_add_u32 m0, s14, 131072
    s_waitcnt lgkmcnt(8)
    v_mfma_f32_16x16x32_bf16 v[44:47], a[8:11], a[32:35], v[44:47]
    ds_read_b64_tr_b16 a[0:1], v229 offset:192
    v_mfma_f32_16x16x32_bf16 v[44:47], a[12:15], a[48:51], v[44:47]
    v_mfma_f32_16x16x32_bf16 v[100:103], a[8:11], a[36:39], v[100:103]
    ds_read_b64_tr_b16 a[2:3], v229 offset:1984
    buffer_load_dwordx4 v234, s[56:59], s60 offen offset:0  lds
    v_mfma_f32_16x16x32_bf16 v[100:103], a[12:15], a[52:55], v[100:103]
    v_mfma_f32_16x16x32_bf16 v[156:159], a[8:11], a[40:43], v[156:159]
    ds_read_b64_tr_b16 a[4:5], v229 offset:16576
    v_mfma_f32_16x16x32_bf16 v[156:159], a[12:15], a[56:59], v[156:159]
    v_mfma_f32_16x16x32_bf16 v[212:215], a[8:11], a[44:47], v[212:215]
    ds_read_b64_tr_b16 a[6:7], v229 offset:18368
    buffer_load_dwordx4 v235, s[56:59], s60 offen offset:1024  lds
    v_mfma_f32_16x16x32_bf16 v[212:215], a[12:15], a[60:63], v[212:215]
    s_add_u32 s60, s15, 65536
    s_add_u32 m0, s14, 139264
    s_waitcnt lgkmcnt(8)
    v_mfma_f32_16x16x32_bf16 v[20:23], a[16:19], a[32:35], v[20:23]
    ds_read_b64_tr_b16 a[8:9], v229 offset:8384
    v_mfma_f32_16x16x32_bf16 v[20:23], a[20:23], a[48:51], v[20:23]
    v_mfma_f32_16x16x32_bf16 v[76:79], a[16:19], a[36:39], v[76:79]
    ds_read_b64_tr_b16 a[10:11], v229 offset:10176
    buffer_load_dwordx4 v234, s[56:59], s60 offen offset:0  lds
    v_mfma_f32_16x16x32_bf16 v[76:79], a[20:23], a[52:55], v[76:79]
    v_mfma_f32_16x16x32_bf16 v[132:135], a[16:19], a[40:43], v[132:135]
    ds_read_b64_tr_b16 a[12:13], v229 offset:24768
    v_mfma_f32_16x16x32_bf16 v[132:135], a[20:23], a[56:59], v[132:135]
    v_mfma_f32_16x16x32_bf16 v[188:191], a[16:19], a[44:47], v[188:191]
    ds_read_b64_tr_b16 a[14:15], v229 offset:26560
    buffer_load_dwordx4 v235, s[56:59], s60 offen offset:1024  lds
    v_mfma_f32_16x16x32_bf16 v[188:191], a[20:23], a[60:63], v[188:191]
    s_add_u32 s60, s15, 131072
    s_add_u32 m0, s14, 147456
    s_waitcnt vmcnt(12) lgkmcnt(8)
    s_barrier
    v_mfma_f32_16x16x32_bf16 v[48:51], a[24:27], a[32:35], v[48:51]
    ds_read_b64_tr_b16 a[16:17], v229 offset:32768
    v_mfma_f32_16x16x32_bf16 v[48:51], a[28:31], a[48:51], v[48:51]
    v_mfma_f32_16x16x32_bf16 v[104:107], a[24:27], a[36:39], v[104:107]
    ds_read_b64_tr_b16 a[18:19], v229 offset:34560
    buffer_load_dwordx4 v234, s[56:59], s60 offen offset:0  lds
    v_mfma_f32_16x16x32_bf16 v[104:107], a[28:31], a[52:55], v[104:107]
    v_mfma_f32_16x16x32_bf16 v[160:163], a[24:27], a[40:43], v[160:163]
    ds_read_b64_tr_b16 a[20:21], v229 offset:49152
    v_mfma_f32_16x16x32_bf16 v[160:163], a[28:31], a[56:59], v[160:163]
    v_mfma_f32_16x16x32_bf16 v[216:219], a[24:27], a[44:47], v[216:219]
    ds_read_b64_tr_b16 a[22:23], v229 offset:50944
    buffer_load_dwordx4 v235, s[56:59], s60 offen offset:1024  lds
    v_mfma_f32_16x16x32_bf16 v[216:219], a[28:31], a[60:63], v[216:219]
    s_add_u32 s60, s15, 229376
    s_add_u32 m0, s14, 155648
    s_waitcnt lgkmcnt(8)
    v_mfma_f32_16x16x32_bf16 v[24:27], a[0:3], a[32:35], v[24:27]
    ds_read_b64_tr_b16 a[24:25], v230 offset:0
    v_mfma_f32_16x16x32_bf16 v[24:27], a[4:7], a[48:51], v[24:27]
    v_mfma_f32_16x16x32_bf16 v[80:83], a[0:3], a[36:39], v[80:83]
    ds_read_b64_tr_b16 a[26:27], v230 offset:1792
    buffer_load_dwordx4 v234, s[56:59], s60 offen offset:0  lds
    v_mfma_f32_16x16x32_bf16 v[80:83], a[4:7], a[52:55], v[80:83]
    v_mfma_f32_16x16x32_bf16 v[136:139], a[0:3], a[40:43], v[136:139]
    ds_read_b64_tr_b16 a[28:29], v230 offset:16384
    v_mfma_f32_16x16x32_bf16 v[136:139], a[4:7], a[56:59], v[136:139]
    v_mfma_f32_16x16x32_bf16 v[192:195], a[0:3], a[44:47], v[192:195]
    ds_read_b64_tr_b16 a[30:31], v230 offset:18176
    buffer_load_dwordx4 v235, s[56:59], s60 offen offset:1024  lds
    v_mfma_f32_16x16x32_bf16 v[192:195], a[4:7], a[60:63], v[192:195]
    s_mov_b32 s16, 0
    s_waitcnt lgkmcnt(8)
    v_mfma_f32_16x16x32_bf16 v[52:55], a[8:11], a[32:35], v[52:55]
    ds_read_b64_tr_b16 a[0:1], v230 offset:32768
    v_mfma_f32_16x16x32_bf16 v[52:55], a[12:15], a[48:51], v[52:55]
    v_mfma_f32_16x16x32_bf16 v[108:111], a[8:11], a[36:39], v[108:111]
    ds_read_b64_tr_b16 a[2:3], v230 offset:34560
    buffer_load_dword a255, v231, s[56:59], s16 offen
    v_mfma_f32_16x16x32_bf16 v[108:111], a[12:15], a[52:55], v[108:111]
    s_mov_b32 s16, 2048
    v_mfma_f32_16x16x32_bf16 v[164:167], a[8:11], a[40:43], v[164:167]
    ds_read_b64_tr_b16 a[4:5], v230 offset:49152
    v_mfma_f32_16x16x32_bf16 v[164:167], a[12:15], a[56:59], v[164:167]
    v_mfma_f32_16x16x32_bf16 v[220:223], a[8:11], a[44:47], v[220:223]
    ds_read_b64_tr_b16 a[6:7], v230 offset:50944
    buffer_load_dword a255, v231, s[56:59], s16 offen
    v_mfma_f32_16x16x32_bf16 v[220:223], a[12:15], a[60:63], v[220:223]
    s_waitcnt lgkmcnt(8)
    v_mfma_f32_16x16x32_bf16 v[0:3], a[16:19], a[64:67], v[0:3]
    ds_read_b64_tr_b16 a[8:9], v229 offset:40960
    s_mov_b32 s16, 4096
    v_mfma_f32_16x16x32_bf16 v[0:3], a[20:23], a[80:83], v[0:3]
    v_mfma_f32_16x16x32_bf16 v[56:59], a[16:19], a[68:71], v[56:59]
    ds_read_b64_tr_b16 a[10:11], v229 offset:42752
    v_mfma_f32_16x16x32_bf16 v[56:59], a[20:23], a[84:87], v[56:59]
    v_mfma_f32_16x16x32_bf16 v[112:115], a[16:19], a[72:75], v[112:115]
    ds_read_b64_tr_b16 a[12:13], v229 offset:57344
    buffer_load_dword a255, v231, s[56:59], s16 offen
    v_mfma_f32_16x16x32_bf16 v[112:115], a[20:23], a[88:91], v[112:115]
    v_mfma_f32_16x16x32_bf16 v[168:171], a[16:19], a[76:79], v[168:171]
    ds_read_b64_tr_b16 a[14:15], v229 offset:59136
    v_mfma_f32_16x16x32_bf16 v[168:171], a[20:23], a[92:95], v[168:171]
    s_waitcnt lgkmcnt(8)
    v_mfma_f32_16x16x32_bf16 v[0:3], a[24:27], a[96:99], v[0:3]
    ds_read_b64_tr_b16 a[16:17], v230 offset:8192
    s_mov_b32 s16, 6144
    v_mfma_f32_16x16x32_bf16 v[0:3], a[28:31], a[112:115], v[0:3]
    v_mfma_f32_16x16x32_bf16 v[56:59], a[24:27], a[100:103], v[56:59]
    ds_read_b64_tr_b16 a[18:19], v230 offset:9984
    buffer_load_dword a255, v231, s[56:59], s16 offen
    v_mfma_f32_16x16x32_bf16 v[56:59], a[28:31], a[116:119], v[56:59]
    v_mfma_f32_16x16x32_bf16 v[112:115], a[24:27], a[104:107], v[112:115]
    ds_read_b64_tr_b16 a[20:21], v230 offset:24576
    v_mfma_f32_16x16x32_bf16 v[112:115], a[28:31], a[120:123], v[112:115]
    v_mfma_f32_16x16x32_bf16 v[168:171], a[24:27], a[108:111], v[168:171]
    ds_read_b64_tr_b16 a[22:23], v230 offset:26368
    v_mfma_f32_16x16x32_bf16 v[168:171], a[28:31], a[124:127], v[168:171]
    s_waitcnt vmcnt(12) lgkmcnt(8)
    v_mfma_f32_16x16x32_bf16 v[0:3], a[0:3], a[128:131], v[0:3]
    ds_read_b64_tr_b16 a[24:25], v230 offset:40960
    v_mfma_f32_16x16x32_bf16 v[0:3], a[4:7], a[144:147], v[0:3]
    v_mfma_f32_16x16x32_bf16 v[56:59], a[0:3], a[132:135], v[56:59]
    ds_read_b64_tr_b16 a[26:27], v230 offset:42752
    v_mfma_f32_16x16x32_bf16 v[56:59], a[4:7], a[148:151], v[56:59]
    v_mfma_f32_16x16x32_bf16 v[112:115], a[0:3], a[136:139], v[112:115]
    ds_read_b64_tr_b16 a[28:29], v230 offset:57344
    v_mfma_f32_16x16x32_bf16 v[112:115], a[4:7], a[152:155], v[112:115]
    v_mfma_f32_16x16x32_bf16 v[168:171], a[0:3], a[140:143], v[168:171]
    ds_read_b64_tr_b16 a[30:31], v230 offset:59136
    v_mfma_f32_16x16x32_bf16 v[168:171], a[4:7], a[156:159], v[168:171]
    s_waitcnt lgkmcnt(8)
    v_mfma_f32_16x16x32_bf16 v[28:31], a[8:11], a[64:67], v[28:31]
    ds_read_b64_tr_b16 a[0:1], v229 offset:32800
    v_mfma_f32_16x16x32_bf16 v[28:31], a[12:15], a[80:83], v[28:31]
    v_mfma_f32_16x16x32_bf16 v[84:87], a[8:11], a[68:71], v[84:87]
    ds_read_b64_tr_b16 a[2:3], v229 offset:34592
    v_mfma_f32_16x16x32_bf16 v[84:87], a[12:15], a[84:87], v[84:87]
    v_mfma_f32_16x16x32_bf16 v[140:143], a[8:11], a[72:75], v[140:143]
    ds_read_b64_tr_b16 a[4:5], v229 offset:49184
    v_mfma_f32_16x16x32_bf16 v[140:143], a[12:15], a[88:91], v[140:143]
    v_mfma_f32_16x16x32_bf16 v[196:199], a[8:11], a[76:79], v[196:199]
    ds_read_b64_tr_b16 a[6:7], v229 offset:50976
    v_mfma_f32_16x16x32_bf16 v[196:199], a[12:15], a[92:95], v[196:199]
    s_waitcnt lgkmcnt(8)
    v_mfma_f32_16x16x32_bf16 v[28:31], a[16:19], a[96:99], v[28:31]
    ds_read_b64_tr_b16 a[8:9], v230 offset:32
    v_mfma_f32_16x16x32_bf16 v[28:31], a[20:23], a[112:115], v[28:31]
    v_mfma_f32_16x16x32_bf16 v[84:87], a[16:19], a[100:103], v[84:87]
    ds_read_b64_tr_b16 a[10:11], v230 offset:1824
    v_mfma_f32_16x16x32_bf16 v[84:87], a[20:23], a[116:119], v[84:87]
    v_mfma_f32_16x16x32_bf16 v[140:143], a[16:19], a[104:107], v[140:143]
    ds_read_b64_tr_b16 a[12:13], v230 offset:16416
    v_mfma_f32_16x16x32_bf16 v[140:143], a[20:23], a[120:123], v[140:143]
    v_mfma_f32_16x16x32_bf16 v[196:199], a[16:19], a[108:111], v[196:199]
    ds_read_b64_tr_b16 a[14:15], v230 offset:18208
    v_mfma_f32_16x16x32_bf16 v[196:199], a[20:23], a[124:127], v[196:199]
    s_waitcnt lgkmcnt(8)
    v_mfma_f32_16x16x32_bf16 v[28:31], a[24:27], a[128:131], v[28:31]
    ds_read_b64_tr_b16 a[16:17], v230 offset:32800
    v_mfma_f32_16x16x32_bf16 v[28:31], a[28:31], a[144:147], v[28:31]
    v_mfma_f32_16x16x32_bf16 v[84:87], a[24:27], a[132:135], v[84:87]
    ds_read_b64_tr_b16 a[18:19], v230 offset:34592
    v_mfma_f32_16x16x32_bf16 v[84:87], a[28:31], a[148:151], v[84:87]
    v_mfma_f32_16x16x32_bf16 v[140:143], a[24:27], a[136:139], v[140:143]
    ds_read_b64_tr_b16 a[20:21], v230 offset:49184
    v_mfma_f32_16x16x32_bf16 v[140:143], a[28:31], a[152:155], v[140:143]
    v_mfma_f32_16x16x32_bf16 v[196:199], a[24:27], a[140:143], v[196:199]
    ds_read_b64_tr_b16 a[22:23], v230 offset:50976
    v_mfma_f32_16x16x32_bf16 v[196:199], a[28:31], a[156:159], v[196:199]
    s_waitcnt lgkmcnt(8)
    v_mfma_f32_16x16x32_bf16 v[4:7], a[0:3], a[64:67], v[4:7]
    ds_read_b64_tr_b16 a[24:25], v229 offset:40992
    v_mfma_f32_16x16x32_bf16 v[4:7], a[4:7], a[80:83], v[4:7]
    v_mfma_f32_16x16x32_bf16 v[60:63], a[0:3], a[68:71], v[60:63]
    ds_read_b64_tr_b16 a[26:27], v229 offset:42784
    v_mfma_f32_16x16x32_bf16 v[60:63], a[4:7], a[84:87], v[60:63]
    v_mfma_f32_16x16x32_bf16 v[116:119], a[0:3], a[72:75], v[116:119]
    ds_read_b64_tr_b16 a[28:29], v229 offset:57376
    v_mfma_f32_16x16x32_bf16 v[116:119], a[4:7], a[88:91], v[116:119]
    v_mfma_f32_16x16x32_bf16 v[172:175], a[0:3], a[76:79], v[172:175]
    ds_read_b64_tr_b16 a[30:31], v229 offset:59168
    v_mfma_f32_16x16x32_bf16 v[172:175], a[4:7], a[92:95], v[172:175]
    s_waitcnt lgkmcnt(8)
    v_mfma_f32_16x16x32_bf16 v[4:7], a[8:11], a[96:99], v[4:7]
    ds_read_b64_tr_b16 a[0:1], v230 offset:8224
    v_mfma_f32_16x16x32_bf16 v[4:7], a[12:15], a[112:115], v[4:7]
    v_mfma_f32_16x16x32_bf16 v[60:63], a[8:11], a[100:103], v[60:63]
    ds_read_b64_tr_b16 a[2:3], v230 offset:10016
    v_mfma_f32_16x16x32_bf16 v[60:63], a[12:15], a[116:119], v[60:63]
    v_mfma_f32_16x16x32_bf16 v[116:119], a[8:11], a[104:107], v[116:119]
    ds_read_b64_tr_b16 a[4:5], v230 offset:24608
    v_mfma_f32_16x16x32_bf16 v[116:119], a[12:15], a[120:123], v[116:119]
    v_mfma_f32_16x16x32_bf16 v[172:175], a[8:11], a[108:111], v[172:175]
    ds_read_b64_tr_b16 a[6:7], v230 offset:26400
    v_mfma_f32_16x16x32_bf16 v[172:175], a[12:15], a[124:127], v[172:175]
    s_waitcnt lgkmcnt(8)
    v_mfma_f32_16x16x32_bf16 v[4:7], a[16:19], a[128:131], v[4:7]
    ds_read_b64_tr_b16 a[8:9], v230 offset:40992
    v_mfma_f32_16x16x32_bf16 v[4:7], a[20:23], a[144:147], v[4:7]
    v_mfma_f32_16x16x32_bf16 v[60:63], a[16:19], a[132:135], v[60:63]
    ds_read_b64_tr_b16 a[10:11], v230 offset:42784
    v_mfma_f32_16x16x32_bf16 v[60:63], a[20:23], a[148:151], v[60:63]
    v_mfma_f32_16x16x32_bf16 v[116:119], a[16:19], a[136:139], v[116:119]
    ds_read_b64_tr_b16 a[12:13], v230 offset:57376
    v_mfma_f32_16x16x32_bf16 v[116:119], a[20:23], a[152:155], v[116:119]
    v_mfma_f32_16x16x32_bf16 v[172:175], a[16:19], a[140:143], v[172:175]
    ds_read_b64_tr_b16 a[14:15], v230 offset:59168
    v_mfma_f32_16x16x32_bf16 v[172:175], a[20:23], a[156:159], v[172:175]
    s_waitcnt lgkmcnt(8)
    v_mfma_f32_16x16x32_bf16 v[32:35], a[24:27], a[64:67], v[32:35]
    ds_read_b64_tr_b16 a[16:17], v229 offset:32832
    v_mfma_f32_16x16x32_bf16 v[32:35], a[28:31], a[80:83], v[32:35]
    v_mfma_f32_16x16x32_bf16 v[88:91], a[24:27], a[68:71], v[88:91]
    ds_read_b64_tr_b16 a[18:19], v229 offset:34624
    v_mfma_f32_16x16x32_bf16 v[88:91], a[28:31], a[84:87], v[88:91]
    v_mfma_f32_16x16x32_bf16 v[144:147], a[24:27], a[72:75], v[144:147]
    ds_read_b64_tr_b16 a[20:21], v229 offset:49216
    v_mfma_f32_16x16x32_bf16 v[144:147], a[28:31], a[88:91], v[144:147]
    v_mfma_f32_16x16x32_bf16 v[200:203], a[24:27], a[76:79], v[200:203]
    ds_read_b64_tr_b16 a[22:23], v229 offset:51008
    v_mfma_f32_16x16x32_bf16 v[200:203], a[28:31], a[92:95], v[200:203]
    s_waitcnt lgkmcnt(8)
    v_mfma_f32_16x16x32_bf16 v[32:35], a[0:3], a[96:99], v[32:35]
    ds_read_b64_tr_b16 a[24:25], v230 offset:64
    v_mfma_f32_16x16x32_bf16 v[32:35], a[4:7], a[112:115], v[32:35]
    v_mfma_f32_16x16x32_bf16 v[88:91], a[0:3], a[100:103], v[88:91]
    ds_read_b64_tr_b16 a[26:27], v230 offset:1856
    v_mfma_f32_16x16x32_bf16 v[88:91], a[4:7], a[116:119], v[88:91]
    v_mfma_f32_16x16x32_bf16 v[144:147], a[0:3], a[104:107], v[144:147]
    ds_read_b64_tr_b16 a[28:29], v230 offset:16448
    v_mfma_f32_16x16x32_bf16 v[144:147], a[4:7], a[120:123], v[144:147]
    v_mfma_f32_16x16x32_bf16 v[200:203], a[0:3], a[108:111], v[200:203]
    ds_read_b64_tr_b16 a[30:31], v230 offset:18240
    v_mfma_f32_16x16x32_bf16 v[200:203], a[4:7], a[124:127], v[200:203]
    s_waitcnt lgkmcnt(8)
    v_mfma_f32_16x16x32_bf16 v[32:35], a[8:11], a[128:131], v[32:35]
    ds_read_b64_tr_b16 a[0:1], v230 offset:32832
    v_mfma_f32_16x16x32_bf16 v[32:35], a[12:15], a[144:147], v[32:35]
    v_mfma_f32_16x16x32_bf16 v[88:91], a[8:11], a[132:135], v[88:91]
    ds_read_b64_tr_b16 a[2:3], v230 offset:34624
    v_mfma_f32_16x16x32_bf16 v[88:91], a[12:15], a[148:151], v[88:91]
    v_mfma_f32_16x16x32_bf16 v[144:147], a[8:11], a[136:139], v[144:147]
    ds_read_b64_tr_b16 a[4:5], v230 offset:49216
    v_mfma_f32_16x16x32_bf16 v[144:147], a[12:15], a[152:155], v[144:147]
    v_mfma_f32_16x16x32_bf16 v[200:203], a[8:11], a[140:143], v[200:203]
    ds_read_b64_tr_b16 a[6:7], v230 offset:51008
    v_mfma_f32_16x16x32_bf16 v[200:203], a[12:15], a[156:159], v[200:203]
    s_waitcnt lgkmcnt(8)
    v_mfma_f32_16x16x32_bf16 v[8:11], a[16:19], a[64:67], v[8:11]
    ds_read_b64_tr_b16 a[8:9], v229 offset:41024
    v_mul_f32 v0, v0, v28
    v_mfma_f32_16x16x32_bf16 v[8:11], a[20:23], a[80:83], v[8:11]
    v_mul_f32 v1, v1, v29
    v_mul_f32 v2, v2, v30
    v_mfma_f32_16x16x32_bf16 v[64:67], a[16:19], a[68:71], v[64:67]
    ds_read_b64_tr_b16 a[10:11], v229 offset:42816
    v_mul_f32 v3, v3, v31
    v_mfma_f32_16x16x32_bf16 v[64:67], a[20:23], a[84:87], v[64:67]
    v_mul_f32 v4, v4, v32
    v_mul_f32 v5, v5, v33
    v_mfma_f32_16x16x32_bf16 v[120:123], a[16:19], a[72:75], v[120:123]
    ds_read_b64_tr_b16 a[12:13], v229 offset:57408
    v_mul_f32 v6, v6, v34
    v_mfma_f32_16x16x32_bf16 v[120:123], a[20:23], a[88:91], v[120:123]
    v_mul_f32 v7, v7, v35
    v_cvt_pk_bf16_f32 v240, v0, v1
    v_mfma_f32_16x16x32_bf16 v[176:179], a[16:19], a[76:79], v[176:179]
    ds_read_b64_tr_b16 a[14:15], v229 offset:59200
    v_cvt_pk_bf16_f32 v241, v2, v3
    v_mfma_f32_16x16x32_bf16 v[176:179], a[20:23], a[92:95], v[176:179]
    v_cvt_pk_bf16_f32 v242, v4, v5
    v_cvt_pk_bf16_f32 v243, v6, v7
    s_waitcnt lgkmcnt(8)
    v_mfma_f32_16x16x32_bf16 v[8:11], a[24:27], a[96:99], v[8:11]
    ds_read_b64_tr_b16 a[16:17], v230 offset:8256
    buffer_store_dwordx4 v[240:243], v228, s[48:51], s10 offen offset:0 sc1
    v_mfma_f32_16x16x32_bf16 v[8:11], a[28:31], a[112:115], v[8:11]
    v_mul_f32 v56, v56, v84
    v_mul_f32 v57, v57, v85
    v_mfma_f32_16x16x32_bf16 v[64:67], a[24:27], a[100:103], v[64:67]
    ds_read_b64_tr_b16 a[18:19], v230 offset:10048
    v_mul_f32 v58, v58, v86
    v_mfma_f32_16x16x32_bf16 v[64:67], a[28:31], a[116:119], v[64:67]
    v_mul_f32 v59, v59, v87
    v_mul_f32 v60, v60, v88
    v_mfma_f32_16x16x32_bf16 v[120:123], a[24:27], a[104:107], v[120:123]
    ds_read_b64_tr_b16 a[20:21], v230 offset:24640
    v_mul_f32 v61, v61, v89
    v_mfma_f32_16x16x32_bf16 v[120:123], a[28:31], a[120:123], v[120:123]
    v_mul_f32 v62, v62, v90
    v_mul_f32 v63, v63, v91
    v_mfma_f32_16x16x32_bf16 v[176:179], a[24:27], a[108:111], v[176:179]
    ds_read_b64_tr_b16 a[22:23], v230 offset:26432
    v_cvt_pk_bf16_f32 v244, v56, v57
    v_mfma_f32_16x16x32_bf16 v[176:179], a[28:31], a[124:127], v[176:179]
    v_cvt_pk_bf16_f32 v245, v58, v59
    v_cvt_pk_bf16_f32 v246, v60, v61
    s_waitcnt lgkmcnt(8)
    v_mfma_f32_16x16x32_bf16 v[8:11], a[0:3], a[128:131], v[8:11]
    ds_read_b64_tr_b16 a[24:25], v230 offset:41024
    v_cvt_pk_bf16_f32 v247, v62, v63
    v_mfma_f32_16x16x32_bf16 v[8:11], a[4:7], a[144:147], v[8:11]
    buffer_store_dwordx4 v[244:247], v228, s[48:51], s10 offen offset:1024 sc1
    v_mul_f32 v112, v112, v140
    v_mfma_f32_16x16x32_bf16 v[64:67], a[0:3], a[132:135], v[64:67]
    ds_read_b64_tr_b16 a[26:27], v230 offset:42816
    v_mul_f32 v113, v113, v141
    v_mfma_f32_16x16x32_bf16 v[64:67], a[4:7], a[148:151], v[64:67]
    v_mul_f32 v114, v114, v142
    v_mul_f32 v115, v115, v143
    v_mfma_f32_16x16x32_bf16 v[120:123], a[0:3], a[136:139], v[120:123]
    ds_read_b64_tr_b16 a[28:29], v230 offset:57408
    v_mul_f32 v116, v116, v144
    v_mfma_f32_16x16x32_bf16 v[120:123], a[4:7], a[152:155], v[120:123]
    v_mul_f32 v117, v117, v145
    v_mul_f32 v118, v118, v146
    v_mfma_f32_16x16x32_bf16 v[176:179], a[0:3], a[140:143], v[176:179]
    ds_read_b64_tr_b16 a[30:31], v230 offset:59200
    v_mul_f32 v119, v119, v147
    v_mfma_f32_16x16x32_bf16 v[176:179], a[4:7], a[156:159], v[176:179]
    v_cvt_pk_bf16_f32 v248, v112, v113
    v_cvt_pk_bf16_f32 v249, v114, v115
    s_waitcnt lgkmcnt(8)
    v_mfma_f32_16x16x32_bf16 v[36:39], a[8:11], a[64:67], v[36:39]
    ds_read_b64_tr_b16 a[0:1], v229 offset:32864
    v_cvt_pk_bf16_f32 v250, v116, v117
    v_mfma_f32_16x16x32_bf16 v[36:39], a[12:15], a[80:83], v[36:39]
    v_cvt_pk_bf16_f32 v251, v118, v119
    buffer_store_dwordx4 v[248:251], v228, s[48:51], s10 offen offset:2048 sc1
    v_mfma_f32_16x16x32_bf16 v[92:95], a[8:11], a[68:71], v[92:95]
    ds_read_b64_tr_b16 a[2:3], v229 offset:34656
    v_mul_f32 v168, v168, v196
    v_mfma_f32_16x16x32_bf16 v[92:95], a[12:15], a[84:87], v[92:95]
    v_mul_f32 v169, v169, v197
    v_mul_f32 v170, v170, v198
    v_mfma_f32_16x16x32_bf16 v[148:151], a[8:11], a[72:75], v[148:151]
    ds_read_b64_tr_b16 a[4:5], v229 offset:49248
    v_mul_f32 v171, v171, v199
    v_mfma_f32_16x16x32_bf16 v[148:151], a[12:15], a[88:91], v[148:151]
    v_mul_f32 v172, v172, v200
    v_mul_f32 v173, v173, v201
    v_mfma_f32_16x16x32_bf16 v[204:207], a[8:11], a[76:79], v[204:207]
    ds_read_b64_tr_b16 a[6:7], v229 offset:51040
    v_mul_f32 v174, v174, v202
    v_mfma_f32_16x16x32_bf16 v[204:207], a[12:15], a[92:95], v[204:207]
    v_mul_f32 v175, v175, v203
    v_cvt_pk_bf16_f32 v252, v168, v169
    s_waitcnt lgkmcnt(8)
    v_mfma_f32_16x16x32_bf16 v[36:39], a[16:19], a[96:99], v[36:39]
    ds_read_b64_tr_b16 a[8:9], v230 offset:96
    v_cvt_pk_bf16_f32 v253, v170, v171
    v_mfma_f32_16x16x32_bf16 v[36:39], a[20:23], a[112:115], v[36:39]
    v_cvt_pk_bf16_f32 v254, v172, v173
    v_cvt_pk_bf16_f32 v255, v174, v175
    v_mfma_f32_16x16x32_bf16 v[92:95], a[16:19], a[100:103], v[92:95]
    ds_read_b64_tr_b16 a[10:11], v230 offset:1888
    buffer_store_dwordx4 v[252:255], v228, s[48:51], s10 offen offset:3072 sc1
    v_mfma_f32_16x16x32_bf16 v[92:95], a[20:23], a[116:119], v[92:95]
    v_mfma_f32_16x16x32_bf16 v[148:151], a[16:19], a[104:107], v[148:151]
    ds_read_b64_tr_b16 a[12:13], v230 offset:16480
    v_mfma_f32_16x16x32_bf16 v[148:151], a[20:23], a[120:123], v[148:151]
    v_mfma_f32_16x16x32_bf16 v[204:207], a[16:19], a[108:111], v[204:207]
    ds_read_b64_tr_b16 a[14:15], v230 offset:18272
    v_mfma_f32_16x16x32_bf16 v[204:207], a[20:23], a[124:127], v[204:207]
    s_waitcnt lgkmcnt(8)
    v_mfma_f32_16x16x32_bf16 v[36:39], a[24:27], a[128:131], v[36:39]
    ds_read_b64_tr_b16 a[16:17], v230 offset:32864
    v_mfma_f32_16x16x32_bf16 v[36:39], a[28:31], a[144:147], v[36:39]
    v_mfma_f32_16x16x32_bf16 v[92:95], a[24:27], a[132:135], v[92:95]
    ds_read_b64_tr_b16 a[18:19], v230 offset:34656
    v_mfma_f32_16x16x32_bf16 v[92:95], a[28:31], a[148:151], v[92:95]
    v_mfma_f32_16x16x32_bf16 v[148:151], a[24:27], a[136:139], v[148:151]
    ds_read_b64_tr_b16 a[20:21], v230 offset:49248
    v_mfma_f32_16x16x32_bf16 v[148:151], a[28:31], a[152:155], v[148:151]
    v_mfma_f32_16x16x32_bf16 v[204:207], a[24:27], a[140:143], v[204:207]
    ds_read_b64_tr_b16 a[22:23], v230 offset:51040
    v_mfma_f32_16x16x32_bf16 v[204:207], a[28:31], a[156:159], v[204:207]
    s_waitcnt lgkmcnt(8)
    v_mfma_f32_16x16x32_bf16 v[12:15], a[0:3], a[64:67], v[12:15]
    ds_read_b64_tr_b16 a[24:25], v229 offset:41056
    v_mfma_f32_16x16x32_bf16 v[12:15], a[4:7], a[80:83], v[12:15]
    v_mfma_f32_16x16x32_bf16 v[68:71], a[0:3], a[68:71], v[68:71]
    ds_read_b64_tr_b16 a[26:27], v229 offset:42848
    v_mfma_f32_16x16x32_bf16 v[68:71], a[4:7], a[84:87], v[68:71]
    v_mfma_f32_16x16x32_bf16 v[124:127], a[0:3], a[72:75], v[124:127]
    ds_read_b64_tr_b16 a[28:29], v229 offset:57440
    v_mfma_f32_16x16x32_bf16 v[124:127], a[4:7], a[88:91], v[124:127]
    v_mfma_f32_16x16x32_bf16 v[180:183], a[0:3], a[76:79], v[180:183]
    ds_read_b64_tr_b16 a[30:31], v229 offset:59232
    v_mfma_f32_16x16x32_bf16 v[180:183], a[4:7], a[92:95], v[180:183]
    s_waitcnt lgkmcnt(8)
    v_mfma_f32_16x16x32_bf16 v[12:15], a[8:11], a[96:99], v[12:15]
    ds_read_b64_tr_b16 a[0:1], v230 offset:8288
    v_mfma_f32_16x16x32_bf16 v[12:15], a[12:15], a[112:115], v[12:15]
    v_mfma_f32_16x16x32_bf16 v[68:71], a[8:11], a[100:103], v[68:71]
    ds_read_b64_tr_b16 a[2:3], v230 offset:10080
    v_mfma_f32_16x16x32_bf16 v[68:71], a[12:15], a[116:119], v[68:71]
    v_mfma_f32_16x16x32_bf16 v[124:127], a[8:11], a[104:107], v[124:127]
    ds_read_b64_tr_b16 a[4:5], v230 offset:24672
    v_mfma_f32_16x16x32_bf16 v[124:127], a[12:15], a[120:123], v[124:127]
    v_mfma_f32_16x16x32_bf16 v[180:183], a[8:11], a[108:111], v[180:183]
    ds_read_b64_tr_b16 a[6:7], v230 offset:26464
    v_mfma_f32_16x16x32_bf16 v[180:183], a[12:15], a[124:127], v[180:183]
    s_waitcnt lgkmcnt(8)
    v_mfma_f32_16x16x32_bf16 v[12:15], a[16:19], a[128:131], v[12:15]
    ds_read_b64_tr_b16 a[8:9], v230 offset:41056
    v_mfma_f32_16x16x32_bf16 v[12:15], a[20:23], a[144:147], v[12:15]
    v_mfma_f32_16x16x32_bf16 v[68:71], a[16:19], a[132:135], v[68:71]
    ds_read_b64_tr_b16 a[10:11], v230 offset:42848
    v_mfma_f32_16x16x32_bf16 v[68:71], a[20:23], a[148:151], v[68:71]
    v_mfma_f32_16x16x32_bf16 v[124:127], a[16:19], a[136:139], v[124:127]
    ds_read_b64_tr_b16 a[12:13], v230 offset:57440
    v_mfma_f32_16x16x32_bf16 v[124:127], a[20:23], a[152:155], v[124:127]
    v_mfma_f32_16x16x32_bf16 v[180:183], a[16:19], a[140:143], v[180:183]
    ds_read_b64_tr_b16 a[14:15], v230 offset:59232
    v_mfma_f32_16x16x32_bf16 v[180:183], a[20:23], a[156:159], v[180:183]
    s_waitcnt lgkmcnt(8)
    v_mfma_f32_16x16x32_bf16 v[40:43], a[24:27], a[64:67], v[40:43]
    ds_read_b64_tr_b16 a[16:17], v229 offset:32896
    v_mfma_f32_16x16x32_bf16 v[40:43], a[28:31], a[80:83], v[40:43]
    v_mfma_f32_16x16x32_bf16 v[96:99], a[24:27], a[68:71], v[96:99]
    ds_read_b64_tr_b16 a[18:19], v229 offset:34688
    v_mfma_f32_16x16x32_bf16 v[96:99], a[28:31], a[84:87], v[96:99]
    v_mfma_f32_16x16x32_bf16 v[152:155], a[24:27], a[72:75], v[152:155]
    ds_read_b64_tr_b16 a[20:21], v229 offset:49280
    v_mfma_f32_16x16x32_bf16 v[152:155], a[28:31], a[88:91], v[152:155]
    v_mfma_f32_16x16x32_bf16 v[208:211], a[24:27], a[76:79], v[208:211]
    ds_read_b64_tr_b16 a[22:23], v229 offset:51072
    v_mfma_f32_16x16x32_bf16 v[208:211], a[28:31], a[92:95], v[208:211]
    s_waitcnt lgkmcnt(8)
    v_mfma_f32_16x16x32_bf16 v[40:43], a[0:3], a[96:99], v[40:43]
    ds_read_b64_tr_b16 a[24:25], v230 offset:128
    v_mfma_f32_16x16x32_bf16 v[40:43], a[4:7], a[112:115], v[40:43]
    v_mfma_f32_16x16x32_bf16 v[96:99], a[0:3], a[100:103], v[96:99]
    ds_read_b64_tr_b16 a[26:27], v230 offset:1920
    v_mfma_f32_16x16x32_bf16 v[96:99], a[4:7], a[116:119], v[96:99]
    v_mfma_f32_16x16x32_bf16 v[152:155], a[0:3], a[104:107], v[152:155]
    ds_read_b64_tr_b16 a[28:29], v230 offset:16512
    v_mfma_f32_16x16x32_bf16 v[152:155], a[4:7], a[120:123], v[152:155]
    v_mfma_f32_16x16x32_bf16 v[208:211], a[0:3], a[108:111], v[208:211]
    ds_read_b64_tr_b16 a[30:31], v230 offset:18304
    v_mfma_f32_16x16x32_bf16 v[208:211], a[4:7], a[124:127], v[208:211]
    s_waitcnt lgkmcnt(8)
    v_mfma_f32_16x16x32_bf16 v[40:43], a[8:11], a[128:131], v[40:43]
    ds_read_b64_tr_b16 a[0:1], v230 offset:32896
    v_mfma_f32_16x16x32_bf16 v[40:43], a[12:15], a[144:147], v[40:43]
    v_mfma_f32_16x16x32_bf16 v[96:99], a[8:11], a[132:135], v[96:99]
    ds_read_b64_tr_b16 a[2:3], v230 offset:34688
    v_mfma_f32_16x16x32_bf16 v[96:99], a[12:15], a[148:151], v[96:99]
    v_mfma_f32_16x16x32_bf16 v[152:155], a[8:11], a[136:139], v[152:155]
    ds_read_b64_tr_b16 a[4:5], v230 offset:49280
    v_mfma_f32_16x16x32_bf16 v[152:155], a[12:15], a[152:155], v[152:155]
    v_mfma_f32_16x16x32_bf16 v[208:211], a[8:11], a[140:143], v[208:211]
    ds_read_b64_tr_b16 a[6:7], v230 offset:51072
    v_mfma_f32_16x16x32_bf16 v[208:211], a[12:15], a[156:159], v[208:211]
    s_waitcnt lgkmcnt(8)
    v_mfma_f32_16x16x32_bf16 v[16:19], a[16:19], a[64:67], v[16:19]
    ds_read_b64_tr_b16 a[8:9], v229 offset:41088
    v_mul_f32 v8, v8, v36
    v_mfma_f32_16x16x32_bf16 v[16:19], a[20:23], a[80:83], v[16:19]
    v_mul_f32 v9, v9, v37
    v_mul_f32 v10, v10, v38
    v_mfma_f32_16x16x32_bf16 v[72:75], a[16:19], a[68:71], v[72:75]
    ds_read_b64_tr_b16 a[10:11], v229 offset:42880
    v_mul_f32 v11, v11, v39
    v_mfma_f32_16x16x32_bf16 v[72:75], a[20:23], a[84:87], v[72:75]
    v_mul_f32 v12, v12, v40
    v_mul_f32 v13, v13, v41
    v_mfma_f32_16x16x32_bf16 v[128:131], a[16:19], a[72:75], v[128:131]
    ds_read_b64_tr_b16 a[12:13], v229 offset:57472
    v_mul_f32 v14, v14, v42
    v_mfma_f32_16x16x32_bf16 v[128:131], a[20:23], a[88:91], v[128:131]
    v_mul_f32 v15, v15, v43
    v_cvt_pk_bf16_f32 v240, v8, v9
    v_mfma_f32_16x16x32_bf16 v[184:187], a[16:19], a[76:79], v[184:187]
    ds_read_b64_tr_b16 a[14:15], v229 offset:59264
    v_cvt_pk_bf16_f32 v241, v10, v11
    v_mfma_f32_16x16x32_bf16 v[184:187], a[20:23], a[92:95], v[184:187]
    v_cvt_pk_bf16_f32 v242, v12, v13
    s_branch L_fused_kernel_pc9
L_fused_kernel_isl0_9:
    s_branch L_fused_kernel_isl0_13
L_fused_kernel_pc9:
    v_cvt_pk_bf16_f32 v243, v14, v15
    s_waitcnt lgkmcnt(8)
    v_mfma_f32_16x16x32_bf16 v[16:19], a[24:27], a[96:99], v[16:19]
    ds_read_b64_tr_b16 a[16:17], v230 offset:8320
    buffer_store_dwordx4 v[240:243], v228, s[48:51], s11 offen offset:0 sc1
    v_mfma_f32_16x16x32_bf16 v[16:19], a[28:31], a[112:115], v[16:19]
    v_mul_f32 v64, v64, v92
    v_mul_f32 v65, v65, v93
    v_mfma_f32_16x16x32_bf16 v[72:75], a[24:27], a[100:103], v[72:75]
    ds_read_b64_tr_b16 a[18:19], v230 offset:10112
    v_mul_f32 v66, v66, v94
    v_mfma_f32_16x16x32_bf16 v[72:75], a[28:31], a[116:119], v[72:75]
    v_mul_f32 v67, v67, v95
    v_mul_f32 v68, v68, v96
    v_mfma_f32_16x16x32_bf16 v[128:131], a[24:27], a[104:107], v[128:131]
    ds_read_b64_tr_b16 a[20:21], v230 offset:24704
    v_mul_f32 v69, v69, v97
    v_mfma_f32_16x16x32_bf16 v[128:131], a[28:31], a[120:123], v[128:131]
    v_mul_f32 v70, v70, v98
    v_mul_f32 v71, v71, v99
    v_mfma_f32_16x16x32_bf16 v[184:187], a[24:27], a[108:111], v[184:187]
    ds_read_b64_tr_b16 a[22:23], v230 offset:26496
    v_cvt_pk_bf16_f32 v244, v64, v65
    v_mfma_f32_16x16x32_bf16 v[184:187], a[28:31], a[124:127], v[184:187]
    v_cvt_pk_bf16_f32 v245, v66, v67
    v_cvt_pk_bf16_f32 v246, v68, v69
    s_waitcnt lgkmcnt(8)
    v_mfma_f32_16x16x32_bf16 v[16:19], a[0:3], a[128:131], v[16:19]
    ds_read_b64_tr_b16 a[24:25], v230 offset:41088
    v_cvt_pk_bf16_f32 v247, v70, v71
    v_mfma_f32_16x16x32_bf16 v[16:19], a[4:7], a[144:147], v[16:19]
    buffer_store_dwordx4 v[244:247], v228, s[48:51], s11 offen offset:1024 sc1
    v_mul_f32 v120, v120, v148
    v_mfma_f32_16x16x32_bf16 v[72:75], a[0:3], a[132:135], v[72:75]
    ds_read_b64_tr_b16 a[26:27], v230 offset:42880
    v_mul_f32 v121, v121, v149
    v_mfma_f32_16x16x32_bf16 v[72:75], a[4:7], a[148:151], v[72:75]
    v_mul_f32 v122, v122, v150
    v_mul_f32 v123, v123, v151
    v_mfma_f32_16x16x32_bf16 v[128:131], a[0:3], a[136:139], v[128:131]
    ds_read_b64_tr_b16 a[28:29], v230 offset:57472
    v_mul_f32 v124, v124, v152
    v_mfma_f32_16x16x32_bf16 v[128:131], a[4:7], a[152:155], v[128:131]
    v_mul_f32 v125, v125, v153
    v_mul_f32 v126, v126, v154
    v_mfma_f32_16x16x32_bf16 v[184:187], a[0:3], a[140:143], v[184:187]
    ds_read_b64_tr_b16 a[30:31], v230 offset:59264
    v_mul_f32 v127, v127, v155
    v_mfma_f32_16x16x32_bf16 v[184:187], a[4:7], a[156:159], v[184:187]
    v_cvt_pk_bf16_f32 v248, v120, v121
    v_cvt_pk_bf16_f32 v249, v122, v123
    s_waitcnt lgkmcnt(8)
    v_mfma_f32_16x16x32_bf16 v[44:47], a[8:11], a[64:67], v[44:47]
    ds_read_b64_tr_b16 a[0:1], v229 offset:32928
    v_cvt_pk_bf16_f32 v250, v124, v125
    v_mfma_f32_16x16x32_bf16 v[44:47], a[12:15], a[80:83], v[44:47]
    v_cvt_pk_bf16_f32 v251, v126, v127
    buffer_store_dwordx4 v[248:251], v228, s[48:51], s11 offen offset:2048 sc1
    v_mfma_f32_16x16x32_bf16 v[100:103], a[8:11], a[68:71], v[100:103]
    ds_read_b64_tr_b16 a[2:3], v229 offset:34720
    v_mul_f32 v176, v176, v204
    v_mfma_f32_16x16x32_bf16 v[100:103], a[12:15], a[84:87], v[100:103]
    v_mul_f32 v177, v177, v205
    v_mul_f32 v178, v178, v206
    v_mfma_f32_16x16x32_bf16 v[156:159], a[8:11], a[72:75], v[156:159]
    ds_read_b64_tr_b16 a[4:5], v229 offset:49312
    v_mul_f32 v179, v179, v207
    v_mfma_f32_16x16x32_bf16 v[156:159], a[12:15], a[88:91], v[156:159]
    v_mul_f32 v180, v180, v208
    v_mul_f32 v181, v181, v209
    v_mfma_f32_16x16x32_bf16 v[212:215], a[8:11], a[76:79], v[212:215]
    ds_read_b64_tr_b16 a[6:7], v229 offset:51104
    v_mul_f32 v182, v182, v210
    v_mfma_f32_16x16x32_bf16 v[212:215], a[12:15], a[92:95], v[212:215]
    v_mul_f32 v183, v183, v211
    v_cvt_pk_bf16_f32 v252, v176, v177
    s_waitcnt lgkmcnt(8)
    v_mfma_f32_16x16x32_bf16 v[44:47], a[16:19], a[96:99], v[44:47]
    ds_read_b64_tr_b16 a[8:9], v230 offset:160
    v_cvt_pk_bf16_f32 v253, v178, v179
    v_mfma_f32_16x16x32_bf16 v[44:47], a[20:23], a[112:115], v[44:47]
    v_cvt_pk_bf16_f32 v254, v180, v181
    v_cvt_pk_bf16_f32 v255, v182, v183
    v_mfma_f32_16x16x32_bf16 v[100:103], a[16:19], a[100:103], v[100:103]
    ds_read_b64_tr_b16 a[10:11], v230 offset:1952
    buffer_store_dwordx4 v[252:255], v228, s[48:51], s11 offen offset:3072 sc1
    v_mfma_f32_16x16x32_bf16 v[100:103], a[20:23], a[116:119], v[100:103]
    v_mfma_f32_16x16x32_bf16 v[156:159], a[16:19], a[104:107], v[156:159]
    ds_read_b64_tr_b16 a[12:13], v230 offset:16544
    v_mfma_f32_16x16x32_bf16 v[156:159], a[20:23], a[120:123], v[156:159]
    v_mfma_f32_16x16x32_bf16 v[212:215], a[16:19], a[108:111], v[212:215]
    ds_read_b64_tr_b16 a[14:15], v230 offset:18336
    v_mfma_f32_16x16x32_bf16 v[212:215], a[20:23], a[124:127], v[212:215]
    s_waitcnt lgkmcnt(8)
    v_mfma_f32_16x16x32_bf16 v[44:47], a[24:27], a[128:131], v[44:47]
    ds_read_b64_tr_b16 a[16:17], v230 offset:32928
    v_mfma_f32_16x16x32_bf16 v[44:47], a[28:31], a[144:147], v[44:47]
    v_mfma_f32_16x16x32_bf16 v[100:103], a[24:27], a[132:135], v[100:103]
    ds_read_b64_tr_b16 a[18:19], v230 offset:34720
    v_mfma_f32_16x16x32_bf16 v[100:103], a[28:31], a[148:151], v[100:103]
    v_mfma_f32_16x16x32_bf16 v[156:159], a[24:27], a[136:139], v[156:159]
    ds_read_b64_tr_b16 a[20:21], v230 offset:49312
    v_mfma_f32_16x16x32_bf16 v[156:159], a[28:31], a[152:155], v[156:159]
    v_mfma_f32_16x16x32_bf16 v[212:215], a[24:27], a[140:143], v[212:215]
    ds_read_b64_tr_b16 a[22:23], v230 offset:51104
    v_mfma_f32_16x16x32_bf16 v[212:215], a[28:31], a[156:159], v[212:215]
    s_waitcnt lgkmcnt(8)
    v_mfma_f32_16x16x32_bf16 v[20:23], a[0:3], a[64:67], v[20:23]
    ds_read_b64_tr_b16 a[24:25], v229 offset:41120
    v_mfma_f32_16x16x32_bf16 v[20:23], a[4:7], a[80:83], v[20:23]
    v_mfma_f32_16x16x32_bf16 v[76:79], a[0:3], a[68:71], v[76:79]
    ds_read_b64_tr_b16 a[26:27], v229 offset:42912
    v_mfma_f32_16x16x32_bf16 v[76:79], a[4:7], a[84:87], v[76:79]
    v_mfma_f32_16x16x32_bf16 v[132:135], a[0:3], a[72:75], v[132:135]
    ds_read_b64_tr_b16 a[28:29], v229 offset:57504
    v_mfma_f32_16x16x32_bf16 v[132:135], a[4:7], a[88:91], v[132:135]
    v_mfma_f32_16x16x32_bf16 v[188:191], a[0:3], a[76:79], v[188:191]
    ds_read_b64_tr_b16 a[30:31], v229 offset:59296
    v_mfma_f32_16x16x32_bf16 v[188:191], a[4:7], a[92:95], v[188:191]
    s_waitcnt lgkmcnt(8)
    v_mfma_f32_16x16x32_bf16 v[20:23], a[8:11], a[96:99], v[20:23]
    ds_read_b64_tr_b16 a[0:1], v230 offset:8352
    v_mfma_f32_16x16x32_bf16 v[20:23], a[12:15], a[112:115], v[20:23]
    v_mfma_f32_16x16x32_bf16 v[76:79], a[8:11], a[100:103], v[76:79]
    ds_read_b64_tr_b16 a[2:3], v230 offset:10144
    v_mfma_f32_16x16x32_bf16 v[76:79], a[12:15], a[116:119], v[76:79]
    v_mfma_f32_16x16x32_bf16 v[132:135], a[8:11], a[104:107], v[132:135]
    ds_read_b64_tr_b16 a[4:5], v230 offset:24736
    v_mfma_f32_16x16x32_bf16 v[132:135], a[12:15], a[120:123], v[132:135]
    v_mfma_f32_16x16x32_bf16 v[188:191], a[8:11], a[108:111], v[188:191]
    ds_read_b64_tr_b16 a[6:7], v230 offset:26528
    v_mfma_f32_16x16x32_bf16 v[188:191], a[12:15], a[124:127], v[188:191]
    s_waitcnt lgkmcnt(8)
    v_mfma_f32_16x16x32_bf16 v[20:23], a[16:19], a[128:131], v[20:23]
    ds_read_b64_tr_b16 a[8:9], v230 offset:41120
    v_mfma_f32_16x16x32_bf16 v[20:23], a[20:23], a[144:147], v[20:23]
    v_mfma_f32_16x16x32_bf16 v[76:79], a[16:19], a[132:135], v[76:79]
    ds_read_b64_tr_b16 a[10:11], v230 offset:42912
    v_mfma_f32_16x16x32_bf16 v[76:79], a[20:23], a[148:151], v[76:79]
    v_mfma_f32_16x16x32_bf16 v[132:135], a[16:19], a[136:139], v[132:135]
    ds_read_b64_tr_b16 a[12:13], v230 offset:57504
    v_mfma_f32_16x16x32_bf16 v[132:135], a[20:23], a[152:155], v[132:135]
    v_mfma_f32_16x16x32_bf16 v[188:191], a[16:19], a[140:143], v[188:191]
    ds_read_b64_tr_b16 a[14:15], v230 offset:59296
    v_mfma_f32_16x16x32_bf16 v[188:191], a[20:23], a[156:159], v[188:191]
    s_waitcnt lgkmcnt(8)
    v_mfma_f32_16x16x32_bf16 v[48:51], a[24:27], a[64:67], v[48:51]
    ds_read_b64_tr_b16 a[16:17], v229 offset:32960
    v_mfma_f32_16x16x32_bf16 v[48:51], a[28:31], a[80:83], v[48:51]
    v_mfma_f32_16x16x32_bf16 v[104:107], a[24:27], a[68:71], v[104:107]
    ds_read_b64_tr_b16 a[18:19], v229 offset:34752
    v_mfma_f32_16x16x32_bf16 v[104:107], a[28:31], a[84:87], v[104:107]
    v_mfma_f32_16x16x32_bf16 v[160:163], a[24:27], a[72:75], v[160:163]
    ds_read_b64_tr_b16 a[20:21], v229 offset:49344
    v_mfma_f32_16x16x32_bf16 v[160:163], a[28:31], a[88:91], v[160:163]
    v_mfma_f32_16x16x32_bf16 v[216:219], a[24:27], a[76:79], v[216:219]
    ds_read_b64_tr_b16 a[22:23], v229 offset:51136
    v_mfma_f32_16x16x32_bf16 v[216:219], a[28:31], a[92:95], v[216:219]
    s_waitcnt lgkmcnt(8)
    v_mfma_f32_16x16x32_bf16 v[48:51], a[0:3], a[96:99], v[48:51]
    ds_read_b64_tr_b16 a[24:25], v230 offset:192
    v_mfma_f32_16x16x32_bf16 v[48:51], a[4:7], a[112:115], v[48:51]
    v_mfma_f32_16x16x32_bf16 v[104:107], a[0:3], a[100:103], v[104:107]
    ds_read_b64_tr_b16 a[26:27], v230 offset:1984
    v_mfma_f32_16x16x32_bf16 v[104:107], a[4:7], a[116:119], v[104:107]
    v_mfma_f32_16x16x32_bf16 v[160:163], a[0:3], a[104:107], v[160:163]
    ds_read_b64_tr_b16 a[28:29], v230 offset:16576
    v_mfma_f32_16x16x32_bf16 v[160:163], a[4:7], a[120:123], v[160:163]
    v_mfma_f32_16x16x32_bf16 v[216:219], a[0:3], a[108:111], v[216:219]
    ds_read_b64_tr_b16 a[30:31], v230 offset:18368
    v_mfma_f32_16x16x32_bf16 v[216:219], a[4:7], a[124:127], v[216:219]
    s_waitcnt lgkmcnt(8)
    v_mfma_f32_16x16x32_bf16 v[48:51], a[8:11], a[128:131], v[48:51]
    ds_read_b64_tr_b16 a[0:1], v230 offset:32960
    v_mfma_f32_16x16x32_bf16 v[48:51], a[12:15], a[144:147], v[48:51]
    v_mfma_f32_16x16x32_bf16 v[104:107], a[8:11], a[132:135], v[104:107]
    ds_read_b64_tr_b16 a[2:3], v230 offset:34752
    v_mfma_f32_16x16x32_bf16 v[104:107], a[12:15], a[148:151], v[104:107]
    v_mfma_f32_16x16x32_bf16 v[160:163], a[8:11], a[136:139], v[160:163]
    ds_read_b64_tr_b16 a[4:5], v230 offset:49344
    v_mfma_f32_16x16x32_bf16 v[160:163], a[12:15], a[152:155], v[160:163]
    v_mfma_f32_16x16x32_bf16 v[216:219], a[8:11], a[140:143], v[216:219]
    ds_read_b64_tr_b16 a[6:7], v230 offset:51136
    v_mfma_f32_16x16x32_bf16 v[216:219], a[12:15], a[156:159], v[216:219]
    s_waitcnt lgkmcnt(8)
    v_mfma_f32_16x16x32_bf16 v[24:27], a[16:19], a[64:67], v[24:27]
    ds_read_b64_tr_b16 a[8:9], v229 offset:41152
    v_mul_f32 v16, v16, v44
    v_mfma_f32_16x16x32_bf16 v[24:27], a[20:23], a[80:83], v[24:27]
    v_mul_f32 v17, v17, v45
    v_mul_f32 v18, v18, v46
    v_mfma_f32_16x16x32_bf16 v[80:83], a[16:19], a[68:71], v[80:83]
    ds_read_b64_tr_b16 a[10:11], v229 offset:42944
    v_mul_f32 v19, v19, v47
    v_mfma_f32_16x16x32_bf16 v[80:83], a[20:23], a[84:87], v[80:83]
    v_mul_f32 v20, v20, v48
    v_mul_f32 v21, v21, v49
    v_mfma_f32_16x16x32_bf16 v[136:139], a[16:19], a[72:75], v[136:139]
    ds_read_b64_tr_b16 a[12:13], v229 offset:57536
    v_mul_f32 v22, v22, v50
    v_mfma_f32_16x16x32_bf16 v[136:139], a[20:23], a[88:91], v[136:139]
    v_mul_f32 v23, v23, v51
    v_cvt_pk_bf16_f32 v240, v16, v17
    v_mfma_f32_16x16x32_bf16 v[192:195], a[16:19], a[76:79], v[192:195]
    ds_read_b64_tr_b16 a[14:15], v229 offset:59328
    v_cvt_pk_bf16_f32 v241, v18, v19
    v_mfma_f32_16x16x32_bf16 v[192:195], a[20:23], a[92:95], v[192:195]
    v_cvt_pk_bf16_f32 v242, v20, v21
    v_cvt_pk_bf16_f32 v243, v22, v23
    s_waitcnt lgkmcnt(8)
    v_mfma_f32_16x16x32_bf16 v[24:27], a[24:27], a[96:99], v[24:27]
    ds_read_b64_tr_b16 a[16:17], v230 offset:8384
    buffer_store_dwordx4 v[240:243], v228, s[48:51], s12 offen offset:0 sc1
    v_mfma_f32_16x16x32_bf16 v[24:27], a[28:31], a[112:115], v[24:27]
    v_mul_f32 v72, v72, v100
    v_mul_f32 v73, v73, v101
    v_mfma_f32_16x16x32_bf16 v[80:83], a[24:27], a[100:103], v[80:83]
    ds_read_b64_tr_b16 a[18:19], v230 offset:10176
    v_mul_f32 v74, v74, v102
    v_mfma_f32_16x16x32_bf16 v[80:83], a[28:31], a[116:119], v[80:83]
    v_mul_f32 v75, v75, v103
    v_mul_f32 v76, v76, v104
    v_mfma_f32_16x16x32_bf16 v[136:139], a[24:27], a[104:107], v[136:139]
    ds_read_b64_tr_b16 a[20:21], v230 offset:24768
    v_mul_f32 v77, v77, v105
    v_mfma_f32_16x16x32_bf16 v[136:139], a[28:31], a[120:123], v[136:139]
    v_mul_f32 v78, v78, v106
    v_mul_f32 v79, v79, v107
    v_mfma_f32_16x16x32_bf16 v[192:195], a[24:27], a[108:111], v[192:195]
    ds_read_b64_tr_b16 a[22:23], v230 offset:26560
    v_cvt_pk_bf16_f32 v244, v72, v73
    v_mfma_f32_16x16x32_bf16 v[192:195], a[28:31], a[124:127], v[192:195]
    v_cvt_pk_bf16_f32 v245, v74, v75
    v_cvt_pk_bf16_f32 v246, v76, v77
    s_waitcnt lgkmcnt(8)
    v_mfma_f32_16x16x32_bf16 v[24:27], a[0:3], a[128:131], v[24:27]
    ds_read_b64_tr_b16 a[24:25], v230 offset:41152
    v_cvt_pk_bf16_f32 v247, v78, v79
    v_mfma_f32_16x16x32_bf16 v[24:27], a[4:7], a[144:147], v[24:27]
    buffer_store_dwordx4 v[244:247], v228, s[48:51], s12 offen offset:1024 sc1
    v_mul_f32 v128, v128, v156
    v_mfma_f32_16x16x32_bf16 v[80:83], a[0:3], a[132:135], v[80:83]
    ds_read_b64_tr_b16 a[26:27], v230 offset:42944
    v_mul_f32 v129, v129, v157
    v_mfma_f32_16x16x32_bf16 v[80:83], a[4:7], a[148:151], v[80:83]
    v_mul_f32 v130, v130, v158
    v_mul_f32 v131, v131, v159
    v_mfma_f32_16x16x32_bf16 v[136:139], a[0:3], a[136:139], v[136:139]
    ds_read_b64_tr_b16 a[28:29], v230 offset:57536
    v_mul_f32 v132, v132, v160
    v_mfma_f32_16x16x32_bf16 v[136:139], a[4:7], a[152:155], v[136:139]
    v_mul_f32 v133, v133, v161
    v_mul_f32 v134, v134, v162
    v_mfma_f32_16x16x32_bf16 v[192:195], a[0:3], a[140:143], v[192:195]
    ds_read_b64_tr_b16 a[30:31], v230 offset:59328
    v_mul_f32 v135, v135, v163
    v_mfma_f32_16x16x32_bf16 v[192:195], a[4:7], a[156:159], v[192:195]
    v_cvt_pk_bf16_f32 v248, v128, v129
    v_cvt_pk_bf16_f32 v249, v130, v131
    s_waitcnt lgkmcnt(8)
    v_mfma_f32_16x16x32_bf16 v[52:55], a[8:11], a[64:67], v[52:55]
    v_cvt_pk_bf16_f32 v250, v132, v133
    v_cvt_pk_bf16_f32 v251, v134, v135
    v_mfma_f32_16x16x32_bf16 v[52:55], a[12:15], a[80:83], v[52:55]
    buffer_store_dwordx4 v[248:251], v228, s[48:51], s12 offen offset:2048 sc1
    v_mul_f32 v184, v184, v212
    v_mfma_f32_16x16x32_bf16 v[108:111], a[8:11], a[68:71], v[108:111]
    v_mul_f32 v185, v185, v213
    v_mul_f32 v186, v186, v214
    v_mfma_f32_16x16x32_bf16 v[108:111], a[12:15], a[84:87], v[108:111]
    v_mul_f32 v187, v187, v215
    v_mul_f32 v188, v188, v216
    v_mfma_f32_16x16x32_bf16 v[164:167], a[8:11], a[72:75], v[164:167]
    v_mul_f32 v189, v189, v217
    v_mul_f32 v190, v190, v218
    v_mfma_f32_16x16x32_bf16 v[164:167], a[12:15], a[88:91], v[164:167]
    v_mul_f32 v191, v191, v219
    v_cvt_pk_bf16_f32 v252, v184, v185
    v_mfma_f32_16x16x32_bf16 v[220:223], a[8:11], a[76:79], v[220:223]
    v_cvt_pk_bf16_f32 v253, v186, v187
    v_cvt_pk_bf16_f32 v254, v188, v189
    v_mfma_f32_16x16x32_bf16 v[220:223], a[12:15], a[92:95], v[220:223]
    v_cvt_pk_bf16_f32 v255, v190, v191
    buffer_store_dwordx4 v[252:255], v228, s[48:51], s12 offen offset:3072 sc1
    s_waitcnt lgkmcnt(4)
    v_mfma_f32_16x16x32_bf16 v[52:55], a[16:19], a[96:99], v[52:55]
    v_mfma_f32_16x16x32_bf16 v[52:55], a[20:23], a[112:115], v[52:55]
    v_mfma_f32_16x16x32_bf16 v[108:111], a[16:19], a[100:103], v[108:111]
    v_mfma_f32_16x16x32_bf16 v[108:111], a[20:23], a[116:119], v[108:111]
    v_mfma_f32_16x16x32_bf16 v[164:167], a[16:19], a[104:107], v[164:167]
    v_mfma_f32_16x16x32_bf16 v[164:167], a[20:23], a[120:123], v[164:167]
    v_mfma_f32_16x16x32_bf16 v[220:223], a[16:19], a[108:111], v[220:223]
    v_mfma_f32_16x16x32_bf16 v[220:223], a[20:23], a[124:127], v[220:223]
    s_waitcnt lgkmcnt(0)
    v_mfma_f32_16x16x32_bf16 v[52:55], a[24:27], a[128:131], v[52:55]
    v_mfma_f32_16x16x32_bf16 v[52:55], a[28:31], a[144:147], v[52:55]
    v_mfma_f32_16x16x32_bf16 v[108:111], a[24:27], a[132:135], v[108:111]
    v_mfma_f32_16x16x32_bf16 v[108:111], a[28:31], a[148:151], v[108:111]
    v_mfma_f32_16x16x32_bf16 v[164:167], a[24:27], a[136:139], v[164:167]
    v_mul_f32 v24, v24, v52
    v_mul_f32 v25, v25, v53
    v_mul_f32 v26, v26, v54
    v_mfma_f32_16x16x32_bf16 v[164:167], a[28:31], a[152:155], v[164:167]
    v_mul_f32 v27, v27, v55
    v_cvt_pk_bf16_f32 v240, v24, v25
    v_cvt_pk_bf16_f32 v241, v26, v27
    v_mfma_f32_16x16x32_bf16 v[220:223], a[24:27], a[140:143], v[220:223]
    buffer_store_dwordx2 v[240:241], v228, s[48:51], s13 offen offset:0 sc1
    v_mul_f32 v80, v80, v108
    v_mul_f32 v81, v81, v109
    v_mfma_f32_16x16x32_bf16 v[220:223], a[28:31], a[156:159], v[220:223]
    v_mul_f32 v82, v82, v110
    v_mul_f32 v83, v83, v111
    v_cvt_pk_bf16_f32 v244, v80, v81
    v_cvt_pk_bf16_f32 v245, v82, v83
    buffer_store_dwordx2 v[244:245], v228, s[48:51], s13 offen offset:1024 sc1
    v_mul_f32 v136, v136, v164
    v_mul_f32 v137, v137, v165
    v_mul_f32 v138, v138, v166
    v_mul_f32 v139, v139, v167
    v_cvt_pk_bf16_f32 v248, v136, v137
    v_cvt_pk_bf16_f32 v249, v138, v139
    buffer_store_dwordx2 v[248:249], v228, s[48:51], s13 offen offset:2048 sc1
    v_mul_f32 v192, v192, v220
    v_mul_f32 v193, v193, v221
    v_mul_f32 v194, v194, v222
    v_mul_f32 v195, v195, v223
    v_cvt_pk_bf16_f32 v252, v192, v193
    v_cvt_pk_bf16_f32 v253, v194, v195
    buffer_store_dwordx2 v[252:253], v228, s[48:51], s13 offen offset:3072 sc1
    v_mbcnt_lo_u32_b32 v96, -1, 0
    v_mbcnt_hi_u32_b32 v96, -1, v96
    s_lshr_b32 s3, s33, 1
    s_lshl_b32 s3, s3, 2
    s_and_b32 s16, s34, 3
    s_add_u32 s8, s3, s16
    s_lshr_b32 s9, s33, 1
    s_lshl_b32 s9, s9, 2
    s_lshr_b32 s9, 8193, s9
    s_and_b32 s9, s9, 15
    s_lshr_b32 s61, s34, 2
    s_xor_b32 s9, s9, s61
    s_and_b32 s10, s33, 1
    s_lshl_b32 s3, s8, 3
    s_lshl_b32 s16, s32, 1
    s_add_u32 s11, s3, s16
    s_lshl_b32 s3, s11, 10
    v_lshlrev_b32 v67, 4, v96
    v_add_u32 v67, s3, v67
    v_lshrrev_b32 v97, 4, v96
    v_bfe_u32 v98, v96, 2, 2
    v_lshl_add_u32 v97, v97, 2, v98
    v_and_b32 v98, 7, v97
    s_lshl_b32 s3, s10, 2
    v_xor_b32 v98, s3, v98
    v_and_b32 v99, 3, v96
    v_lshlrev_b32 v99, 3, v99
    v_lshl_add_u32 v99, v97, 8, v99
    v_xor_b32 v100, 0, v98
    v_lshl_add_u32 v72, v100, 5, v99
    v_add_u32 v80, 0x10000, v72
    v_add_u32 v88, 0x20000, v72
    v_xor_b32 v100, 1, v98
    v_lshl_add_u32 v73, v100, 5, v99
    v_add_u32 v81, 0x10000, v73
    v_add_u32 v89, 0x20000, v73
    v_xor_b32 v100, 2, v98
    v_lshl_add_u32 v74, v100, 5, v99
    v_add_u32 v82, 0x10000, v74
    v_add_u32 v90, 0x20000, v74
    v_xor_b32 v100, 3, v98
    v_lshl_add_u32 v75, v100, 5, v99
    v_add_u32 v83, 0x10000, v75
    v_add_u32 v91, 0x20000, v75
    v_xor_b32 v100, 4, v98
    v_lshl_add_u32 v76, v100, 5, v99
    v_add_u32 v84, 0x10000, v76
    v_add_u32 v92, 0x20000, v76
    v_xor_b32 v100, 5, v98
    v_lshl_add_u32 v77, v100, 5, v99
    v_add_u32 v85, 0x10000, v77
    v_add_u32 v93, 0x20000, v77
    v_xor_b32 v100, 6, v98
    v_lshl_add_u32 v78, v100, 5, v99
    v_add_u32 v86, 0x10000, v78
    v_add_u32 v94, 0x20000, v78
    v_xor_b32 v100, 7, v98
    v_lshl_add_u32 v79, v100, 5, v99
    v_add_u32 v87, 0x10000, v79
    v_add_u32 v95, 0x20000, v79
    v_and_b32 v97, 15, v96
    v_lshrrev_b32 v98, 4, v96
    v_and_b32 v99, 1, v98
    v_lshlrev_b32 v99, 5, v99
    v_lshrrev_b32 v98, 1, v98
    v_lshl_add_u32 v99, v98, 4, v99
    v_lshl_add_u32 v99, v97, 11, v99
    s_lshl_b32 s3, s11, 15
    s_lshl_b32 s16, s9, 8
    s_add_u32 s3, s3, s16
    s_lshl_b32 s16, s10, 7
    s_add_u32 s3, s3, s16
    v_add_u32 v68, s3, v99
    v_lshrrev_b32 v71, 11, v68
    v_mul_u32_u24 v71, 0, v71
    v_add_u32 v71, v71, v68
    s_lshl_b32 s3, s2, 2
    s_add_u32 s3, s3, s32
    s_lshl_b32 s3, s3, 12
    v_lshlrev_b32 v97, 4, v96
    v_add_u32 v69, s3, v97
    s_xor_b32 s16, s2, 1
    s_lshl_b32 s16, s16, 2
    s_add_u32 s16, s16, s32
    s_lshl_b32 s16, s16, 12
    v_add_u32 v70, s16, v97
    s_bfe_u32 s3, s21, 262148
    s_lshl3_add_u32 s3, s10, s3
    s_mul_i32 s6, s3, 458752
    s_bfe_u32 s3, s21, 262152
    s_lshl3_add_u32 s3, s10, s3
    s_mul_i32 s7, s3, 458752
    s_bfe_u32 s3, s21, 262156
    s_lshl3_add_u32 s3, s10, s3
    s_mul_i32 s12, s3, 458752
    s_bfe_u32 s3, s21, 262160
    s_lshl3_add_u32 s3, s10, s3
    s_mul_i32 s13, s3, 458752
    s_bfe_u32 s3, s21, 262164
    s_lshl3_add_u32 s3, s10, s3
    s_mul_i32 s18, s3, 458752
    s_bfe_u32 s3, s21, 262168
    s_lshl3_add_u32 s3, s10, s3
    s_mul_i32 s19, s3, 458752
    s_bfe_u32 s3, s21, 262172
    s_lshl3_add_u32 s3, s10, s3
    s_mul_i32 s20, s3, 458752
    s_and_b32 s3, s34, 3
    s_lshl_b32 s3, s3, 2
    s_add_u32 s3, s3, s32
    s_lshl_b32 s16, s3, 4
    v_lshrrev_b32 v97, 2, v96
    v_add_u32 v97, s16, v97
    v_mul_u32_u24 v97, 2048, v97
    v_and_b32 v98, 3, v96
    v_lshl_add_u32 v97, v98, 6, v97
    s_lshl_b32 s16, s9, 8
    v_add_u32 v97, s16, v97
    s_cmp_lt_u32 s3, 14
    s_cselect_b32 s3, 0, 0x7ff00000
    v_add_u32 v103, s3, v97
    v_lshrrev_b32 v97, 1, v96
    v_lshlrev_b32 v97, 2, v97
    v_mov_b32 v98, s21
    v_lshrrev_b32 v97, v97, v98
    v_and_b32 v97, 15, v97
    v_and_b32 v98, 1, v96
    v_lshl_add_u32 v97, v97, 1, v98
    s_lshr_b32 s3, s8, 1
    s_lshl_b32 s3, s3, 5
    s_lshl_b32 s16, s10, 4
    s_add_u32 s3, s3, s16
    v_add_u32 v97, s3, v97
    s_and_b32 s3, s8, 1
    s_lshl_b32 s3, s3, 1
    s_lshr_b32 s16, s32, 1
    s_add_u32 s3, s3, s16
    v_lshl_add_u32 v97, v97, 2, s3
    s_xor_b32 s3, s4, 4
    s_lshl_b32 s3, s3, 5
    s_xor_b32 s16, s5, 0
    s_add_u32 s3, s3, s16
    s_lshl_b32 s3, s3, 2
    s_add_u32 s3, s3, s32
    v_mov_b32 v98, s3
    v_cmp_gt_u32 vcc, 16, v96
    s_nop 1
    v_cndmask_b32 v97, v98, v97, vcc
    v_lshlrev_b32 v97, 7, v97
    v_add_u32 v97, 131072, v97
    s_lshl_b32 s3, s8, 4
    s_lshl_b32 s16, s32, 2
    s_add_u32 s3, s3, s16
    s_sub_u32 s3, s3, 17
    v_add_u32 v98, s3, v96
    v_lshlrev_b32 v98, 7, v98
    v_add_u32 v98, 262144, v98
    v_cmp_gt_u32 vcc, 17, v96
    s_nop 1
    v_cndmask_b32 v97, v98, v97, vcc
    v_mov_b32 v98, 0x7ff00000
    v_cmp_gt_u32 vcc, 17, v96
    s_nop 1
    v_cndmask_b32 v66, v98, v97, vcc
    s_lshl_b32 s3, s4, 5
    s_add_u32 s3, s3, s5
    s_lshl_b32 s3, s3, 2
    s_add_u32 s3, s3, s32
    s_lshl_b32 s3, s3, 7
    s_add_u32 s3, s3, 131072
    s_add_u32 s62, s30, 4
    s_addc_u32 s63, s31, 0
    buffer_load_dwordx2 v[64:65], v66, s[36:39], 0 offen sc1
    v_mov_b32 v96, s62
    v_mov_b32 v97, s63
    v_mov_b32 v98, 0x7ff00000
    v_writelane_b32 v98, 0, 0
    s_waitcnt vmcnt(0)
    buffer_store_dwordx2 v[96:97], v98, s[36:39], s3 offen sc1
    v_cmp_ne_u64 vcc, s[62:63], v[64:65]
    s_nop 4
    s_and_b32 s3, vcc_lo, 0x3
    s_cbranch_scc1 L_fused_kernel_fs_23
L_fused_kernel_fb_24:
    s_mov_b32 s44, s24
    s_mov_b32 s45, s25
    s_mov_b32 s46, 4194304
    s_mov_b32 s47, 0x20000
    s_add_u32 s52, s28, 28311552
    s_addc_u32 s53, s29, 0
    s_mov_b32 s54, 4194304
    s_mov_b32 s55, 0x20000
    s_lshl1_add_u32 s8, s15, 0
    buffer_load_dwordx4 a[0:3], v67, s[48:51], s8 offen offset:0 sc1
    buffer_load_dwordx4 a[4:7], v67, s[48:51], s8 offen offset:1024 sc1
    s_lshl1_add_u32 s8, s15, 131072
    buffer_load_dwordx4 a[8:11], v67, s[48:51], s8 offen offset:0 sc1
    buffer_load_dwordx4 a[12:15], v67, s[48:51], s8 offen offset:1024 sc1
    s_lshl1_add_u32 s8, s15, 262144
    buffer_load_dwordx4 a[16:19], v67, s[48:51], s8 offen offset:0 sc1
    buffer_load_dwordx4 a[20:23], v67, s[48:51], s8 offen offset:1024 sc1
    s_lshl1_add_u32 s8, s15, 393216
    buffer_load_dwordx4 a[24:27], v67, s[48:51], s8 offen offset:0 sc1
    buffer_load_dwordx4 a[28:31], v67, s[48:51], s8 offen offset:1024 sc1
    s_barrier
    ds_read_b64_tr_b16 a[80:81], v88 offset:0
    ds_read_b64_tr_b16 a[82:83], v88 offset:4096
    ds_read_b64_tr_b16 a[84:85], v88 offset:8192
    ds_read_b64_tr_b16 a[86:87], v88 offset:12288
    ds_read_b64_tr_b16 a[88:89], v89 offset:0
    ds_read_b64_tr_b16 a[90:91], v89 offset:4096
    ds_read_b64_tr_b16 a[92:93], v89 offset:8192
    ds_read_b64_tr_b16 a[94:95], v89 offset:12288
    ds_read_b64_tr_b16 a[96:97], v90 offset:0
    ds_read_b64_tr_b16 a[98:99], v90 offset:4096
    ds_read_b64_tr_b16 a[100:101], v90 offset:8192
    ds_read_b64_tr_b16 a[102:103], v90 offset:12288
    ds_read_b64_tr_b16 a[104:105], v91 offset:0
    ds_read_b64_tr_b16 a[106:107], v91 offset:4096
    ds_read_b64_tr_b16 a[108:109], v91 offset:8192
    ds_read_b64_tr_b16 a[110:111], v91 offset:12288
    s_waitcnt vmcnt(4) lgkmcnt(8)
    v_mfma_f32_16x16x32_bf16 v[0:3], a[80:83], a[0:3], 0
    ds_read_b64_tr_b16 a[112:113], v92 offset:0
    buffer_load_dwordx2 v[64:65], v66, s[36:39], 0 offen sc1
    v_mfma_f32_16x16x32_bf16 v[0:3], a[84:87], a[8:11], v[0:3]
    ds_read_b64_tr_b16 a[114:115], v92 offset:4096
    s_lshl1_add_u32 s8, s15, 524288
    v_mfma_f32_16x16x32_bf16 v[32:35], a[80:83], a[4:7], 0
    ds_read_b64_tr_b16 a[116:117], v92 offset:8192
    buffer_load_dwordx4 a[32:35], v67, s[48:51], s8 offen offset:0 sc1
    v_mfma_f32_16x16x32_bf16 v[32:35], a[84:87], a[12:15], v[32:35]
    ds_read_b64_tr_b16 a[118:119], v92 offset:12288
    v_mfma_f32_16x16x32_bf16 v[4:7], a[88:91], a[0:3], 0
    ds_read_b64_tr_b16 a[120:121], v93 offset:0
    buffer_load_dwordx4 a[36:39], v67, s[48:51], s8 offen offset:1024 sc1
    v_mfma_f32_16x16x32_bf16 v[4:7], a[92:95], a[8:11], v[4:7]
    ds_read_b64_tr_b16 a[122:123], v93 offset:4096
    s_add_u32 s60, s15, 294912
    v_mfma_f32_16x16x32_bf16 v[36:39], a[88:91], a[4:7], 0
    ds_read_b64_tr_b16 a[124:125], v93 offset:8192
    s_add_u32 m0, s14, 0
    v_mfma_f32_16x16x32_bf16 v[36:39], a[92:95], a[12:15], v[36:39]
    ds_read_b64_tr_b16 a[126:127], v93 offset:12288
    s_waitcnt lgkmcnt(8)
    v_mfma_f32_16x16x32_bf16 v[8:11], a[96:99], a[0:3], 0
    ds_read_b64_tr_b16 a[80:81], v94 offset:0
    buffer_load_dwordx4 v234, s[56:59], s60 offen offset:0  lds
    v_mfma_f32_16x16x32_bf16 v[8:11], a[100:103], a[8:11], v[8:11]
    ds_read_b64_tr_b16 a[82:83], v94 offset:4096
    v_mfma_f32_16x16x32_bf16 v[40:43], a[96:99], a[4:7], 0
    ds_read_b64_tr_b16 a[84:85], v94 offset:8192
    buffer_load_dwordx4 v235, s[56:59], s60 offen offset:1024  lds
    v_mfma_f32_16x16x32_bf16 v[40:43], a[100:103], a[12:15], v[40:43]
    ds_read_b64_tr_b16 a[86:87], v94 offset:12288
    s_lshl1_add_u32 s8, s15, 655360
    v_mfma_f32_16x16x32_bf16 v[12:15], a[104:107], a[0:3], 0
    ds_read_b64_tr_b16 a[88:89], v95 offset:0
    buffer_load_dwordx4 a[40:43], v67, s[48:51], s8 offen offset:0 sc1
    v_mfma_f32_16x16x32_bf16 v[12:15], a[108:111], a[8:11], v[12:15]
    ds_read_b64_tr_b16 a[90:91], v95 offset:4096
    v_mfma_f32_16x16x32_bf16 v[44:47], a[104:107], a[4:7], 0
    ds_read_b64_tr_b16 a[92:93], v95 offset:8192
    buffer_load_dwordx4 a[44:47], v67, s[48:51], s8 offen offset:1024 sc1
    v_mfma_f32_16x16x32_bf16 v[44:47], a[108:111], a[12:15], v[44:47]
    ds_read_b64_tr_b16 a[94:95], v95 offset:12288
    s_waitcnt lgkmcnt(8)
    v_mfma_f32_16x16x32_bf16 v[16:19], a[112:115], a[0:3], 0
    ds_read_b64_tr_b16 a[96:97], v88 offset:16384
    s_add_u32 s60, s15, 360448
    v_mfma_f32_16x16x32_bf16 v[16:19], a[116:119], a[8:11], v[16:19]
    ds_read_b64_tr_b16 a[98:99], v88 offset:20480
    s_add_u32 m0, s14, 8192
    v_mfma_f32_16x16x32_bf16 v[48:51], a[112:115], a[4:7], 0
    ds_read_b64_tr_b16 a[100:101], v88 offset:24576
    buffer_load_dwordx4 v234, s[56:59], s60 offen offset:0  lds
    v_mfma_f32_16x16x32_bf16 v[48:51], a[116:119], a[12:15], v[48:51]
    ds_read_b64_tr_b16 a[102:103], v88 offset:28672
    v_mfma_f32_16x16x32_bf16 v[20:23], a[120:123], a[0:3], 0
    ds_read_b64_tr_b16 a[104:105], v89 offset:16384
    buffer_load_dwordx4 v235, s[56:59], s60 offen offset:1024  lds
    v_mfma_f32_16x16x32_bf16 v[20:23], a[124:127], a[8:11], v[20:23]
    ds_read_b64_tr_b16 a[106:107], v89 offset:20480
    s_lshl1_add_u32 s8, s15, 786432
    v_mfma_f32_16x16x32_bf16 v[52:55], a[120:123], a[4:7], 0
    ds_read_b64_tr_b16 a[108:109], v89 offset:24576
    buffer_load_dwordx4 a[48:51], v67, s[48:51], s8 offen offset:0 sc1
    v_mfma_f32_16x16x32_bf16 v[52:55], a[124:127], a[12:15], v[52:55]
    ds_read_b64_tr_b16 a[110:111], v89 offset:28672
    s_waitcnt lgkmcnt(8)
    v_mfma_f32_16x16x32_bf16 v[24:27], a[80:83], a[0:3], 0
    ds_read_b64_tr_b16 a[112:113], v90 offset:16384
    buffer_load_dwordx4 a[52:55], v67, s[48:51], s8 offen offset:1024 sc1
    v_mfma_f32_16x16x32_bf16 v[24:27], a[84:87], a[8:11], v[24:27]
    s_branch L_fused_kernel_pc10
L_fused_kernel_isl0_10:
    s_branch L_fused_kernel_isl0_14
L_fused_kernel_pc10:
    ds_read_b64_tr_b16 a[114:115], v90 offset:20480
    s_add_u32 s60, s17, s15
    v_mfma_f32_16x16x32_bf16 v[56:59], a[80:83], a[4:7], 0
    ds_read_b64_tr_b16 a[116:117], v90 offset:24576
    s_add_u32 m0, s14, 16384
    v_mfma_f32_16x16x32_bf16 v[56:59], a[84:87], a[12:15], v[56:59]
    ds_read_b64_tr_b16 a[118:119], v90 offset:28672
    buffer_load_dwordx4 v234, s[56:59], s60 offen offset:0  lds
    v_mfma_f32_16x16x32_bf16 v[28:31], a[88:91], a[0:3], 0
    ds_read_b64_tr_b16 a[120:121], v91 offset:16384
    v_mfma_f32_16x16x32_bf16 v[28:31], a[92:95], a[8:11], v[28:31]
    ds_read_b64_tr_b16 a[122:123], v91 offset:20480
    buffer_load_dwordx4 v235, s[56:59], s60 offen offset:1024  lds
    v_mfma_f32_16x16x32_bf16 v[60:63], a[88:91], a[4:7], 0
    ds_read_b64_tr_b16 a[124:125], v91 offset:24576
    s_add_u32 s60, s6, 0
    v_mfma_f32_16x16x32_bf16 v[60:63], a[92:95], a[12:15], v[60:63]
    ds_read_b64_tr_b16 a[126:127], v91 offset:28672
    s_waitcnt vmcnt(13) lgkmcnt(8)
    v_mfma_f32_16x16x32_bf16 v[0:3], a[96:99], a[16:19], v[0:3]
    ds_read_b64_tr_b16 a[80:81], v92 offset:16384
    s_add_u32 m0, s14, 24576
    v_mfma_f32_16x16x32_bf16 v[0:3], a[100:103], a[24:27], v[0:3]
    ds_read_b64_tr_b16 a[82:83], v92 offset:20480
    buffer_load_dwordx4 v234, s[56:59], s60 offen offset:0  lds
    v_mfma_f32_16x16x32_bf16 v[32:35], a[96:99], a[20:23], v[32:35]
    ds_read_b64_tr_b16 a[84:85], v92 offset:24576
    v_mfma_f32_16x16x32_bf16 v[32:35], a[100:103], a[28:31], v[32:35]
    ds_read_b64_tr_b16 a[86:87], v92 offset:28672
    buffer_load_dwordx4 v235, s[56:59], s60 offen offset:1024  lds
    v_mfma_f32_16x16x32_bf16 v[4:7], a[104:107], a[16:19], v[4:7]
    ds_read_b64_tr_b16 a[88:89], v93 offset:16384
    s_waitcnt vmcnt(14)
    v_mfma_f32_16x16x32_bf16 v[4:7], a[108:111], a[24:27], v[4:7]
    ds_read_b64_tr_b16 a[90:91], v93 offset:20480
    v_cmp_ne_u64 vcc, s[62:63], v[64:65]
    v_mfma_f32_16x16x32_bf16 v[36:39], a[104:107], a[20:23], v[36:39]
    ds_read_b64_tr_b16 a[92:93], v93 offset:24576
    s_nop 4
    v_mfma_f32_16x16x32_bf16 v[36:39], a[108:111], a[28:31], v[36:39]
    ds_read_b64_tr_b16 a[94:95], v93 offset:28672
    s_waitcnt lgkmcnt(8)
    v_mfma_f32_16x16x32_bf16 v[8:11], a[112:115], a[16:19], v[8:11]
    ds_read_b64_tr_b16 a[96:97], v94 offset:16384
    s_and_b32 s3, vcc_lo, 0xc
    v_mfma_f32_16x16x32_bf16 v[8:11], a[116:119], a[24:27], v[8:11]
    ds_read_b64_tr_b16 a[98:99], v94 offset:20480
    s_cbranch_scc1 L_fused_kernel_fs_26
L_fused_kernel_fb_27:
    v_mfma_f32_16x16x32_bf16 v[40:43], a[112:115], a[20:23], v[40:43]
    ds_read_b64_tr_b16 a[100:101], v94 offset:24576
    s_lshl1_add_u32 s8, s6, 0
    v_mfma_f32_16x16x32_bf16 v[40:43], a[116:119], a[28:31], v[40:43]
    ds_read_b64_tr_b16 a[102:103], v94 offset:28672
    buffer_load_dwordx4 a[56:59], v67, s[48:51], s8 offen offset:0 sc1
    v_mfma_f32_16x16x32_bf16 v[12:15], a[120:123], a[16:19], v[12:15]
    ds_read_b64_tr_b16 a[104:105], v95 offset:16384
    v_mfma_f32_16x16x32_bf16 v[12:15], a[124:127], a[24:27], v[12:15]
    ds_read_b64_tr_b16 a[106:107], v95 offset:20480
    buffer_load_dwordx4 a[60:63], v67, s[48:51], s8 offen offset:1024 sc1
    v_mfma_f32_16x16x32_bf16 v[44:47], a[120:123], a[20:23], v[44:47]
    ds_read_b64_tr_b16 a[108:109], v95 offset:24576
    v_mfma_f32_16x16x32_bf16 v[44:47], a[124:127], a[28:31], v[44:47]
    ds_read_b64_tr_b16 a[110:111], v95 offset:28672
    s_waitcnt vmcnt(8) lgkmcnt(8)
    s_barrier
    v_mfma_f32_16x16x32_bf16 v[16:19], a[80:83], a[16:19], v[16:19]
    ds_read_b64_tr_b16 a[112:113], v72 offset:0
    buffer_load_dwordx2 v[64:65], v66, s[36:39], 0 offen sc1
    v_mfma_f32_16x16x32_bf16 v[16:19], a[84:87], a[24:27], v[16:19]
    ds_read_b64_tr_b16 a[114:115], v72 offset:4096
    s_lshl1_add_u32 s8, s6, 131072
    v_mfma_f32_16x16x32_bf16 v[48:51], a[80:83], a[20:23], v[48:51]
    ds_read_b64_tr_b16 a[116:117], v72 offset:8192
    buffer_load_dwordx4 a[64:67], v67, s[48:51], s8 offen offset:0 sc1
    v_mfma_f32_16x16x32_bf16 v[48:51], a[84:87], a[28:31], v[48:51]
    ds_read_b64_tr_b16 a[118:119], v72 offset:12288
    v_mfma_f32_16x16x32_bf16 v[20:23], a[88:91], a[16:19], v[20:23]
    ds_read_b64_tr_b16 a[120:121], v73 offset:0
    buffer_load_dwordx4 a[68:71], v67, s[48:51], s8 offen offset:1024 sc1
    v_mfma_f32_16x16x32_bf16 v[20:23], a[92:95], a[24:27], v[20:23]
    ds_read_b64_tr_b16 a[122:123], v73 offset:4096
    s_add_u32 s60, s6, 65536
    v_mfma_f32_16x16x32_bf16 v[52:55], a[88:91], a[20:23], v[52:55]
    ds_read_b64_tr_b16 a[124:125], v73 offset:8192
    s_add_u32 m0, s14, 32768
    v_mfma_f32_16x16x32_bf16 v[52:55], a[92:95], a[28:31], v[52:55]
    ds_read_b64_tr_b16 a[126:127], v73 offset:12288
    s_waitcnt lgkmcnt(8)
    v_mfma_f32_16x16x32_bf16 v[24:27], a[96:99], a[16:19], v[24:27]
    ds_read_b64_tr_b16 a[80:81], v74 offset:0
    buffer_load_dwordx4 v234, s[56:59], s60 offen offset:0  lds
    v_mfma_f32_16x16x32_bf16 v[24:27], a[100:103], a[24:27], v[24:27]
    ds_read_b64_tr_b16 a[82:83], v74 offset:4096
    v_mfma_f32_16x16x32_bf16 v[56:59], a[96:99], a[20:23], v[56:59]
    ds_read_b64_tr_b16 a[84:85], v74 offset:8192
    buffer_load_dwordx4 v235, s[56:59], s60 offen offset:1024  lds
    v_mfma_f32_16x16x32_bf16 v[56:59], a[100:103], a[28:31], v[56:59]
    ds_read_b64_tr_b16 a[86:87], v74 offset:12288
    s_lshl1_add_u32 s8, s6, 262144
    v_mfma_f32_16x16x32_bf16 v[28:31], a[104:107], a[16:19], v[28:31]
    ds_read_b64_tr_b16 a[88:89], v75 offset:0
    buffer_load_dwordx4 a[72:75], v67, s[48:51], s8 offen offset:0 sc1
    v_mfma_f32_16x16x32_bf16 v[28:31], a[108:111], a[24:27], v[28:31]
    ds_read_b64_tr_b16 a[90:91], v75 offset:4096
    v_mfma_f32_16x16x32_bf16 v[60:63], a[104:107], a[20:23], v[60:63]
    ds_read_b64_tr_b16 a[92:93], v75 offset:8192
    buffer_load_dwordx4 a[76:79], v67, s[48:51], s8 offen offset:1024 sc1
    v_mfma_f32_16x16x32_bf16 v[60:63], a[108:111], a[28:31], v[60:63]
    ds_read_b64_tr_b16 a[94:95], v75 offset:12288
    s_waitcnt lgkmcnt(8)
    v_mfma_f32_16x16x32_bf16 v[0:3], a[112:115], a[32:35], v[0:3]
    ds_read_b64_tr_b16 a[96:97], v76 offset:0
    s_add_u32 s60, s6, 131072
    v_mfma_f32_16x16x32_bf16 v[0:3], a[116:119], a[40:43], v[0:3]
    ds_read_b64_tr_b16 a[98:99], v76 offset:4096
    s_add_u32 m0, s14, 40960
    v_mfma_f32_16x16x32_bf16 v[32:35], a[112:115], a[36:39], v[32:35]
    ds_read_b64_tr_b16 a[100:101], v76 offset:8192
    buffer_load_dwordx4 v234, s[56:59], s60 offen offset:0  lds
    v_mfma_f32_16x16x32_bf16 v[32:35], a[116:119], a[44:47], v[32:35]
    ds_read_b64_tr_b16 a[102:103], v76 offset:12288
    v_mfma_f32_16x16x32_bf16 v[4:7], a[120:123], a[32:35], v[4:7]
    ds_read_b64_tr_b16 a[104:105], v77 offset:0
    buffer_load_dwordx4 v235, s[56:59], s60 offen offset:1024  lds
    v_mfma_f32_16x16x32_bf16 v[4:7], a[124:127], a[40:43], v[4:7]
    ds_read_b64_tr_b16 a[106:107], v77 offset:4096
    s_lshl1_add_u32 s8, s6, 393216
    v_mfma_f32_16x16x32_bf16 v[36:39], a[120:123], a[36:39], v[36:39]
    ds_read_b64_tr_b16 a[108:109], v77 offset:8192
    buffer_load_dwordx4 a[0:3], v67, s[48:51], s8 offen offset:0 sc1
    v_mfma_f32_16x16x32_bf16 v[36:39], a[124:127], a[44:47], v[36:39]
    ds_read_b64_tr_b16 a[110:111], v77 offset:12288
    s_waitcnt lgkmcnt(8)
    v_mfma_f32_16x16x32_bf16 v[8:11], a[80:83], a[32:35], v[8:11]
    ds_read_b64_tr_b16 a[112:113], v78 offset:0
    buffer_load_dwordx4 a[4:7], v67, s[48:51], s8 offen offset:1024 sc1
    v_mfma_f32_16x16x32_bf16 v[8:11], a[84:87], a[40:43], v[8:11]
    ds_read_b64_tr_b16 a[114:115], v78 offset:4096
    s_add_u32 s60, s6, 229376
    v_mfma_f32_16x16x32_bf16 v[40:43], a[80:83], a[36:39], v[40:43]
    ds_read_b64_tr_b16 a[116:117], v78 offset:8192
    s_add_u32 m0, s14, 49152
    v_mfma_f32_16x16x32_bf16 v[40:43], a[84:87], a[44:47], v[40:43]
    ds_read_b64_tr_b16 a[118:119], v78 offset:12288
    buffer_load_dwordx4 v234, s[56:59], s60 offen offset:0  lds
    v_mfma_f32_16x16x32_bf16 v[12:15], a[88:91], a[32:35], v[12:15]
    ds_read_b64_tr_b16 a[120:121], v79 offset:0
    v_mfma_f32_16x16x32_bf16 v[12:15], a[92:95], a[40:43], v[12:15]
    ds_read_b64_tr_b16 a[122:123], v79 offset:4096
    buffer_load_dwordx4 v235, s[56:59], s60 offen offset:1024  lds
    v_mfma_f32_16x16x32_bf16 v[44:47], a[88:91], a[36:39], v[44:47]
    ds_read_b64_tr_b16 a[124:125], v79 offset:8192
    s_lshl1_add_u32 s8, s6, 524288
    v_mfma_f32_16x16x32_bf16 v[44:47], a[92:95], a[44:47], v[44:47]
    ds_read_b64_tr_b16 a[126:127], v79 offset:12288
    s_waitcnt vmcnt(15) lgkmcnt(8)
    s_barrier
    v_mfma_f32_16x16x32_bf16 v[16:19], a[96:99], a[32:35], v[16:19]
    ds_read_b64_tr_b16 a[80:81], v72 offset:16384
    buffer_load_dwordx4 a[8:11], v67, s[48:51], s8 offen offset:0 sc1
    v_mfma_f32_16x16x32_bf16 v[16:19], a[100:103], a[40:43], v[16:19]
    ds_read_b64_tr_b16 a[82:83], v72 offset:20480
    v_mfma_f32_16x16x32_bf16 v[48:51], a[96:99], a[36:39], v[48:51]
    ds_read_b64_tr_b16 a[84:85], v72 offset:24576
    buffer_load_dwordx4 a[12:15], v67, s[48:51], s8 offen offset:1024 sc1
    v_mfma_f32_16x16x32_bf16 v[48:51], a[100:103], a[44:47], v[48:51]
    ds_read_b64_tr_b16 a[86:87], v72 offset:28672
    s_add_u32 s60, s6, 294912
    v_mfma_f32_16x16x32_bf16 v[20:23], a[104:107], a[32:35], v[20:23]
    ds_read_b64_tr_b16 a[88:89], v73 offset:16384
    s_add_u32 m0, s14, 57344
    v_mfma_f32_16x16x32_bf16 v[20:23], a[108:111], a[40:43], v[20:23]
    ds_read_b64_tr_b16 a[90:91], v73 offset:20480
    buffer_load_dwordx4 v234, s[56:59], s60 offen offset:0  lds
    v_mfma_f32_16x16x32_bf16 v[52:55], a[104:107], a[36:39], v[52:55]
    ds_read_b64_tr_b16 a[92:93], v73 offset:24576
    v_mfma_f32_16x16x32_bf16 v[52:55], a[108:111], a[44:47], v[52:55]
    ds_read_b64_tr_b16 a[94:95], v73 offset:28672
    s_waitcnt lgkmcnt(8)
    v_mfma_f32_16x16x32_bf16 v[24:27], a[112:115], a[32:35], v[24:27]
    ds_read_b64_tr_b16 a[96:97], v74 offset:16384
    buffer_load_dwordx4 v235, s[56:59], s60 offen offset:1024  lds
    v_mfma_f32_16x16x32_bf16 v[24:27], a[116:119], a[40:43], v[24:27]
    ds_read_b64_tr_b16 a[98:99], v74 offset:20480
    s_lshl1_add_u32 s8, s6, 655360
    v_mfma_f32_16x16x32_bf16 v[56:59], a[112:115], a[36:39], v[56:59]
    ds_read_b64_tr_b16 a[100:101], v74 offset:24576
    buffer_load_dwordx4 a[16:19], v67, s[48:51], s8 offen offset:0 sc1
    v_mfma_f32_16x16x32_bf16 v[56:59], a[116:119], a[44:47], v[56:59]
    ds_read_b64_tr_b16 a[102:103], v74 offset:28672
    v_mfma_f32_16x16x32_bf16 v[28:31], a[120:123], a[32:35], v[28:31]
    ds_read_b64_tr_b16 a[104:105], v75 offset:16384
    buffer_load_dwordx4 a[20:23], v67, s[48:51], s8 offen offset:1024 sc1
    v_mfma_f32_16x16x32_bf16 v[28:31], a[124:127], a[40:43], v[28:31]
    ds_read_b64_tr_b16 a[106:107], v75 offset:20480
    s_add_u32 s60, s6, 360448
    v_mfma_f32_16x16x32_bf16 v[60:63], a[120:123], a[36:39], v[60:63]
    ds_read_b64_tr_b16 a[108:109], v75 offset:24576
    s_add_u32 m0, s14, 65536
    v_mfma_f32_16x16x32_bf16 v[60:63], a[124:127], a[44:47], v[60:63]
    ds_read_b64_tr_b16 a[110:111], v75 offset:28672
    s_waitcnt vmcnt(19) lgkmcnt(8)
    v_mfma_f32_16x16x32_bf16 v[0:3], a[80:83], a[48:51], v[0:3]
    ds_read_b64_tr_b16 a[112:113], v76 offset:16384
    buffer_load_dwordx4 v234, s[56:59], s60 offen offset:0  lds
    v_mfma_f32_16x16x32_bf16 v[0:3], a[84:87], a[56:59], v[0:3]
    ds_read_b64_tr_b16 a[114:115], v76 offset:20480
    v_mfma_f32_16x16x32_bf16 v[32:35], a[80:83], a[52:55], v[32:35]
    ds_read_b64_tr_b16 a[116:117], v76 offset:24576
    buffer_load_dwordx4 v235, s[56:59], s60 offen offset:1024  lds
    v_mfma_f32_16x16x32_bf16 v[32:35], a[84:87], a[60:63], v[32:35]
    ds_read_b64_tr_b16 a[118:119], v76 offset:28672
    s_lshl1_add_u32 s8, s6, 786432
    v_mfma_f32_16x16x32_bf16 v[4:7], a[88:91], a[48:51], v[4:7]
    ds_read_b64_tr_b16 a[120:121], v77 offset:16384
    buffer_load_dwordx4 a[24:27], v67, s[48:51], s8 offen offset:0 sc1
    v_mfma_f32_16x16x32_bf16 v[4:7], a[92:95], a[56:59], v[4:7]
    ds_read_b64_tr_b16 a[122:123], v77 offset:20480
    v_mfma_f32_16x16x32_bf16 v[36:39], a[88:91], a[52:55], v[36:39]
    ds_read_b64_tr_b16 a[124:125], v77 offset:24576
    buffer_load_dwordx4 a[28:31], v67, s[48:51], s8 offen offset:1024 sc1
    v_mfma_f32_16x16x32_bf16 v[36:39], a[92:95], a[60:63], v[36:39]
    ds_read_b64_tr_b16 a[126:127], v77 offset:28672
    s_waitcnt lgkmcnt(8)
    v_mfma_f32_16x16x32_bf16 v[8:11], a[96:99], a[48:51], v[8:11]
    ds_read_b64_tr_b16 a[80:81], v78 offset:16384
    s_add_u32 s60, s17, s6
    v_mfma_f32_16x16x32_bf16 v[8:11], a[100:103], a[56:59], v[8:11]
    ds_read_b64_tr_b16 a[82:83], v78 offset:20480
    s_add_u32 m0, s14, 73728
    v_mfma_f32_16x16x32_bf16 v[40:43], a[96:99], a[52:55], v[40:43]
    ds_read_b64_tr_b16 a[84:85], v78 offset:24576
    buffer_load_dwordx4 v234, s[56:59], s60 offen offset:0  lds
    v_mfma_f32_16x16x32_bf16 v[40:43], a[100:103], a[60:63], v[40:43]
    ds_read_b64_tr_b16 a[86:87], v78 offset:28672
    v_mfma_f32_16x16x32_bf16 v[12:15], a[104:107], a[48:51], v[12:15]
    ds_read_b64_tr_b16 a[88:89], v79 offset:16384
    buffer_load_dwordx4 v235, s[56:59], s60 offen offset:1024  lds
    v_mfma_f32_16x16x32_bf16 v[12:15], a[108:111], a[56:59], v[12:15]
    ds_read_b64_tr_b16 a[90:91], v79 offset:20480
    s_waitcnt vmcnt(24)
    v_mfma_f32_16x16x32_bf16 v[44:47], a[104:107], a[52:55], v[44:47]
    ds_read_b64_tr_b16 a[92:93], v79 offset:24576
    v_cmp_ne_u64 vcc, s[62:63], v[64:65]
    v_mfma_f32_16x16x32_bf16 v[44:47], a[108:111], a[60:63], v[44:47]
    ds_read_b64_tr_b16 a[94:95], v79 offset:28672
    s_waitcnt vmcnt(16) lgkmcnt(8)
    s_barrier
    v_mfma_f32_16x16x32_bf16 v[16:19], a[112:115], a[48:51], v[16:19]
    ds_read_b64_tr_b16 a[96:97], v72 offset:32768
    s_nop 4
    v_mfma_f32_16x16x32_bf16 v[16:19], a[116:119], a[56:59], v[16:19]
    ds_read_b64_tr_b16 a[98:99], v72 offset:36864
    s_and_b32 s3, vcc_lo, 0x30
    v_mfma_f32_16x16x32_bf16 v[48:51], a[112:115], a[52:55], v[48:51]
    ds_read_b64_tr_b16 a[100:101], v72 offset:40960
    s_cbranch_scc1 L_fused_kernel_fs_29
L_fused_kernel_fb_30:
    v_mfma_f32_16x16x32_bf16 v[48:51], a[116:119], a[60:63], v[48:51]
    ds_read_b64_tr_b16 a[102:103], v72 offset:45056
    s_lshl1_add_u32 s8, s7, 0
    v_mfma_f32_16x16x32_bf16 v[20:23], a[120:123], a[48:51], v[20:23]
    ds_read_b64_tr_b16 a[104:105], v73 offset:32768
    buffer_load_dwordx4 a[32:35], v67, s[48:51], s8 offen offset:0 sc1
    v_mfma_f32_16x16x32_bf16 v[20:23], a[124:127], a[56:59], v[20:23]
    ds_read_b64_tr_b16 a[106:107], v73 offset:36864
    v_mfma_f32_16x16x32_bf16 v[52:55], a[120:123], a[52:55], v[52:55]
    ds_read_b64_tr_b16 a[108:109], v73 offset:40960
    buffer_load_dwordx4 a[36:39], v67, s[48:51], s8 offen offset:1024 sc1
    v_mfma_f32_16x16x32_bf16 v[52:55], a[124:127], a[60:63], v[52:55]
    ds_read_b64_tr_b16 a[110:111], v73 offset:45056
    s_waitcnt lgkmcnt(8)
    v_mfma_f32_16x16x32_bf16 v[24:27], a[80:83], a[48:51], v[24:27]
    ds_read_b64_tr_b16 a[112:113], v74 offset:32768
    s_add_u32 s60, s7, 0
    v_mfma_f32_16x16x32_bf16 v[24:27], a[84:87], a[56:59], v[24:27]
    ds_read_b64_tr_b16 a[114:115], v74 offset:36864
    s_add_u32 m0, s14, 81920
    v_mfma_f32_16x16x32_bf16 v[56:59], a[80:83], a[52:55], v[56:59]
    ds_read_b64_tr_b16 a[116:117], v74 offset:40960
    buffer_load_dwordx4 v234, s[56:59], s60 offen offset:0  lds
    v_mfma_f32_16x16x32_bf16 v[56:59], a[84:87], a[60:63], v[56:59]
    ds_read_b64_tr_b16 a[118:119], v74 offset:45056
    v_mfma_f32_16x16x32_bf16 v[28:31], a[88:91], a[48:51], v[28:31]
    ds_read_b64_tr_b16 a[120:121], v75 offset:32768
    buffer_load_dwordx4 v235, s[56:59], s60 offen offset:1024  lds
    v_mfma_f32_16x16x32_bf16 v[28:31], a[92:95], a[56:59], v[28:31]
    ds_read_b64_tr_b16 a[122:123], v75 offset:36864
    s_add_u32 s60, s7, 65536
    v_mfma_f32_16x16x32_bf16 v[60:63], a[88:91], a[52:55], v[60:63]
    ds_read_b64_tr_b16 a[124:125], v75 offset:40960
    s_add_u32 m0, s14, 90112
    v_mfma_f32_16x16x32_bf16 v[60:63], a[92:95], a[60:63], v[60:63]
    ds_read_b64_tr_b16 a[126:127], v75 offset:45056
    s_waitcnt lgkmcnt(8)
    v_mfma_f32_16x16x32_bf16 v[0:3], a[96:99], a[64:67], v[0:3]
    ds_read_b64_tr_b16 a[80:81], v76 offset:32768
    buffer_load_dwordx4 v234, s[56:59], s60 offen offset:0  lds
    v_mfma_f32_16x16x32_bf16 v[0:3], a[100:103], a[72:75], v[0:3]
    ds_read_b64_tr_b16 a[82:83], v76 offset:36864
    v_mfma_f32_16x16x32_bf16 v[32:35], a[96:99], a[68:71], v[32:35]
    ds_read_b64_tr_b16 a[84:85], v76 offset:40960
    buffer_load_dwordx4 v235, s[56:59], s60 offen offset:1024  lds
    v_mfma_f32_16x16x32_bf16 v[32:35], a[100:103], a[76:79], v[32:35]
    ds_read_b64_tr_b16 a[86:87], v76 offset:45056
    v_mfma_f32_16x16x32_bf16 v[4:7], a[104:107], a[64:67], v[4:7]
    ds_read_b64_tr_b16 a[88:89], v77 offset:32768
    buffer_load_dwordx2 v[64:65], v66, s[36:39], 0 offen sc1
    v_mfma_f32_16x16x32_bf16 v[4:7], a[108:111], a[72:75], v[4:7]
    ds_read_b64_tr_b16 a[90:91], v77 offset:36864
    s_lshl1_add_u32 s8, s7, 131072
    v_mfma_f32_16x16x32_bf16 v[36:39], a[104:107], a[68:71], v[36:39]
    ds_read_b64_tr_b16 a[92:93], v77 offset:40960
    buffer_load_dwordx4 a[40:43], v67, s[48:51], s8 offen offset:0 sc1
    v_mfma_f32_16x16x32_bf16 v[36:39], a[108:111], a[76:79], v[36:39]
    ds_read_b64_tr_b16 a[94:95], v77 offset:45056
    s_waitcnt lgkmcnt(8)
    v_mfma_f32_16x16x32_bf16 v[8:11], a[112:115], a[64:67], v[8:11]
    ds_read_b64_tr_b16 a[96:97], v78 offset:32768
    buffer_load_dwordx4 a[44:47], v67, s[48:51], s8 offen offset:1024 sc1
    v_mfma_f32_16x16x32_bf16 v[8:11], a[116:119], a[72:75], v[8:11]
    ds_read_b64_tr_b16 a[98:99], v78 offset:36864
    s_lshl1_add_u32 s8, s7, 262144
    v_mfma_f32_16x16x32_bf16 v[40:43], a[112:115], a[68:71], v[40:43]
    ds_read_b64_tr_b16 a[100:101], v78 offset:40960
    buffer_load_dwordx4 a[48:51], v67, s[48:51], s8 offen offset:0 sc1
    v_mfma_f32_16x16x32_bf16 v[40:43], a[116:119], a[76:79], v[40:43]
    ds_read_b64_tr_b16 a[102:103], v78 offset:45056
    v_mfma_f32_16x16x32_bf16 v[12:15], a[120:123], a[64:67], v[12:15]
    ds_read_b64_tr_b16 a[104:105], v79 offset:32768
    buffer_load_dwordx4 a[52:55], v67, s[48:51], s8 offen offset:1024 sc1
    v_mfma_f32_16x16x32_bf16 v[12:15], a[124:127], a[72:75], v[12:15]
    ds_read_b64_tr_b16 a[106:107], v79 offset:36864
    s_add_u32 s60, s7, 131072
    v_mfma_f32_16x16x32_bf16 v[44:47], a[120:123], a[68:71], v[44:47]
    ds_read_b64_tr_b16 a[108:109], v79 offset:40960
    s_add_u32 m0, s14, 131072
    v_mfma_f32_16x16x32_bf16 v[44:47], a[124:127], a[76:79], v[44:47]
    ds_read_b64_tr_b16 a[110:111], v79 offset:45056
    s_waitcnt vmcnt(19) lgkmcnt(8)
    s_barrier
    v_mfma_f32_16x16x32_bf16 v[16:19], a[80:83], a[64:67], v[16:19]
    ds_read_b64_tr_b16 a[112:113], v72 offset:49152
    buffer_load_dwordx4 v234, s[56:59], s60 offen offset:0  lds
    v_mfma_f32_16x16x32_bf16 v[16:19], a[84:87], a[72:75], v[16:19]
    ds_read_b64_tr_b16 a[114:115], v72 offset:53248
    v_mfma_f32_16x16x32_bf16 v[48:51], a[80:83], a[68:71], v[48:51]
    ds_read_b64_tr_b16 a[116:117], v72 offset:57344
    buffer_load_dwordx4 v235, s[56:59], s60 offen offset:1024  lds
    v_mfma_f32_16x16x32_bf16 v[48:51], a[84:87], a[76:79], v[48:51]
    ds_read_b64_tr_b16 a[118:119], v72 offset:61440
    s_add_u32 s60, s7, 229376
    v_mfma_f32_16x16x32_bf16 v[20:23], a[88:91], a[64:67], v[20:23]
    ds_read_b64_tr_b16 a[120:121], v73 offset:49152
    s_add_u32 m0, s14, 139264
    v_mfma_f32_16x16x32_bf16 v[20:23], a[92:95], a[72:75], v[20:23]
    ds_read_b64_tr_b16 a[122:123], v73 offset:53248
    buffer_load_dwordx4 v234, s[56:59], s60 offen offset:0  lds
    v_mfma_f32_16x16x32_bf16 v[52:55], a[88:91], a[68:71], v[52:55]
    ds_read_b64_tr_b16 a[124:125], v73 offset:57344
    v_mfma_f32_16x16x32_bf16 v[52:55], a[92:95], a[76:79], v[52:55]
    ds_read_b64_tr_b16 a[126:127], v73 offset:61440
    s_waitcnt lgkmcnt(8)
    v_mfma_f32_16x16x32_bf16 v[24:27], a[96:99], a[64:67], v[24:27]
    ds_read_b64_tr_b16 a[80:81], v74 offset:49152
    buffer_load_dwordx4 v235, s[56:59], s60 offen offset:1024  lds
    v_mfma_f32_16x16x32_bf16 v[24:27], a[100:103], a[72:75], v[24:27]
    ds_read_b64_tr_b16 a[82:83], v74 offset:53248
    s_add_u32 s60, s7, 294912
    v_mfma_f32_16x16x32_bf16 v[56:59], a[96:99], a[68:71], v[56:59]
    ds_read_b64_tr_b16 a[84:85], v74 offset:57344
    s_add_u32 m0, s14, 147456
    v_mfma_f32_16x16x32_bf16 v[56:59], a[100:103], a[76:79], v[56:59]
    ds_read_b64_tr_b16 a[86:87], v74 offset:61440
    buffer_load_dwordx4 v234, s[56:59], s60 offen offset:0  lds
    v_mfma_f32_16x16x32_bf16 v[28:31], a[104:107], a[64:67], v[28:31]
    ds_read_b64_tr_b16 a[88:89], v75 offset:49152
    v_mfma_f32_16x16x32_bf16 v[28:31], a[108:111], a[72:75], v[28:31]
    ds_read_b64_tr_b16 a[90:91], v75 offset:53248
    buffer_load_dwordx4 v235, s[56:59], s60 offen offset:1024  lds
    v_mfma_f32_16x16x32_bf16 v[60:63], a[104:107], a[68:71], v[60:63]
    ds_read_b64_tr_b16 a[92:93], v75 offset:57344
    s_add_u32 s60, s7, 360448
    v_mfma_f32_16x16x32_bf16 v[60:63], a[108:111], a[76:79], v[60:63]
    ds_read_b64_tr_b16 a[94:95], v75 offset:61440
    s_waitcnt lgkmcnt(8)
    v_mfma_f32_16x16x32_bf16 v[0:3], a[112:115], a[0:3], v[0:3]
    ds_read_b64_tr_b16 a[96:97], v76 offset:49152
    s_add_u32 m0, s14, 155648
    v_mfma_f32_16x16x32_bf16 v[0:3], a[116:119], a[8:11], v[0:3]
    ds_read_b64_tr_b16 a[98:99], v76 offset:53248
    buffer_load_dwordx4 v234, s[56:59], s60 offen offset:0  lds
    v_mfma_f32_16x16x32_bf16 v[32:35], a[112:115], a[4:7], v[32:35]
    ds_read_b64_tr_b16 a[100:101], v76 offset:57344
    v_mfma_f32_16x16x32_bf16 v[32:35], a[116:119], a[12:15], v[32:35]
    ds_read_b64_tr_b16 a[102:103], v76 offset:61440
    buffer_load_dwordx4 v235, s[56:59], s60 offen offset:1024  lds
    v_mfma_f32_16x16x32_bf16 v[4:7], a[120:123], a[0:3], v[4:7]
    ds_read_b64_tr_b16 a[104:105], v77 offset:49152
    s_lshl1_add_u32 s8, s7, 393216
    v_mfma_f32_16x16x32_bf16 v[4:7], a[124:127], a[8:11], v[4:7]
    ds_read_b64_tr_b16 a[106:107], v77 offset:53248
    buffer_load_dwordx4 a[56:59], v67, s[48:51], s8 offen offset:0 sc1
    v_mfma_f32_16x16x32_bf16 v[36:39], a[120:123], a[4:7], v[36:39]
    ds_read_b64_tr_b16 a[108:109], v77 offset:57344
    v_mfma_f32_16x16x32_bf16 v[36:39], a[124:127], a[12:15], v[36:39]
    ds_read_b64_tr_b16 a[110:111], v77 offset:61440
    s_waitcnt lgkmcnt(8)
    v_mfma_f32_16x16x32_bf16 v[8:11], a[80:83], a[0:3], v[8:11]
    ds_read_b64_tr_b16 a[112:113], v78 offset:49152
    buffer_load_dwordx4 a[60:63], v67, s[48:51], s8 offen offset:1024 sc1
    v_mfma_f32_16x16x32_bf16 v[8:11], a[84:87], a[8:11], v[8:11]
    ds_read_b64_tr_b16 a[114:115], v78 offset:53248
    s_lshl1_add_u32 s8, s7, 524288
    v_mfma_f32_16x16x32_bf16 v[40:43], a[80:83], a[4:7], v[40:43]
    ds_read_b64_tr_b16 a[116:117], v78 offset:57344
    buffer_load_dwordx4 a[64:67], v67, s[48:51], s8 offen offset:0 sc1
    v_mfma_f32_16x16x32_bf16 v[40:43], a[84:87], a[12:15], v[40:43]
    ds_read_b64_tr_b16 a[118:119], v78 offset:61440
    v_mfma_f32_16x16x32_bf16 v[12:15], a[88:91], a[0:3], v[12:15]
    ds_read_b64_tr_b16 a[120:121], v79 offset:49152
    buffer_load_dwordx4 a[68:71], v67, s[48:51], s8 offen offset:1024 sc1
    v_mfma_f32_16x16x32_bf16 v[12:15], a[92:95], a[8:11], v[12:15]
    ds_read_b64_tr_b16 a[122:123], v79 offset:53248
    s_add_u32 s60, s17, s7
    v_mfma_f32_16x16x32_bf16 v[44:47], a[88:91], a[4:7], v[44:47]
    ds_read_b64_tr_b16 a[124:125], v79 offset:57344
    s_add_u32 m0, s14, 0
    v_mfma_f32_16x16x32_bf16 v[44:47], a[92:95], a[12:15], v[44:47]
    ds_read_b64_tr_b16 a[126:127], v79 offset:61440
    s_waitcnt vmcnt(23) lgkmcnt(8)
    s_barrier
    v_mfma_f32_16x16x32_bf16 v[16:19], a[96:99], a[0:3], v[16:19]
    ds_read_b64_tr_b16 a[80:81], v80 offset:0
    buffer_load_dwordx4 v234, s[56:59], s60 offen offset:0  lds
    v_mfma_f32_16x16x32_bf16 v[16:19], a[100:103], a[8:11], v[16:19]
    ds_read_b64_tr_b16 a[82:83], v80 offset:4096
    v_mfma_f32_16x16x32_bf16 v[48:51], a[96:99], a[4:7], v[48:51]
    ds_read_b64_tr_b16 a[84:85], v80 offset:8192
    buffer_load_dwordx4 v235, s[56:59], s60 offen offset:1024  lds
    v_mfma_f32_16x16x32_bf16 v[48:51], a[100:103], a[12:15], v[48:51]
    ds_read_b64_tr_b16 a[86:87], v80 offset:12288
    s_add_u32 s60, s12, 0
    v_mfma_f32_16x16x32_bf16 v[20:23], a[104:107], a[0:3], v[20:23]
    ds_read_b64_tr_b16 a[88:89], v81 offset:0
    s_add_u32 m0, s14, 8192
    v_mfma_f32_16x16x32_bf16 v[20:23], a[108:111], a[8:11], v[20:23]
    ds_read_b64_tr_b16 a[90:91], v81 offset:4096
    buffer_load_dwordx4 v234, s[56:59], s60 offen offset:0  lds
    v_mfma_f32_16x16x32_bf16 v[52:55], a[104:107], a[4:7], v[52:55]
    ds_read_b64_tr_b16 a[92:93], v81 offset:8192
    v_mfma_f32_16x16x32_bf16 v[52:55], a[108:111], a[12:15], v[52:55]
    ds_read_b64_tr_b16 a[94:95], v81 offset:12288
    s_waitcnt lgkmcnt(8)
    v_mfma_f32_16x16x32_bf16 v[24:27], a[112:115], a[0:3], v[24:27]
    ds_read_b64_tr_b16 a[96:97], v82 offset:0
    buffer_load_dwordx4 v235, s[56:59], s60 offen offset:1024  lds
    v_mfma_f32_16x16x32_bf16 v[24:27], a[116:119], a[8:11], v[24:27]
    ds_read_b64_tr_b16 a[98:99], v82 offset:4096
    s_add_u32 s60, s12, 65536
    v_mfma_f32_16x16x32_bf16 v[56:59], a[112:115], a[4:7], v[56:59]
    ds_read_b64_tr_b16 a[100:101], v82 offset:8192
    s_add_u32 m0, s14, 16384
    v_mfma_f32_16x16x32_bf16 v[56:59], a[116:119], a[12:15], v[56:59]
    ds_read_b64_tr_b16 a[102:103], v82 offset:12288
    buffer_load_dwordx4 v234, s[56:59], s60 offen offset:0  lds
    v_mfma_f32_16x16x32_bf16 v[28:31], a[120:123], a[0:3], v[28:31]
    ds_read_b64_tr_b16 a[104:105], v83 offset:0
    v_mfma_f32_16x16x32_bf16 v[28:31], a[124:127], a[8:11], v[28:31]
    ds_read_b64_tr_b16 a[106:107], v83 offset:4096
    buffer_load_dwordx4 v235, s[56:59], s60 offen offset:1024  lds
    v_mfma_f32_16x16x32_bf16 v[60:63], a[120:123], a[4:7], v[60:63]
    ds_read_b64_tr_b16 a[108:109], v83 offset:8192
    v_mfma_f32_16x16x32_bf16 v[60:63], a[124:127], a[12:15], v[60:63]
    ds_read_b64_tr_b16 a[110:111], v83 offset:12288
    s_waitcnt lgkmcnt(8)
    v_mfma_f32_16x16x32_bf16 v[0:3], a[80:83], a[16:19], v[0:3]
    ds_read_b64_tr_b16 a[112:113], v84 offset:0
    s_lshl1_add_u32 s8, s7, 655360
    v_mfma_f32_16x16x32_bf16 v[0:3], a[84:87], a[24:27], v[0:3]
    ds_read_b64_tr_b16 a[114:115], v84 offset:4096
    buffer_load_dwordx4 a[72:75], v67, s[48:51], s8 offen offset:0 sc1
    v_mfma_f32_16x16x32_bf16 v[32:35], a[80:83], a[20:23], v[32:35]
    ds_read_b64_tr_b16 a[116:117], v84 offset:8192
    v_mfma_f32_16x16x32_bf16 v[32:35], a[84:87], a[28:31], v[32:35]
    ds_read_b64_tr_b16 a[118:119], v84 offset:12288
    buffer_load_dwordx4 a[76:79], v67, s[48:51], s8 offen offset:1024 sc1
    v_mfma_f32_16x16x32_bf16 v[4:7], a[88:91], a[16:19], v[4:7]
    ds_read_b64_tr_b16 a[120:121], v85 offset:0
    s_lshl1_add_u32 s8, s7, 786432
    v_mfma_f32_16x16x32_bf16 v[4:7], a[92:95], a[24:27], v[4:7]
    ds_read_b64_tr_b16 a[122:123], v85 offset:4096
    buffer_load_dwordx4 a[0:3], v67, s[48:51], s8 offen offset:0 sc1
    v_mfma_f32_16x16x32_bf16 v[36:39], a[88:91], a[20:23], v[36:39]
    ds_read_b64_tr_b16 a[124:125], v85 offset:8192
    v_mfma_f32_16x16x32_bf16 v[36:39], a[92:95], a[28:31], v[36:39]
    ds_read_b64_tr_b16 a[126:127], v85 offset:12288
    s_waitcnt lgkmcnt(8)
    v_mfma_f32_16x16x32_bf16 v[8:11], a[96:99], a[16:19], v[8:11]
    ds_read_b64_tr_b16 a[80:81], v86 offset:0
    buffer_load_dwordx4 a[4:7], v67, s[48:51], s8 offen offset:1024 sc1
    v_mfma_f32_16x16x32_bf16 v[8:11], a[100:103], a[24:27], v[8:11]
    ds_read_b64_tr_b16 a[82:83], v86 offset:4096
    s_add_u32 s60, s12, 131072
    v_mfma_f32_16x16x32_bf16 v[40:43], a[96:99], a[20:23], v[40:43]
    ds_read_b64_tr_b16 a[84:85], v86 offset:8192
    s_add_u32 m0, s14, 24576
    v_mfma_f32_16x16x32_bf16 v[40:43], a[100:103], a[28:31], v[40:43]
    ds_read_b64_tr_b16 a[86:87], v86 offset:12288
    buffer_load_dwordx4 v234, s[56:59], s60 offen offset:0  lds
    v_mfma_f32_16x16x32_bf16 v[12:15], a[104:107], a[16:19], v[12:15]
    ds_read_b64_tr_b16 a[88:89], v87 offset:0
    v_mfma_f32_16x16x32_bf16 v[12:15], a[108:111], a[24:27], v[12:15]
    ds_read_b64_tr_b16 a[90:91], v87 offset:4096
    buffer_load_dwordx4 v235, s[56:59], s60 offen offset:1024  lds
    v_mfma_f32_16x16x32_bf16 v[44:47], a[104:107], a[20:23], v[44:47]
    ds_read_b64_tr_b16 a[92:93], v87 offset:8192
    s_add_u32 s60, s12, 229376
    v_mfma_f32_16x16x32_bf16 v[44:47], a[108:111], a[28:31], v[44:47]
    ds_read_b64_tr_b16 a[94:95], v87 offset:12288
    s_waitcnt vmcnt(29) lgkmcnt(8)
    s_barrier
    v_mfma_f32_16x16x32_bf16 v[16:19], a[112:115], a[16:19], v[16:19]
    ds_read_b64_tr_b16 a[96:97], v80 offset:16384
    s_add_u32 m0, s14, 32768
    v_mfma_f32_16x16x32_bf16 v[16:19], a[116:119], a[24:27], v[16:19]
    ds_read_b64_tr_b16 a[98:99], v80 offset:20480
    buffer_load_dwordx4 v234, s[56:59], s60 offen offset:0  lds
    v_mfma_f32_16x16x32_bf16 v[48:51], a[112:115], a[20:23], v[48:51]
    ds_read_b64_tr_b16 a[100:101], v80 offset:24576
    v_mfma_f32_16x16x32_bf16 v[48:51], a[116:119], a[28:31], v[48:51]
    ds_read_b64_tr_b16 a[102:103], v80 offset:28672
    buffer_load_dwordx4 v235, s[56:59], s60 offen offset:1024  lds
    v_mfma_f32_16x16x32_bf16 v[20:23], a[120:123], a[16:19], v[20:23]
    ds_read_b64_tr_b16 a[104:105], v81 offset:16384
    v_mfma_f32_16x16x32_bf16 v[20:23], a[124:127], a[24:27], v[20:23]
    s_branch L_fused_kernel_pc11
L_fused_kernel_isl0_11:
    s_branch L_fused_kernel_warmback0
L_fused_kernel_pc11:
    ds_read_b64_tr_b16 a[106:107], v81 offset:20480
    v_mfma_f32_16x16x32_bf16 v[52:55], a[120:123], a[20:23], v[52:55]
    ds_read_b64_tr_b16 a[108:109], v81 offset:24576
    v_mfma_f32_16x16x32_bf16 v[52:55], a[124:127], a[28:31], v[52:55]
    ds_read_b64_tr_b16 a[110:111], v81 offset:28672
    s_waitcnt lgkmcnt(8)
    v_mfma_f32_16x16x32_bf16 v[24:27], a[80:83], a[16:19], v[24:27]
    ds_read_b64_tr_b16 a[112:113], v82 offset:16384
    v_mfma_f32_16x16x32_bf16 v[24:27], a[84:87], a[24:27], v[24:27]
    ds_read_b64_tr_b16 a[114:115], v82 offset:20480
    v_mfma_f32_16x16x32_bf16 v[56:59], a[80:83], a[20:23], v[56:59]
    ds_read_b64_tr_b16 a[116:117], v82 offset:24576
    v_mfma_f32_16x16x32_bf16 v[56:59], a[84:87], a[28:31], v[56:59]
    ds_read_b64_tr_b16 a[118:119], v82 offset:28672
    v_mfma_f32_16x16x32_bf16 v[28:31], a[88:91], a[16:19], v[28:31]
    ds_read_b64_tr_b16 a[120:121], v83 offset:16384
    v_mfma_f32_16x16x32_bf16 v[28:31], a[92:95], a[24:27], v[28:31]
    ds_read_b64_tr_b16 a[122:123], v83 offset:20480
    v_mfma_f32_16x16x32_bf16 v[60:63], a[88:91], a[20:23], v[60:63]
    ds_read_b64_tr_b16 a[124:125], v83 offset:24576
    v_mfma_f32_16x16x32_bf16 v[60:63], a[92:95], a[28:31], v[60:63]
    ds_read_b64_tr_b16 a[126:127], v83 offset:28672
    s_waitcnt vmcnt(28) lgkmcnt(8)
    v_mfma_f32_16x16x32_bf16 v[0:3], a[96:99], a[32:35], v[0:3]
    ds_read_b64_tr_b16 a[80:81], v84 offset:16384
    v_mfma_f32_16x16x32_bf16 v[0:3], a[100:103], a[40:43], v[0:3]
    ds_read_b64_tr_b16 a[82:83], v84 offset:20480
    v_cmp_ne_u64 vcc, s[62:63], v[64:65]
    v_mfma_f32_16x16x32_bf16 v[32:35], a[96:99], a[36:39], v[32:35]
    ds_read_b64_tr_b16 a[84:85], v84 offset:24576
    s_nop 4
    v_mfma_f32_16x16x32_bf16 v[32:35], a[100:103], a[44:47], v[32:35]
    ds_read_b64_tr_b16 a[86:87], v84 offset:28672
    s_and_b32 s3, vcc_lo, 0xc0
    v_mfma_f32_16x16x32_bf16 v[4:7], a[104:107], a[32:35], v[4:7]
    ds_read_b64_tr_b16 a[88:89], v85 offset:16384
    s_cbranch_scc1 L_fused_kernel_fs_32
L_fused_kernel_fb_33:
    v_mfma_f32_16x16x32_bf16 v[4:7], a[108:111], a[40:43], v[4:7]
    ds_read_b64_tr_b16 a[90:91], v85 offset:20480
    s_lshl1_add_u32 s8, s12, 0
    v_mfma_f32_16x16x32_bf16 v[36:39], a[104:107], a[36:39], v[36:39]
    ds_read_b64_tr_b16 a[92:93], v85 offset:24576
    buffer_load_dwordx4 a[8:11], v67, s[48:51], s8 offen offset:0 sc1
    v_mfma_f32_16x16x32_bf16 v[36:39], a[108:111], a[44:47], v[36:39]
    ds_read_b64_tr_b16 a[94:95], v85 offset:28672
    s_waitcnt lgkmcnt(8)
    v_mfma_f32_16x16x32_bf16 v[8:11], a[112:115], a[32:35], v[8:11]
    ds_read_b64_tr_b16 a[96:97], v86 offset:16384
    buffer_load_dwordx4 a[12:15], v67, s[48:51], s8 offen offset:1024 sc1
    v_mfma_f32_16x16x32_bf16 v[8:11], a[116:119], a[40:43], v[8:11]
    ds_read_b64_tr_b16 a[98:99], v86 offset:20480
    s_lshl1_add_u32 s8, s12, 131072
    v_mfma_f32_16x16x32_bf16 v[40:43], a[112:115], a[36:39], v[40:43]
    ds_read_b64_tr_b16 a[100:101], v86 offset:24576
    buffer_load_dwordx4 a[16:19], v67, s[48:51], s8 offen offset:0 sc1
    v_mfma_f32_16x16x32_bf16 v[40:43], a[116:119], a[44:47], v[40:43]
    ds_read_b64_tr_b16 a[102:103], v86 offset:28672
    v_mfma_f32_16x16x32_bf16 v[12:15], a[120:123], a[32:35], v[12:15]
    ds_read_b64_tr_b16 a[104:105], v87 offset:16384
    buffer_load_dwordx4 a[20:23], v67, s[48:51], s8 offen offset:1024 sc1
    v_mfma_f32_16x16x32_bf16 v[12:15], a[124:127], a[40:43], v[12:15]
    ds_read_b64_tr_b16 a[106:107], v87 offset:20480
    s_add_u32 s60, s12, 294912
    v_mfma_f32_16x16x32_bf16 v[44:47], a[120:123], a[36:39], v[44:47]
    ds_read_b64_tr_b16 a[108:109], v87 offset:24576
    s_add_u32 m0, s14, 40960
    v_mfma_f32_16x16x32_bf16 v[44:47], a[124:127], a[44:47], v[44:47]
    ds_read_b64_tr_b16 a[110:111], v87 offset:28672
    s_waitcnt vmcnt(26) lgkmcnt(8)
    s_barrier
    v_mfma_f32_16x16x32_bf16 v[16:19], a[80:83], a[32:35], v[16:19]
    ds_read_b64_tr_b16 a[112:113], v88 offset:0
    buffer_load_dwordx4 v234, s[56:59], s60 offen offset:0  lds
    v_mfma_f32_16x16x32_bf16 v[16:19], a[84:87], a[40:43], v[16:19]
    ds_read_b64_tr_b16 a[114:115], v88 offset:4096
    v_mfma_f32_16x16x32_bf16 v[48:51], a[80:83], a[36:39], v[48:51]
    ds_read_b64_tr_b16 a[116:117], v88 offset:8192
    buffer_load_dwordx4 v235, s[56:59], s60 offen offset:1024  lds
    v_mfma_f32_16x16x32_bf16 v[48:51], a[84:87], a[44:47], v[48:51]
    ds_read_b64_tr_b16 a[118:119], v88 offset:12288
    s_add_u32 s60, s12, 360448
    v_mfma_f32_16x16x32_bf16 v[20:23], a[88:91], a[32:35], v[20:23]
    ds_read_b64_tr_b16 a[120:121], v89 offset:0
    s_add_u32 m0, s14, 49152
    v_mfma_f32_16x16x32_bf16 v[20:23], a[92:95], a[40:43], v[20:23]
    ds_read_b64_tr_b16 a[122:123], v89 offset:4096
    buffer_load_dwordx4 v234, s[56:59], s60 offen offset:0  lds
    v_mfma_f32_16x16x32_bf16 v[52:55], a[88:91], a[36:39], v[52:55]
    ds_read_b64_tr_b16 a[124:125], v89 offset:8192
    v_mfma_f32_16x16x32_bf16 v[52:55], a[92:95], a[44:47], v[52:55]
    ds_read_b64_tr_b16 a[126:127], v89 offset:12288
    s_waitcnt lgkmcnt(8)
    v_mfma_f32_16x16x32_bf16 v[24:27], a[96:99], a[32:35], v[24:27]
    ds_read_b64_tr_b16 a[80:81], v90 offset:0
    buffer_load_dwordx4 v235, s[56:59], s60 offen offset:1024  lds
    v_mfma_f32_16x16x32_bf16 v[24:27], a[100:103], a[40:43], v[24:27]
    ds_read_b64_tr_b16 a[82:83], v90 offset:4096
    v_mfma_f32_16x16x32_bf16 v[56:59], a[96:99], a[36:39], v[56:59]
    ds_read_b64_tr_b16 a[84:85], v90 offset:8192
    v_mfma_f32_16x16x32_bf16 v[56:59], a[100:103], a[44:47], v[56:59]
    ds_read_b64_tr_b16 a[86:87], v90 offset:12288
    v_mfma_f32_16x16x32_bf16 v[28:31], a[104:107], a[32:35], v[28:31]
    ds_read_b64_tr_b16 a[88:89], v91 offset:0
    v_mfma_f32_16x16x32_bf16 v[28:31], a[108:111], a[40:43], v[28:31]
    ds_read_b64_tr_b16 a[90:91], v91 offset:4096
    v_mfma_f32_16x16x32_bf16 v[60:63], a[104:107], a[36:39], v[60:63]
    ds_read_b64_tr_b16 a[92:93], v91 offset:8192
    v_mfma_f32_16x16x32_bf16 v[60:63], a[108:111], a[44:47], v[60:63]
    ds_read_b64_tr_b16 a[94:95], v91 offset:12288
    s_waitcnt vmcnt(24) lgkmcnt(8)
    v_mfma_f32_16x16x32_bf16 v[0:3], a[112:115], a[48:51], v[0:3]
    ds_read_b64_tr_b16 a[96:97], v92 offset:0
    buffer_load_dwordx2 v[64:65], v66, s[36:39], 0 offen sc1
    v_mfma_f32_16x16x32_bf16 v[0:3], a[116:119], a[56:59], v[0:3]
    ds_read_b64_tr_b16 a[98:99], v92 offset:4096
    s_lshl1_add_u32 s8, s12, 262144
    v_mfma_f32_16x16x32_bf16 v[32:35], a[112:115], a[52:55], v[32:35]
    ds_read_b64_tr_b16 a[100:101], v92 offset:8192
    buffer_load_dwordx4 a[24:27], v67, s[48:51], s8 offen offset:0 sc1
    v_mfma_f32_16x16x32_bf16 v[32:35], a[116:119], a[60:63], v[32:35]
    ds_read_b64_tr_b16 a[102:103], v92 offset:12288
    v_mfma_f32_16x16x32_bf16 v[4:7], a[120:123], a[48:51], v[4:7]
    ds_read_b64_tr_b16 a[104:105], v93 offset:0
    buffer_load_dwordx4 a[28:31], v67, s[48:51], s8 offen offset:1024 sc1
    v_mfma_f32_16x16x32_bf16 v[4:7], a[124:127], a[56:59], v[4:7]
    ds_read_b64_tr_b16 a[106:107], v93 offset:4096
    s_lshl1_add_u32 s8, s12, 393216
    v_mfma_f32_16x16x32_bf16 v[36:39], a[120:123], a[52:55], v[36:39]
    ds_read_b64_tr_b16 a[108:109], v93 offset:8192
    buffer_load_dwordx4 a[32:35], v67, s[48:51], s8 offen offset:0 sc1
    v_mfma_f32_16x16x32_bf16 v[36:39], a[124:127], a[60:63], v[36:39]
    ds_read_b64_tr_b16 a[110:111], v93 offset:12288
    s_waitcnt lgkmcnt(8)
    v_mfma_f32_16x16x32_bf16 v[8:11], a[80:83], a[48:51], v[8:11]
    ds_read_b64_tr_b16 a[112:113], v94 offset:0
    buffer_load_dwordx4 a[36:39], v67, s[48:51], s8 offen offset:1024 sc1
    v_mfma_f32_16x16x32_bf16 v[8:11], a[84:87], a[56:59], v[8:11]
    ds_read_b64_tr_b16 a[114:115], v94 offset:4096
    s_add_u32 s60, s17, s12
    v_mfma_f32_16x16x32_bf16 v[40:43], a[80:83], a[52:55], v[40:43]
    ds_read_b64_tr_b16 a[116:117], v94 offset:8192
    s_add_u32 m0, s14, 57344
    v_mfma_f32_16x16x32_bf16 v[40:43], a[84:87], a[60:63], v[40:43]
    ds_read_b64_tr_b16 a[118:119], v94 offset:12288
    buffer_load_dwordx4 v234, s[56:59], s60 offen offset:0  lds
    v_mfma_f32_16x16x32_bf16 v[12:15], a[88:91], a[48:51], v[12:15]
    ds_read_b64_tr_b16 a[120:121], v95 offset:0
    v_mfma_f32_16x16x32_bf16 v[12:15], a[92:95], a[56:59], v[12:15]
    ds_read_b64_tr_b16 a[122:123], v95 offset:4096
    buffer_load_dwordx4 v235, s[56:59], s60 offen offset:1024  lds
    v_mfma_f32_16x16x32_bf16 v[44:47], a[88:91], a[52:55], v[44:47]
    ds_read_b64_tr_b16 a[124:125], v95 offset:8192
    s_add_u32 s60, s13, 0
    v_mfma_f32_16x16x32_bf16 v[44:47], a[92:95], a[60:63], v[44:47]
    ds_read_b64_tr_b16 a[126:127], v95 offset:12288
    s_waitcnt lgkmcnt(8)
    s_barrier
    v_mfma_f32_16x16x32_bf16 v[16:19], a[96:99], a[48:51], v[16:19]
    ds_read_b64_tr_b16 a[80:81], v88 offset:16384
    s_add_u32 m0, s14, 65536
    v_mfma_f32_16x16x32_bf16 v[16:19], a[100:103], a[56:59], v[16:19]
    ds_read_b64_tr_b16 a[82:83], v88 offset:20480
    buffer_load_dwordx4 v234, s[56:59], s60 offen offset:0  lds
    v_mfma_f32_16x16x32_bf16 v[48:51], a[96:99], a[52:55], v[48:51]
    ds_read_b64_tr_b16 a[84:85], v88 offset:24576
    v_mfma_f32_16x16x32_bf16 v[48:51], a[100:103], a[60:63], v[48:51]
    ds_read_b64_tr_b16 a[86:87], v88 offset:28672
    buffer_load_dwordx4 v235, s[56:59], s60 offen offset:1024  lds
    v_mfma_f32_16x16x32_bf16 v[20:23], a[104:107], a[48:51], v[20:23]
    ds_read_b64_tr_b16 a[88:89], v89 offset:16384
    v_mfma_f32_16x16x32_bf16 v[20:23], a[108:111], a[56:59], v[20:23]
    ds_read_b64_tr_b16 a[90:91], v89 offset:20480
    v_mfma_f32_16x16x32_bf16 v[52:55], a[104:107], a[52:55], v[52:55]
    ds_read_b64_tr_b16 a[92:93], v89 offset:24576
    v_mfma_f32_16x16x32_bf16 v[52:55], a[108:111], a[60:63], v[52:55]
    ds_read_b64_tr_b16 a[94:95], v89 offset:28672
    s_waitcnt lgkmcnt(8)
    v_mfma_f32_16x16x32_bf16 v[24:27], a[112:115], a[48:51], v[24:27]
    ds_read_b64_tr_b16 a[96:97], v90 offset:16384
    v_mfma_f32_16x16x32_bf16 v[24:27], a[116:119], a[56:59], v[24:27]
    ds_read_b64_tr_b16 a[98:99], v90 offset:20480
    v_mfma_f32_16x16x32_bf16 v[56:59], a[112:115], a[52:55], v[56:59]
    ds_read_b64_tr_b16 a[100:101], v90 offset:24576
    v_mfma_f32_16x16x32_bf16 v[56:59], a[116:119], a[60:63], v[56:59]
    ds_read_b64_tr_b16 a[102:103], v90 offset:28672
    v_mfma_f32_16x16x32_bf16 v[28:31], a[120:123], a[48:51], v[28:31]
    ds_read_b64_tr_b16 a[104:105], v91 offset:16384
    v_mfma_f32_16x16x32_bf16 v[28:31], a[124:127], a[56:59], v[28:31]
    ds_read_b64_tr_b16 a[106:107], v91 offset:20480
    v_mfma_f32_16x16x32_bf16 v[60:63], a[120:123], a[52:55], v[60:63]
    ds_read_b64_tr_b16 a[108:109], v91 offset:24576
    v_mfma_f32_16x16x32_bf16 v[60:63], a[124:127], a[60:63], v[60:63]
    ds_read_b64_tr_b16 a[110:111], v91 offset:28672
    s_waitcnt vmcnt(23) lgkmcnt(8)
    v_mfma_f32_16x16x32_bf16 v[0:3], a[80:83], a[64:67], v[0:3]
    ds_read_b64_tr_b16 a[112:113], v92 offset:16384
    s_lshl1_add_u32 s8, s12, 524288
    v_mfma_f32_16x16x32_bf16 v[0:3], a[84:87], a[72:75], v[0:3]
    ds_read_b64_tr_b16 a[114:115], v92 offset:20480
    buffer_load_dwordx4 a[40:43], v67, s[48:51], s8 offen offset:0 sc1
    v_mfma_f32_16x16x32_bf16 v[32:35], a[80:83], a[68:71], v[32:35]
    ds_read_b64_tr_b16 a[116:117], v92 offset:24576
    v_mfma_f32_16x16x32_bf16 v[32:35], a[84:87], a[76:79], v[32:35]
    ds_read_b64_tr_b16 a[118:119], v92 offset:28672
    buffer_load_dwordx4 a[44:47], v67, s[48:51], s8 offen offset:1024 sc1
    v_mfma_f32_16x16x32_bf16 v[4:7], a[88:91], a[64:67], v[4:7]
    ds_read_b64_tr_b16 a[120:121], v93 offset:16384
    s_lshl1_add_u32 s8, s12, 655360
    v_mfma_f32_16x16x32_bf16 v[4:7], a[92:95], a[72:75], v[4:7]
    ds_read_b64_tr_b16 a[122:123], v93 offset:20480
    buffer_load_dwordx4 a[48:51], v67, s[48:51], s8 offen offset:0 sc1
    v_mfma_f32_16x16x32_bf16 v[36:39], a[88:91], a[68:71], v[36:39]
    ds_read_b64_tr_b16 a[124:125], v93 offset:24576
    v_mfma_f32_16x16x32_bf16 v[36:39], a[92:95], a[76:79], v[36:39]
    ds_read_b64_tr_b16 a[126:127], v93 offset:28672
    s_waitcnt lgkmcnt(8)
    v_mfma_f32_16x16x32_bf16 v[8:11], a[96:99], a[64:67], v[8:11]
    ds_read_b64_tr_b16 a[80:81], v94 offset:16384
    buffer_load_dwordx4 a[52:55], v67, s[48:51], s8 offen offset:1024 sc1
    v_mfma_f32_16x16x32_bf16 v[8:11], a[100:103], a[72:75], v[8:11]
    ds_read_b64_tr_b16 a[82:83], v94 offset:20480
    s_add_u32 s60, s13, 65536
    v_mfma_f32_16x16x32_bf16 v[40:43], a[96:99], a[68:71], v[40:43]
    ds_read_b64_tr_b16 a[84:85], v94 offset:24576
    s_add_u32 m0, s14, 73728
    v_mfma_f32_16x16x32_bf16 v[40:43], a[100:103], a[76:79], v[40:43]
    ds_read_b64_tr_b16 a[86:87], v94 offset:28672
    buffer_load_dwordx4 v234, s[56:59], s60 offen offset:0  lds
    v_mfma_f32_16x16x32_bf16 v[12:15], a[104:107], a[64:67], v[12:15]
    ds_read_b64_tr_b16 a[88:89], v95 offset:16384
    v_mfma_f32_16x16x32_bf16 v[12:15], a[108:111], a[72:75], v[12:15]
    ds_read_b64_tr_b16 a[90:91], v95 offset:20480
    buffer_load_dwordx4 v235, s[56:59], s60 offen offset:1024  lds
    v_mfma_f32_16x16x32_bf16 v[44:47], a[104:107], a[68:71], v[44:47]
    ds_read_b64_tr_b16 a[92:93], v95 offset:24576
    s_add_u32 s60, s13, 131072
    v_mfma_f32_16x16x32_bf16 v[44:47], a[108:111], a[76:79], v[44:47]
    ds_read_b64_tr_b16 a[94:95], v95 offset:28672
    s_waitcnt lgkmcnt(8)
    s_barrier
    v_mfma_f32_16x16x32_bf16 v[16:19], a[112:115], a[64:67], v[16:19]
    ds_read_b64_tr_b16 a[96:97], v72 offset:0
    s_add_u32 m0, s14, 81920
    v_mfma_f32_16x16x32_bf16 v[16:19], a[116:119], a[72:75], v[16:19]
    ds_read_b64_tr_b16 a[98:99], v72 offset:4096
    buffer_load_dwordx4 v234, s[56:59], s60 offen offset:0  lds
    v_mfma_f32_16x16x32_bf16 v[48:51], a[112:115], a[68:71], v[48:51]
    ds_read_b64_tr_b16 a[100:101], v72 offset:8192
    v_mfma_f32_16x16x32_bf16 v[48:51], a[116:119], a[76:79], v[48:51]
    ds_read_b64_tr_b16 a[102:103], v72 offset:12288
    buffer_load_dwordx4 v235, s[56:59], s60 offen offset:1024  lds
    v_mfma_f32_16x16x32_bf16 v[20:23], a[120:123], a[64:67], v[20:23]
    ds_read_b64_tr_b16 a[104:105], v73 offset:0
    v_mfma_f32_16x16x32_bf16 v[20:23], a[124:127], a[72:75], v[20:23]
    ds_read_b64_tr_b16 a[106:107], v73 offset:4096
    v_mfma_f32_16x16x32_bf16 v[52:55], a[120:123], a[68:71], v[52:55]
    ds_read_b64_tr_b16 a[108:109], v73 offset:8192
    v_mfma_f32_16x16x32_bf16 v[52:55], a[124:127], a[76:79], v[52:55]
    ds_read_b64_tr_b16 a[110:111], v73 offset:12288
    s_waitcnt lgkmcnt(8)
    v_mfma_f32_16x16x32_bf16 v[24:27], a[80:83], a[64:67], v[24:27]
    ds_read_b64_tr_b16 a[112:113], v74 offset:0
    v_mfma_f32_16x16x32_bf16 v[24:27], a[84:87], a[72:75], v[24:27]
    ds_read_b64_tr_b16 a[114:115], v74 offset:4096
    v_mfma_f32_16x16x32_bf16 v[56:59], a[80:83], a[68:71], v[56:59]
    ds_read_b64_tr_b16 a[116:117], v74 offset:8192
    v_mfma_f32_16x16x32_bf16 v[56:59], a[84:87], a[76:79], v[56:59]
    ds_read_b64_tr_b16 a[118:119], v74 offset:12288
    v_mfma_f32_16x16x32_bf16 v[28:31], a[88:91], a[64:67], v[28:31]
    ds_read_b64_tr_b16 a[120:121], v75 offset:0
    v_mfma_f32_16x16x32_bf16 v[28:31], a[92:95], a[72:75], v[28:31]
    ds_read_b64_tr_b16 a[122:123], v75 offset:4096
    v_mfma_f32_16x16x32_bf16 v[60:63], a[88:91], a[68:71], v[60:63]
    ds_read_b64_tr_b16 a[124:125], v75 offset:8192
    v_mfma_f32_16x16x32_bf16 v[60:63], a[92:95], a[76:79], v[60:63]
    ds_read_b64_tr_b16 a[126:127], v75 offset:12288
    s_waitcnt vmcnt(23) lgkmcnt(8)
    v_mfma_f32_16x16x32_bf16 v[0:3], a[96:99], a[0:3], v[0:3]
    ds_read_b64_tr_b16 a[80:81], v76 offset:0
    s_lshl1_add_u32 s8, s12, 786432
    v_mfma_f32_16x16x32_bf16 v[0:3], a[100:103], a[8:11], v[0:3]
    ds_read_b64_tr_b16 a[82:83], v76 offset:4096
    buffer_load_dwordx4 a[56:59], v67, s[48:51], s8 offen offset:0 sc1
    v_mfma_f32_16x16x32_bf16 v[32:35], a[96:99], a[4:7], v[32:35]
    ds_read_b64_tr_b16 a[84:85], v76 offset:8192
    v_mfma_f32_16x16x32_bf16 v[32:35], a[100:103], a[12:15], v[32:35]
    ds_read_b64_tr_b16 a[86:87], v76 offset:12288
    buffer_load_dwordx4 a[60:63], v67, s[48:51], s8 offen offset:1024 sc1
    v_mfma_f32_16x16x32_bf16 v[4:7], a[104:107], a[0:3], v[4:7]
    ds_read_b64_tr_b16 a[88:89], v77 offset:0
    s_waitcnt vmcnt(18)
    v_mfma_f32_16x16x32_bf16 v[4:7], a[108:111], a[8:11], v[4:7]
    ds_read_b64_tr_b16 a[90:91], v77 offset:4096
    v_cmp_ne_u64 vcc, s[62:63], v[64:65]
    v_mfma_f32_16x16x32_bf16 v[36:39], a[104:107], a[4:7], v[36:39]
    ds_read_b64_tr_b16 a[92:93], v77 offset:8192
    s_nop 4
    v_mfma_f32_16x16x32_bf16 v[36:39], a[108:111], a[12:15], v[36:39]
    ds_read_b64_tr_b16 a[94:95], v77 offset:12288
    s_waitcnt lgkmcnt(8)
    v_mfma_f32_16x16x32_bf16 v[8:11], a[112:115], a[0:3], v[8:11]
    ds_read_b64_tr_b16 a[96:97], v78 offset:0
    s_and_b32 s3, vcc_lo, 0x300
    v_mfma_f32_16x16x32_bf16 v[8:11], a[116:119], a[8:11], v[8:11]
    ds_read_b64_tr_b16 a[98:99], v78 offset:4096
    s_cbranch_scc1 L_fused_kernel_fs_35
L_fused_kernel_fb_36:
    v_mfma_f32_16x16x32_bf16 v[40:43], a[112:115], a[4:7], v[40:43]
    ds_read_b64_tr_b16 a[100:101], v78 offset:8192
    s_lshl1_add_u32 s8, s13, 0
    v_mfma_f32_16x16x32_bf16 v[40:43], a[116:119], a[12:15], v[40:43]
    ds_read_b64_tr_b16 a[102:103], v78 offset:12288
    buffer_load_dwordx4 a[64:67], v67, s[48:51], s8 offen offset:0 sc1
    v_mfma_f32_16x16x32_bf16 v[12:15], a[120:123], a[0:3], v[12:15]
    ds_read_b64_tr_b16 a[104:105], v79 offset:0
    v_mfma_f32_16x16x32_bf16 v[12:15], a[124:127], a[8:11], v[12:15]
    ds_read_b64_tr_b16 a[106:107], v79 offset:4096
    buffer_load_dwordx4 a[68:71], v67, s[48:51], s8 offen offset:1024 sc1
    v_mfma_f32_16x16x32_bf16 v[44:47], a[120:123], a[4:7], v[44:47]
    ds_read_b64_tr_b16 a[108:109], v79 offset:8192
    s_add_u32 s60, s13, 229376
    v_mfma_f32_16x16x32_bf16 v[44:47], a[124:127], a[12:15], v[44:47]
    ds_read_b64_tr_b16 a[110:111], v79 offset:12288
    s_waitcnt lgkmcnt(8)
    s_barrier
    v_mfma_f32_16x16x32_bf16 v[16:19], a[80:83], a[0:3], v[16:19]
    ds_read_b64_tr_b16 a[112:113], v72 offset:16384
    s_add_u32 m0, s14, 90112
    v_mfma_f32_16x16x32_bf16 v[16:19], a[84:87], a[8:11], v[16:19]
    ds_read_b64_tr_b16 a[114:115], v72 offset:20480
    buffer_load_dwordx4 v234, s[56:59], s60 offen offset:0  lds
    v_mfma_f32_16x16x32_bf16 v[48:51], a[80:83], a[4:7], v[48:51]
    ds_read_b64_tr_b16 a[116:117], v72 offset:24576
    v_mfma_f32_16x16x32_bf16 v[48:51], a[84:87], a[12:15], v[48:51]
    ds_read_b64_tr_b16 a[118:119], v72 offset:28672
    buffer_load_dwordx4 v235, s[56:59], s60 offen offset:1024  lds
    v_mfma_f32_16x16x32_bf16 v[20:23], a[88:91], a[0:3], v[20:23]
    ds_read_b64_tr_b16 a[120:121], v73 offset:16384
    s_add_u32 s60, s13, 294912
    v_mfma_f32_16x16x32_bf16 v[20:23], a[92:95], a[8:11], v[20:23]
    ds_read_b64_tr_b16 a[122:123], v73 offset:20480
    s_add_u32 m0, s14, 131072
    v_mfma_f32_16x16x32_bf16 v[52:55], a[88:91], a[4:7], v[52:55]
    ds_read_b64_tr_b16 a[124:125], v73 offset:24576
    buffer_load_dwordx4 v234, s[56:59], s60 offen offset:0  lds
    v_mfma_f32_16x16x32_bf16 v[52:55], a[92:95], a[12:15], v[52:55]
    ds_read_b64_tr_b16 a[126:127], v73 offset:28672
    s_waitcnt lgkmcnt(8)
    v_mfma_f32_16x16x32_bf16 v[24:27], a[96:99], a[0:3], v[24:27]
    ds_read_b64_tr_b16 a[80:81], v74 offset:16384
    buffer_load_dwordx4 v235, s[56:59], s60 offen offset:1024  lds
    v_mfma_f32_16x16x32_bf16 v[24:27], a[100:103], a[8:11], v[24:27]
    ds_read_b64_tr_b16 a[82:83], v74 offset:20480
    v_mfma_f32_16x16x32_bf16 v[56:59], a[96:99], a[4:7], v[56:59]
    ds_read_b64_tr_b16 a[84:85], v74 offset:24576
    v_mfma_f32_16x16x32_bf16 v[56:59], a[100:103], a[12:15], v[56:59]
    ds_read_b64_tr_b16 a[86:87], v74 offset:28672
    v_mfma_f32_16x16x32_bf16 v[28:31], a[104:107], a[0:3], v[28:31]
    ds_read_b64_tr_b16 a[88:89], v75 offset:16384
    v_mfma_f32_16x16x32_bf16 v[28:31], a[108:111], a[8:11], v[28:31]
    ds_read_b64_tr_b16 a[90:91], v75 offset:20480
    v_mfma_f32_16x16x32_bf16 v[60:63], a[104:107], a[4:7], v[60:63]
    ds_read_b64_tr_b16 a[92:93], v75 offset:24576
    v_mfma_f32_16x16x32_bf16 v[60:63], a[108:111], a[12:15], v[60:63]
    ds_read_b64_tr_b16 a[94:95], v75 offset:28672
    s_waitcnt vmcnt(22) lgkmcnt(8)
    v_mfma_f32_16x16x32_bf16 v[0:3], a[112:115], a[16:19], v[0:3]
    ds_read_b64_tr_b16 a[96:97], v76 offset:16384
    buffer_load_dwordx2 v[64:65], v66, s[36:39], 0 offen sc1
    v_mfma_f32_16x16x32_bf16 v[0:3], a[116:119], a[24:27], v[0:3]
    ds_read_b64_tr_b16 a[98:99], v76 offset:20480
    s_lshl1_add_u32 s8, s13, 131072
    v_mfma_f32_16x16x32_bf16 v[32:35], a[112:115], a[20:23], v[32:35]
    ds_read_b64_tr_b16 a[100:101], v76 offset:24576
    buffer_load_dwordx4 a[72:75], v67, s[48:51], s8 offen offset:0 sc1
    v_mfma_f32_16x16x32_bf16 v[32:35], a[116:119], a[28:31], v[32:35]
    ds_read_b64_tr_b16 a[102:103], v76 offset:28672
    v_mfma_f32_16x16x32_bf16 v[4:7], a[120:123], a[16:19], v[4:7]
    ds_read_b64_tr_b16 a[104:105], v77 offset:16384
    buffer_load_dwordx4 a[76:79], v67, s[48:51], s8 offen offset:1024 sc1
    v_mfma_f32_16x16x32_bf16 v[4:7], a[124:127], a[24:27], v[4:7]
    ds_read_b64_tr_b16 a[106:107], v77 offset:20480
    s_lshl1_add_u32 s8, s13, 262144
    v_mfma_f32_16x16x32_bf16 v[36:39], a[120:123], a[20:23], v[36:39]
    ds_read_b64_tr_b16 a[108:109], v77 offset:24576
    buffer_load_dwordx4 a[0:3], v67, s[48:51], s8 offen offset:0 sc1
    v_mfma_f32_16x16x32_bf16 v[36:39], a[124:127], a[28:31], v[36:39]
    ds_read_b64_tr_b16 a[110:111], v77 offset:28672
    s_waitcnt lgkmcnt(8)
    v_mfma_f32_16x16x32_bf16 v[8:11], a[80:83], a[16:19], v[8:11]
    ds_read_b64_tr_b16 a[112:113], v78 offset:16384
    buffer_load_dwordx4 a[4:7], v67, s[48:51], s8 offen offset:1024 sc1
    v_mfma_f32_16x16x32_bf16 v[8:11], a[84:87], a[24:27], v[8:11]
    ds_read_b64_tr_b16 a[114:115], v78 offset:20480
    s_add_u32 s60, s13, 360448
    v_mfma_f32_16x16x32_bf16 v[40:43], a[80:83], a[20:23], v[40:43]
    ds_read_b64_tr_b16 a[116:117], v78 offset:24576
    s_add_u32 m0, s14, 139264
    v_mfma_f32_16x16x32_bf16 v[40:43], a[84:87], a[28:31], v[40:43]
    ds_read_b64_tr_b16 a[118:119], v78 offset:28672
    buffer_load_dwordx4 v234, s[56:59], s60 offen offset:0  lds
    v_mfma_f32_16x16x32_bf16 v[12:15], a[88:91], a[16:19], v[12:15]
    ds_read_b64_tr_b16 a[120:121], v79 offset:16384
    v_mfma_f32_16x16x32_bf16 v[12:15], a[92:95], a[24:27], v[12:15]
    ds_read_b64_tr_b16 a[122:123], v79 offset:20480
    buffer_load_dwordx4 v235, s[56:59], s60 offen offset:1024  lds
    v_mfma_f32_16x16x32_bf16 v[44:47], a[88:91], a[20:23], v[44:47]
    ds_read_b64_tr_b16 a[124:125], v79 offset:24576
    s_add_u32 s60, s17, s13
    v_mfma_f32_16x16x32_bf16 v[44:47], a[92:95], a[28:31], v[44:47]
    ds_read_b64_tr_b16 a[126:127], v79 offset:28672
    s_waitcnt lgkmcnt(8)
    s_barrier
    v_mfma_f32_16x16x32_bf16 v[16:19], a[96:99], a[16:19], v[16:19]
    ds_read_b64_tr_b16 a[80:81], v72 offset:32768
    s_add_u32 m0, s14, 147456
    v_mfma_f32_16x16x32_bf16 v[16:19], a[100:103], a[24:27], v[16:19]
    ds_read_b64_tr_b16 a[82:83], v72 offset:36864
    buffer_load_dwordx4 v234, s[56:59], s60 offen offset:0  lds
    v_mfma_f32_16x16x32_bf16 v[48:51], a[96:99], a[20:23], v[48:51]
    ds_read_b64_tr_b16 a[84:85], v72 offset:40960
    v_mfma_f32_16x16x32_bf16 v[48:51], a[100:103], a[28:31], v[48:51]
    ds_read_b64_tr_b16 a[86:87], v72 offset:45056
    buffer_load_dwordx4 v235, s[56:59], s60 offen offset:1024  lds
    v_mfma_f32_16x16x32_bf16 v[20:23], a[104:107], a[16:19], v[20:23]
    ds_read_b64_tr_b16 a[88:89], v73 offset:32768
    v_mfma_f32_16x16x32_bf16 v[20:23], a[108:111], a[24:27], v[20:23]
    ds_read_b64_tr_b16 a[90:91], v73 offset:36864
    v_mfma_f32_16x16x32_bf16 v[52:55], a[104:107], a[20:23], v[52:55]
    ds_read_b64_tr_b16 a[92:93], v73 offset:40960
    v_mfma_f32_16x16x32_bf16 v[52:55], a[108:111], a[28:31], v[52:55]
    ds_read_b64_tr_b16 a[94:95], v73 offset:45056
    s_waitcnt lgkmcnt(8)
    v_mfma_f32_16x16x32_bf16 v[24:27], a[112:115], a[16:19], v[24:27]
    ds_read_b64_tr_b16 a[96:97], v74 offset:32768
    v_mfma_f32_16x16x32_bf16 v[24:27], a[116:119], a[24:27], v[24:27]
    ds_read_b64_tr_b16 a[98:99], v74 offset:36864
    v_mfma_f32_16x16x32_bf16 v[56:59], a[112:115], a[20:23], v[56:59]
    ds_read_b64_tr_b16 a[100:101], v74 offset:40960
    v_mfma_f32_16x16x32_bf16 v[56:59], a[116:119], a[28:31], v[56:59]
    ds_read_b64_tr_b16 a[102:103], v74 offset:45056
    v_mfma_f32_16x16x32_bf16 v[28:31], a[120:123], a[16:19], v[28:31]
    ds_read_b64_tr_b16 a[104:105], v75 offset:32768
    v_mfma_f32_16x16x32_bf16 v[28:31], a[124:127], a[24:27], v[28:31]
    ds_read_b64_tr_b16 a[106:107], v75 offset:36864
    v_mfma_f32_16x16x32_bf16 v[60:63], a[120:123], a[20:23], v[60:63]
    ds_read_b64_tr_b16 a[108:109], v75 offset:40960
    v_mfma_f32_16x16x32_bf16 v[60:63], a[124:127], a[28:31], v[60:63]
    ds_read_b64_tr_b16 a[110:111], v75 offset:45056
    s_waitcnt vmcnt(23) lgkmcnt(8)
    v_mfma_f32_16x16x32_bf16 v[0:3], a[80:83], a[32:35], v[0:3]
    ds_read_b64_tr_b16 a[112:113], v76 offset:32768
    s_lshl1_add_u32 s8, s13, 393216
    v_mfma_f32_16x16x32_bf16 v[0:3], a[84:87], a[40:43], v[0:3]
    ds_read_b64_tr_b16 a[114:115], v76 offset:36864
    buffer_load_dwordx4 a[8:11], v67, s[48:51], s8 offen offset:0 sc1
    v_mfma_f32_16x16x32_bf16 v[32:35], a[80:83], a[36:39], v[32:35]
    ds_read_b64_tr_b16 a[116:117], v76 offset:40960
    v_mfma_f32_16x16x32_bf16 v[32:35], a[84:87], a[44:47], v[32:35]
    ds_read_b64_tr_b16 a[118:119], v76 offset:45056
    buffer_load_dwordx4 a[12:15], v67, s[48:51], s8 offen offset:1024 sc1
    v_mfma_f32_16x16x32_bf16 v[4:7], a[88:91], a[32:35], v[4:7]
    ds_read_b64_tr_b16 a[120:121], v77 offset:32768
    s_lshl1_add_u32 s8, s13, 524288
    v_mfma_f32_16x16x32_bf16 v[4:7], a[92:95], a[40:43], v[4:7]
    ds_read_b64_tr_b16 a[122:123], v77 offset:36864
    buffer_load_dwordx4 a[16:19], v67, s[48:51], s8 offen offset:0 sc1
    v_mfma_f32_16x16x32_bf16 v[36:39], a[88:91], a[36:39], v[36:39]
    ds_read_b64_tr_b16 a[124:125], v77 offset:40960
    v_mfma_f32_16x16x32_bf16 v[36:39], a[92:95], a[44:47], v[36:39]
    ds_read_b64_tr_b16 a[126:127], v77 offset:45056
    s_waitcnt lgkmcnt(8)
    v_mfma_f32_16x16x32_bf16 v[8:11], a[96:99], a[32:35], v[8:11]
    ds_read_b64_tr_b16 a[80:81], v78 offset:32768
    buffer_load_dwordx4 a[20:23], v67, s[48:51], s8 offen offset:1024 sc1
    v_mfma_f32_16x16x32_bf16 v[8:11], a[100:103], a[40:43], v[8:11]
    ds_read_b64_tr_b16 a[82:83], v78 offset:36864
    s_add_u32 s60, s18, 0
    v_mfma_f32_16x16x32_bf16 v[40:43], a[96:99], a[36:39], v[40:43]
    ds_read_b64_tr_b16 a[84:85], v78 offset:40960
    s_add_u32 m0, s14, 155648
    v_mfma_f32_16x16x32_bf16 v[40:43], a[100:103], a[44:47], v[40:43]
    ds_read_b64_tr_b16 a[86:87], v78 offset:45056
    buffer_load_dwordx4 v234, s[56:59], s60 offen offset:0  lds
    v_mfma_f32_16x16x32_bf16 v[12:15], a[104:107], a[32:35], v[12:15]
    ds_read_b64_tr_b16 a[88:89], v79 offset:32768
    v_mfma_f32_16x16x32_bf16 v[12:15], a[108:111], a[40:43], v[12:15]
    ds_read_b64_tr_b16 a[90:91], v79 offset:36864
    buffer_load_dwordx4 v235, s[56:59], s60 offen offset:1024  lds
    v_mfma_f32_16x16x32_bf16 v[44:47], a[104:107], a[36:39], v[44:47]
    ds_read_b64_tr_b16 a[92:93], v79 offset:40960
    s_add_u32 s60, s18, 65536
    v_mfma_f32_16x16x32_bf16 v[44:47], a[108:111], a[44:47], v[44:47]
    ds_read_b64_tr_b16 a[94:95], v79 offset:45056
    s_waitcnt lgkmcnt(8)
    s_barrier
    v_mfma_f32_16x16x32_bf16 v[16:19], a[112:115], a[32:35], v[16:19]
    ds_read_b64_tr_b16 a[96:97], v72 offset:49152
    s_add_u32 m0, s14, 0
    v_mfma_f32_16x16x32_bf16 v[16:19], a[116:119], a[40:43], v[16:19]
    ds_read_b64_tr_b16 a[98:99], v72 offset:53248
    buffer_load_dwordx4 v234, s[56:59], s60 offen offset:0  lds
    v_mfma_f32_16x16x32_bf16 v[48:51], a[112:115], a[36:39], v[48:51]
    ds_read_b64_tr_b16 a[100:101], v72 offset:57344
    v_mfma_f32_16x16x32_bf16 v[48:51], a[116:119], a[44:47], v[48:51]
    ds_read_b64_tr_b16 a[102:103], v72 offset:61440
    buffer_load_dwordx4 v235, s[56:59], s60 offen offset:1024  lds
    v_mfma_f32_16x16x32_bf16 v[20:23], a[120:123], a[32:35], v[20:23]
    ds_read_b64_tr_b16 a[104:105], v73 offset:49152
    v_mfma_f32_16x16x32_bf16 v[20:23], a[124:127], a[40:43], v[20:23]
    ds_read_b64_tr_b16 a[106:107], v73 offset:53248
    v_mfma_f32_16x16x32_bf16 v[52:55], a[120:123], a[36:39], v[52:55]
    ds_read_b64_tr_b16 a[108:109], v73 offset:57344
    v_mfma_f32_16x16x32_bf16 v[52:55], a[124:127], a[44:47], v[52:55]
    ds_read_b64_tr_b16 a[110:111], v73 offset:61440
    s_waitcnt lgkmcnt(8)
    v_mfma_f32_16x16x32_bf16 v[24:27], a[80:83], a[32:35], v[24:27]
    ds_read_b64_tr_b16 a[112:113], v74 offset:49152
    v_mfma_f32_16x16x32_bf16 v[24:27], a[84:87], a[40:43], v[24:27]
    ds_read_b64_tr_b16 a[114:115], v74 offset:53248
    v_mfma_f32_16x16x32_bf16 v[56:59], a[80:83], a[36:39], v[56:59]
    ds_read_b64_tr_b16 a[116:117], v74 offset:57344
    v_mfma_f32_16x16x32_bf16 v[56:59], a[84:87], a[44:47], v[56:59]
    ds_read_b64_tr_b16 a[118:119], v74 offset:61440
    v_mfma_f32_16x16x32_bf16 v[28:31], a[88:91], a[32:35], v[28:31]
    ds_read_b64_tr_b16 a[120:121], v75 offset:49152
    v_mfma_f32_16x16x32_bf16 v[28:31], a[92:95], a[40:43], v[28:31]
    ds_read_b64_tr_b16 a[122:123], v75 offset:53248
    v_mfma_f32_16x16x32_bf16 v[60:63], a[88:91], a[36:39], v[60:63]
    ds_read_b64_tr_b16 a[124:125], v75 offset:57344
    v_mfma_f32_16x16x32_bf16 v[60:63], a[92:95], a[44:47], v[60:63]
    ds_read_b64_tr_b16 a[126:127], v75 offset:61440
    s_waitcnt vmcnt(23) lgkmcnt(8)
    v_mfma_f32_16x16x32_bf16 v[0:3], a[96:99], a[48:51], v[0:3]
    ds_read_b64_tr_b16 a[80:81], v76 offset:49152
    s_branch L_fused_kernel_pc12
L_fused_kernel_isl0_12:
    s_branch L_fused_kernel_warmback0
L_fused_kernel_pc12:
    s_lshl1_add_u32 s8, s13, 655360
    v_mfma_f32_16x16x32_bf16 v[0:3], a[100:103], a[56:59], v[0:3]
    ds_read_b64_tr_b16 a[82:83], v76 offset:53248
    buffer_load_dwordx4 a[24:27], v67, s[48:51], s8 offen offset:0 sc1
    v_mfma_f32_16x16x32_bf16 v[32:35], a[96:99], a[52:55], v[32:35]
    ds_read_b64_tr_b16 a[84:85], v76 offset:57344
    v_mfma_f32_16x16x32_bf16 v[32:35], a[100:103], a[60:63], v[32:35]
    ds_read_b64_tr_b16 a[86:87], v76 offset:61440
    buffer_load_dwordx4 a[28:31], v67, s[48:51], s8 offen offset:1024 sc1
    v_mfma_f32_16x16x32_bf16 v[4:7], a[104:107], a[48:51], v[4:7]
    ds_read_b64_tr_b16 a[88:89], v77 offset:49152
    s_lshl1_add_u32 s8, s13, 786432
    v_mfma_f32_16x16x32_bf16 v[4:7], a[108:111], a[56:59], v[4:7]
    ds_read_b64_tr_b16 a[90:91], v77 offset:53248
    buffer_load_dwordx4 a[32:35], v67, s[48:51], s8 offen offset:0 sc1
    v_mfma_f32_16x16x32_bf16 v[36:39], a[104:107], a[52:55], v[36:39]
    ds_read_b64_tr_b16 a[92:93], v77 offset:57344
    v_mfma_f32_16x16x32_bf16 v[36:39], a[108:111], a[60:63], v[36:39]
    ds_read_b64_tr_b16 a[94:95], v77 offset:61440
    s_waitcnt lgkmcnt(8)
    v_mfma_f32_16x16x32_bf16 v[8:11], a[112:115], a[48:51], v[8:11]
    ds_read_b64_tr_b16 a[96:97], v78 offset:49152
    buffer_load_dwordx4 a[36:39], v67, s[48:51], s8 offen offset:1024 sc1
    v_mfma_f32_16x16x32_bf16 v[8:11], a[116:119], a[56:59], v[8:11]
    ds_read_b64_tr_b16 a[98:99], v78 offset:53248
    s_add_u32 s60, s18, 131072
    v_mfma_f32_16x16x32_bf16 v[40:43], a[112:115], a[52:55], v[40:43]
    ds_read_b64_tr_b16 a[100:101], v78 offset:57344
    s_add_u32 m0, s14, 8192
    v_mfma_f32_16x16x32_bf16 v[40:43], a[116:119], a[60:63], v[40:43]
    ds_read_b64_tr_b16 a[102:103], v78 offset:61440
    buffer_load_dwordx4 v234, s[56:59], s60 offen offset:0  lds
    v_mfma_f32_16x16x32_bf16 v[12:15], a[120:123], a[48:51], v[12:15]
    ds_read_b64_tr_b16 a[104:105], v79 offset:49152
    v_mfma_f32_16x16x32_bf16 v[12:15], a[124:127], a[56:59], v[12:15]
    ds_read_b64_tr_b16 a[106:107], v79 offset:53248
    buffer_load_dwordx4 v235, s[56:59], s60 offen offset:1024  lds
    v_mfma_f32_16x16x32_bf16 v[44:47], a[120:123], a[52:55], v[44:47]
    ds_read_b64_tr_b16 a[108:109], v79 offset:57344
    s_add_u32 s60, s18, 229376
    v_mfma_f32_16x16x32_bf16 v[44:47], a[124:127], a[60:63], v[44:47]
    ds_read_b64_tr_b16 a[110:111], v79 offset:61440
    s_waitcnt lgkmcnt(8)
    s_barrier
    v_mfma_f32_16x16x32_bf16 v[16:19], a[80:83], a[48:51], v[16:19]
    ds_read_b64_tr_b16 a[112:113], v80 offset:0
    s_add_u32 m0, s14, 16384
    v_mfma_f32_16x16x32_bf16 v[16:19], a[84:87], a[56:59], v[16:19]
    ds_read_b64_tr_b16 a[114:115], v80 offset:4096
    buffer_load_dwordx4 v234, s[56:59], s60 offen offset:0  lds
    v_mfma_f32_16x16x32_bf16 v[48:51], a[80:83], a[52:55], v[48:51]
    ds_read_b64_tr_b16 a[116:117], v80 offset:8192
    v_mfma_f32_16x16x32_bf16 v[48:51], a[84:87], a[60:63], v[48:51]
    ds_read_b64_tr_b16 a[118:119], v80 offset:12288
    buffer_load_dwordx4 v235, s[56:59], s60 offen offset:1024  lds
    v_mfma_f32_16x16x32_bf16 v[20:23], a[88:91], a[48:51], v[20:23]
    ds_read_b64_tr_b16 a[120:121], v81 offset:0
    v_mfma_f32_16x16x32_bf16 v[20:23], a[92:95], a[56:59], v[20:23]
    ds_read_b64_tr_b16 a[122:123], v81 offset:4096
    v_mfma_f32_16x16x32_bf16 v[52:55], a[88:91], a[52:55], v[52:55]
    ds_read_b64_tr_b16 a[124:125], v81 offset:8192
    v_mfma_f32_16x16x32_bf16 v[52:55], a[92:95], a[60:63], v[52:55]
    ds_read_b64_tr_b16 a[126:127], v81 offset:12288
    s_waitcnt lgkmcnt(8)
    v_mfma_f32_16x16x32_bf16 v[24:27], a[96:99], a[48:51], v[24:27]
    ds_read_b64_tr_b16 a[80:81], v82 offset:0
    v_mfma_f32_16x16x32_bf16 v[24:27], a[100:103], a[56:59], v[24:27]
    ds_read_b64_tr_b16 a[82:83], v82 offset:4096
    v_mfma_f32_16x16x32_bf16 v[56:59], a[96:99], a[52:55], v[56:59]
    ds_read_b64_tr_b16 a[84:85], v82 offset:8192
    v_mfma_f32_16x16x32_bf16 v[56:59], a[100:103], a[60:63], v[56:59]
    ds_read_b64_tr_b16 a[86:87], v82 offset:12288
    v_mfma_f32_16x16x32_bf16 v[28:31], a[104:107], a[48:51], v[28:31]
    ds_read_b64_tr_b16 a[88:89], v83 offset:0
    v_mfma_f32_16x16x32_bf16 v[28:31], a[108:111], a[56:59], v[28:31]
    ds_read_b64_tr_b16 a[90:91], v83 offset:4096
    v_mfma_f32_16x16x32_bf16 v[60:63], a[104:107], a[52:55], v[60:63]
    ds_read_b64_tr_b16 a[92:93], v83 offset:8192
    v_mfma_f32_16x16x32_bf16 v[60:63], a[108:111], a[60:63], v[60:63]
    ds_read_b64_tr_b16 a[94:95], v83 offset:12288
    s_waitcnt vmcnt(22) lgkmcnt(8)
    v_mfma_f32_16x16x32_bf16 v[0:3], a[112:115], a[64:67], v[0:3]
    ds_read_b64_tr_b16 a[96:97], v84 offset:0
    v_mfma_f32_16x16x32_bf16 v[0:3], a[116:119], a[72:75], v[0:3]
    ds_read_b64_tr_b16 a[98:99], v84 offset:4096
    v_cmp_ne_u64 vcc, s[62:63], v[64:65]
    v_mfma_f32_16x16x32_bf16 v[32:35], a[112:115], a[68:71], v[32:35]
    ds_read_b64_tr_b16 a[100:101], v84 offset:8192
    s_nop 4
    v_mfma_f32_16x16x32_bf16 v[32:35], a[116:119], a[76:79], v[32:35]
    ds_read_b64_tr_b16 a[102:103], v84 offset:12288
    s_and_b32 s3, vcc_lo, 0xc00
    v_mfma_f32_16x16x32_bf16 v[4:7], a[120:123], a[64:67], v[4:7]
    ds_read_b64_tr_b16 a[104:105], v85 offset:0
    s_cbranch_scc1 L_fused_kernel_fs_38
L_fused_kernel_fb_39:
    v_mfma_f32_16x16x32_bf16 v[4:7], a[124:127], a[72:75], v[4:7]
    ds_read_b64_tr_b16 a[106:107], v85 offset:4096
    s_lshl1_add_u32 s8, s18, 0
    v_mfma_f32_16x16x32_bf16 v[36:39], a[120:123], a[68:71], v[36:39]
    ds_read_b64_tr_b16 a[108:109], v85 offset:8192
    buffer_load_dwordx4 a[40:43], v67, s[48:51], s8 offen offset:0 sc1
    v_mfma_f32_16x16x32_bf16 v[36:39], a[124:127], a[76:79], v[36:39]
    ds_read_b64_tr_b16 a[110:111], v85 offset:12288
    s_waitcnt lgkmcnt(8)
    v_mfma_f32_16x16x32_bf16 v[8:11], a[80:83], a[64:67], v[8:11]
    ds_read_b64_tr_b16 a[112:113], v86 offset:0
    buffer_load_dwordx4 a[44:47], v67, s[48:51], s8 offen offset:1024 sc1
    v_mfma_f32_16x16x32_bf16 v[8:11], a[84:87], a[72:75], v[8:11]
    ds_read_b64_tr_b16 a[114:115], v86 offset:4096
    s_lshl1_add_u32 s8, s18, 131072
    v_mfma_f32_16x16x32_bf16 v[40:43], a[80:83], a[68:71], v[40:43]
    ds_read_b64_tr_b16 a[116:117], v86 offset:8192
    buffer_load_dwordx4 a[48:51], v67, s[48:51], s8 offen offset:0 sc1
    v_mfma_f32_16x16x32_bf16 v[40:43], a[84:87], a[76:79], v[40:43]
    ds_read_b64_tr_b16 a[118:119], v86 offset:12288
    v_mfma_f32_16x16x32_bf16 v[12:15], a[88:91], a[64:67], v[12:15]
    ds_read_b64_tr_b16 a[120:121], v87 offset:0
    buffer_load_dwordx4 a[52:55], v67, s[48:51], s8 offen offset:1024 sc1
    v_mfma_f32_16x16x32_bf16 v[12:15], a[92:95], a[72:75], v[12:15]
    ds_read_b64_tr_b16 a[122:123], v87 offset:4096
    s_add_u32 s60, s18, 294912
    v_mfma_f32_16x16x32_bf16 v[44:47], a[88:91], a[68:71], v[44:47]
    ds_read_b64_tr_b16 a[124:125], v87 offset:8192
    s_add_u32 m0, s14, 24576
    v_mfma_f32_16x16x32_bf16 v[44:47], a[92:95], a[76:79], v[44:47]
    ds_read_b64_tr_b16 a[126:127], v87 offset:12288
    s_waitcnt lgkmcnt(8)
    s_barrier
    v_mfma_f32_16x16x32_bf16 v[16:19], a[96:99], a[64:67], v[16:19]
    ds_read_b64_tr_b16 a[80:81], v80 offset:16384
    buffer_load_dwordx4 v234, s[56:59], s60 offen offset:0  lds
    v_mfma_f32_16x16x32_bf16 v[16:19], a[100:103], a[72:75], v[16:19]
    ds_read_b64_tr_b16 a[82:83], v80 offset:20480
    v_mfma_f32_16x16x32_bf16 v[48:51], a[96:99], a[68:71], v[48:51]
    ds_read_b64_tr_b16 a[84:85], v80 offset:24576
    buffer_load_dwordx4 v235, s[56:59], s60 offen offset:1024  lds
    v_mfma_f32_16x16x32_bf16 v[48:51], a[100:103], a[76:79], v[48:51]
    ds_read_b64_tr_b16 a[86:87], v80 offset:28672
    s_add_u32 s60, s18, 360448
    v_mfma_f32_16x16x32_bf16 v[20:23], a[104:107], a[64:67], v[20:23]
    ds_read_b64_tr_b16 a[88:89], v81 offset:16384
    s_add_u32 m0, s14, 32768
    v_mfma_f32_16x16x32_bf16 v[20:23], a[108:111], a[72:75], v[20:23]
    ds_read_b64_tr_b16 a[90:91], v81 offset:20480
    buffer_load_dwordx4 v234, s[56:59], s60 offen offset:0  lds
    v_mfma_f32_16x16x32_bf16 v[52:55], a[104:107], a[68:71], v[52:55]
    ds_read_b64_tr_b16 a[92:93], v81 offset:24576
    v_mfma_f32_16x16x32_bf16 v[52:55], a[108:111], a[76:79], v[52:55]
    ds_read_b64_tr_b16 a[94:95], v81 offset:28672
    s_waitcnt lgkmcnt(8)
    v_mfma_f32_16x16x32_bf16 v[24:27], a[112:115], a[64:67], v[24:27]
    ds_read_b64_tr_b16 a[96:97], v82 offset:16384
    buffer_load_dwordx4 v235, s[56:59], s60 offen offset:1024  lds
    v_mfma_f32_16x16x32_bf16 v[24:27], a[116:119], a[72:75], v[24:27]
    ds_read_b64_tr_b16 a[98:99], v82 offset:20480
    v_mfma_f32_16x16x32_bf16 v[56:59], a[112:115], a[68:71], v[56:59]
    ds_read_b64_tr_b16 a[100:101], v82 offset:24576
    v_mfma_f32_16x16x32_bf16 v[56:59], a[116:119], a[76:79], v[56:59]
    ds_read_b64_tr_b16 a[102:103], v82 offset:28672
    v_mfma_f32_16x16x32_bf16 v[28:31], a[120:123], a[64:67], v[28:31]
    ds_read_b64_tr_b16 a[104:105], v83 offset:16384
    v_mfma_f32_16x16x32_bf16 v[28:31], a[124:127], a[72:75], v[28:31]
    ds_read_b64_tr_b16 a[106:107], v83 offset:20480
    v_mfma_f32_16x16x32_bf16 v[60:63], a[120:123], a[68:71], v[60:63]
    ds_read_b64_tr_b16 a[108:109], v83 offset:24576
    v_mfma_f32_16x16x32_bf16 v[60:63], a[124:127], a[76:79], v[60:63]
    ds_read_b64_tr_b16 a[110:111], v83 offset:28672
    s_waitcnt vmcnt(22) lgkmcnt(8)
    v_mfma_f32_16x16x32_bf16 v[0:3], a[80:83], a[0:3], v[0:3]
    ds_read_b64_tr_b16 a[112:113], v84 offset:16384
    buffer_load_dwordx2 v[64:65], v66, s[36:39], 0 offen sc1
    v_mfma_f32_16x16x32_bf16 v[0:3], a[84:87], a[8:11], v[0:3]
    ds_read_b64_tr_b16 a[114:115], v84 offset:20480
    s_lshl1_add_u32 s8, s18, 262144
    v_mfma_f32_16x16x32_bf16 v[32:35], a[80:83], a[4:7], v[32:35]
    ds_read_b64_tr_b16 a[116:117], v84 offset:24576
    buffer_load_dwordx4 a[56:59], v67, s[48:51], s8 offen offset:0 sc1
    v_mfma_f32_16x16x32_bf16 v[32:35], a[84:87], a[12:15], v[32:35]
    ds_read_b64_tr_b16 a[118:119], v84 offset:28672
    v_mfma_f32_16x16x32_bf16 v[4:7], a[88:91], a[0:3], v[4:7]
    ds_read_b64_tr_b16 a[120:121], v85 offset:16384
    buffer_load_dwordx4 a[60:63], v67, s[48:51], s8 offen offset:1024 sc1
    v_mfma_f32_16x16x32_bf16 v[4:7], a[92:95], a[8:11], v[4:7]
    ds_read_b64_tr_b16 a[122:123], v85 offset:20480
    s_lshl1_add_u32 s8, s18, 393216
    v_mfma_f32_16x16x32_bf16 v[36:39], a[88:91], a[4:7], v[36:39]
    ds_read_b64_tr_b16 a[124:125], v85 offset:24576
    buffer_load_dwordx4 a[64:67], v67, s[48:51], s8 offen offset:0 sc1
    v_mfma_f32_16x16x32_bf16 v[36:39], a[92:95], a[12:15], v[36:39]
    ds_read_b64_tr_b16 a[126:127], v85 offset:28672
    s_waitcnt lgkmcnt(8)
    v_mfma_f32_16x16x32_bf16 v[8:11], a[96:99], a[0:3], v[8:11]
    ds_read_b64_tr_b16 a[80:81], v86 offset:16384
    buffer_load_dwordx4 a[68:71], v67, s[48:51], s8 offen offset:1024 sc1
    v_mfma_f32_16x16x32_bf16 v[8:11], a[100:103], a[8:11], v[8:11]
    ds_read_b64_tr_b16 a[82:83], v86 offset:20480
    s_add_u32 s60, s17, s18
    v_mfma_f32_16x16x32_bf16 v[40:43], a[96:99], a[4:7], v[40:43]
    ds_read_b64_tr_b16 a[84:85], v86 offset:24576
    s_add_u32 m0, s14, 40960
    v_mfma_f32_16x16x32_bf16 v[40:43], a[100:103], a[12:15], v[40:43]
    ds_read_b64_tr_b16 a[86:87], v86 offset:28672
    buffer_load_dwordx4 v234, s[56:59], s60 offen offset:0  lds
    v_mfma_f32_16x16x32_bf16 v[12:15], a[104:107], a[0:3], v[12:15]
    ds_read_b64_tr_b16 a[88:89], v87 offset:16384
    v_mfma_f32_16x16x32_bf16 v[12:15], a[108:111], a[8:11], v[12:15]
    ds_read_b64_tr_b16 a[90:91], v87 offset:20480
    buffer_load_dwordx4 v235, s[56:59], s60 offen offset:1024  lds
    v_mfma_f32_16x16x32_bf16 v[44:47], a[104:107], a[4:7], v[44:47]
    ds_read_b64_tr_b16 a[92:93], v87 offset:24576
    s_add_u32 s60, s19, 0
    v_mfma_f32_16x16x32_bf16 v[44:47], a[108:111], a[12:15], v[44:47]
    ds_read_b64_tr_b16 a[94:95], v87 offset:28672
    s_waitcnt lgkmcnt(8)
    s_barrier
    v_mfma_f32_16x16x32_bf16 v[16:19], a[112:115], a[0:3], v[16:19]
    ds_read_b64_tr_b16 a[96:97], v88 offset:0
    s_add_u32 m0, s14, 49152
    v_mfma_f32_16x16x32_bf16 v[16:19], a[116:119], a[8:11], v[16:19]
    ds_read_b64_tr_b16 a[98:99], v88 offset:4096
    buffer_load_dwordx4 v234, s[56:59], s60 offen offset:0  lds
    v_mfma_f32_16x16x32_bf16 v[48:51], a[112:115], a[4:7], v[48:51]
    ds_read_b64_tr_b16 a[100:101], v88 offset:8192
    v_mfma_f32_16x16x32_bf16 v[48:51], a[116:119], a[12:15], v[48:51]
    ds_read_b64_tr_b16 a[102:103], v88 offset:12288
    buffer_load_dwordx4 v235, s[56:59], s60 offen offset:1024  lds
    v_mfma_f32_16x16x32_bf16 v[20:23], a[120:123], a[0:3], v[20:23]
    ds_read_b64_tr_b16 a[104:105], v89 offset:0
    v_mfma_f32_16x16x32_bf16 v[20:23], a[124:127], a[8:11], v[20:23]
    ds_read_b64_tr_b16 a[106:107], v89 offset:4096
    v_mfma_f32_16x16x32_bf16 v[52:55], a[120:123], a[4:7], v[52:55]
    ds_read_b64_tr_b16 a[108:109], v89 offset:8192
    v_mfma_f32_16x16x32_bf16 v[52:55], a[124:127], a[12:15], v[52:55]
    ds_read_b64_tr_b16 a[110:111], v89 offset:12288
    s_waitcnt lgkmcnt(8)
    v_mfma_f32_16x16x32_bf16 v[24:27], a[80:83], a[0:3], v[24:27]
    ds_read_b64_tr_b16 a[112:113], v90 offset:0
    v_mfma_f32_16x16x32_bf16 v[24:27], a[84:87], a[8:11], v[24:27]
    ds_read_b64_tr_b16 a[114:115], v90 offset:4096
    v_mfma_f32_16x16x32_bf16 v[56:59], a[80:83], a[4:7], v[56:59]
    ds_read_b64_tr_b16 a[116:117], v90 offset:8192
    v_mfma_f32_16x16x32_bf16 v[56:59], a[84:87], a[12:15], v[56:59]
    ds_read_b64_tr_b16 a[118:119], v90 offset:12288
    v_mfma_f32_16x16x32_bf16 v[28:31], a[88:91], a[0:3], v[28:31]
    ds_read_b64_tr_b16 a[120:121], v91 offset:0
    v_mfma_f32_16x16x32_bf16 v[28:31], a[92:95], a[8:11], v[28:31]
    ds_read_b64_tr_b16 a[122:123], v91 offset:4096
    v_mfma_f32_16x16x32_bf16 v[60:63], a[88:91], a[4:7], v[60:63]
    ds_read_b64_tr_b16 a[124:125], v91 offset:8192
    v_mfma_f32_16x16x32_bf16 v[60:63], a[92:95], a[12:15], v[60:63]
    ds_read_b64_tr_b16 a[126:127], v91 offset:12288
    s_waitcnt vmcnt(23) lgkmcnt(8)
    v_mfma_f32_16x16x32_bf16 v[0:3], a[96:99], a[16:19], v[0:3]
    ds_read_b64_tr_b16 a[80:81], v92 offset:0
    s_lshl1_add_u32 s8, s18, 524288
    v_mfma_f32_16x16x32_bf16 v[0:3], a[100:103], a[24:27], v[0:3]
    ds_read_b64_tr_b16 a[82:83], v92 offset:4096
    buffer_load_dwordx4 a[72:75], v67, s[48:51], s8 offen offset:0 sc1
    v_mfma_f32_16x16x32_bf16 v[32:35], a[96:99], a[20:23], v[32:35]
    ds_read_b64_tr_b16 a[84:85], v92 offset:8192
    v_mfma_f32_16x16x32_bf16 v[32:35], a[100:103], a[28:31], v[32:35]
    ds_read_b64_tr_b16 a[86:87], v92 offset:12288
    buffer_load_dwordx4 a[76:79], v67, s[48:51], s8 offen offset:1024 sc1
    v_mfma_f32_16x16x32_bf16 v[4:7], a[104:107], a[16:19], v[4:7]
    ds_read_b64_tr_b16 a[88:89], v93 offset:0
    s_lshl1_add_u32 s8, s18, 655360
    v_mfma_f32_16x16x32_bf16 v[4:7], a[108:111], a[24:27], v[4:7]
    ds_read_b64_tr_b16 a[90:91], v93 offset:4096
    buffer_load_dwordx4 a[0:3], v67, s[48:51], s8 offen offset:0 sc1
    v_mfma_f32_16x16x32_bf16 v[36:39], a[104:107], a[20:23], v[36:39]
    ds_read_b64_tr_b16 a[92:93], v93 offset:8192
    v_mfma_f32_16x16x32_bf16 v[36:39], a[108:111], a[28:31], v[36:39]
    ds_read_b64_tr_b16 a[94:95], v93 offset:12288
    s_waitcnt lgkmcnt(8)
    v_mfma_f32_16x16x32_bf16 v[8:11], a[112:115], a[16:19], v[8:11]
    ds_read_b64_tr_b16 a[96:97], v94 offset:0
    buffer_load_dwordx4 a[4:7], v67, s[48:51], s8 offen offset:1024 sc1
    v_mfma_f32_16x16x32_bf16 v[8:11], a[116:119], a[24:27], v[8:11]
    ds_read_b64_tr_b16 a[98:99], v94 offset:4096
    s_add_u32 s60, s19, 65536
    v_mfma_f32_16x16x32_bf16 v[40:43], a[112:115], a[20:23], v[40:43]
    ds_read_b64_tr_b16 a[100:101], v94 offset:8192
    s_add_u32 m0, s14, 57344
    v_mfma_f32_16x16x32_bf16 v[40:43], a[116:119], a[28:31], v[40:43]
    ds_read_b64_tr_b16 a[102:103], v94 offset:12288
    buffer_load_dwordx4 v234, s[56:59], s60 offen offset:0  lds
    v_mfma_f32_16x16x32_bf16 v[12:15], a[120:123], a[16:19], v[12:15]
    ds_read_b64_tr_b16 a[104:105], v95 offset:0
    v_mfma_f32_16x16x32_bf16 v[12:15], a[124:127], a[24:27], v[12:15]
    ds_read_b64_tr_b16 a[106:107], v95 offset:4096
    buffer_load_dwordx4 v235, s[56:59], s60 offen offset:1024  lds
    v_mfma_f32_16x16x32_bf16 v[44:47], a[120:123], a[20:23], v[44:47]
    ds_read_b64_tr_b16 a[108:109], v95 offset:8192
    s_add_u32 s60, s19, 131072
    v_mfma_f32_16x16x32_bf16 v[44:47], a[124:127], a[28:31], v[44:47]
    ds_read_b64_tr_b16 a[110:111], v95 offset:12288
    s_waitcnt lgkmcnt(8)
    s_barrier
    v_mfma_f32_16x16x32_bf16 v[16:19], a[80:83], a[16:19], v[16:19]
    ds_read_b64_tr_b16 a[112:113], v88 offset:16384
    s_add_u32 m0, s14, 65536
    v_mfma_f32_16x16x32_bf16 v[16:19], a[84:87], a[24:27], v[16:19]
    ds_read_b64_tr_b16 a[114:115], v88 offset:20480
    buffer_load_dwordx4 v234, s[56:59], s60 offen offset:0  lds
    v_mfma_f32_16x16x32_bf16 v[48:51], a[80:83], a[20:23], v[48:51]
    ds_read_b64_tr_b16 a[116:117], v88 offset:24576
    v_mfma_f32_16x16x32_bf16 v[48:51], a[84:87], a[28:31], v[48:51]
    ds_read_b64_tr_b16 a[118:119], v88 offset:28672
    buffer_load_dwordx4 v235, s[56:59], s60 offen offset:1024  lds
    v_mfma_f32_16x16x32_bf16 v[20:23], a[88:91], a[16:19], v[20:23]
    ds_read_b64_tr_b16 a[120:121], v89 offset:16384
    v_mfma_f32_16x16x32_bf16 v[20:23], a[92:95], a[24:27], v[20:23]
    ds_read_b64_tr_b16 a[122:123], v89 offset:20480
    v_mfma_f32_16x16x32_bf16 v[52:55], a[88:91], a[20:23], v[52:55]
    ds_read_b64_tr_b16 a[124:125], v89 offset:24576
    v_mfma_f32_16x16x32_bf16 v[52:55], a[92:95], a[28:31], v[52:55]
    ds_read_b64_tr_b16 a[126:127], v89 offset:28672
    s_waitcnt lgkmcnt(8)
    v_mfma_f32_16x16x32_bf16 v[24:27], a[96:99], a[16:19], v[24:27]
    ds_read_b64_tr_b16 a[80:81], v90 offset:16384
    v_mfma_f32_16x16x32_bf16 v[24:27], a[100:103], a[24:27], v[24:27]
    ds_read_b64_tr_b16 a[82:83], v90 offset:20480
    v_mfma_f32_16x16x32_bf16 v[56:59], a[96:99], a[20:23], v[56:59]
    ds_read_b64_tr_b16 a[84:85], v90 offset:24576
    v_mfma_f32_16x16x32_bf16 v[56:59], a[100:103], a[28:31], v[56:59]
    ds_read_b64_tr_b16 a[86:87], v90 offset:28672
    v_mfma_f32_16x16x32_bf16 v[28:31], a[104:107], a[16:19], v[28:31]
    ds_read_b64_tr_b16 a[88:89], v91 offset:16384
    v_mfma_f32_16x16x32_bf16 v[28:31], a[108:111], a[24:27], v[28:31]
    ds_read_b64_tr_b16 a[90:91], v91 offset:20480
    v_mfma_f32_16x16x32_bf16 v[60:63], a[104:107], a[20:23], v[60:63]
    ds_read_b64_tr_b16 a[92:93], v91 offset:24576
    v_mfma_f32_16x16x32_bf16 v[60:63], a[108:111], a[28:31], v[60:63]
    ds_read_b64_tr_b16 a[94:95], v91 offset:28672
    s_waitcnt vmcnt(23) lgkmcnt(8)
    v_mfma_f32_16x16x32_bf16 v[0:3], a[112:115], a[32:35], v[0:3]
    ds_read_b64_tr_b16 a[96:97], v92 offset:16384
    s_lshl1_add_u32 s8, s18, 786432
    v_mfma_f32_16x16x32_bf16 v[0:3], a[116:119], a[40:43], v[0:3]
    ds_read_b64_tr_b16 a[98:99], v92 offset:20480
    buffer_load_dwordx4 a[8:11], v67, s[48:51], s8 offen offset:0 sc1
    v_mfma_f32_16x16x32_bf16 v[32:35], a[112:115], a[36:39], v[32:35]
    ds_read_b64_tr_b16 a[100:101], v92 offset:24576
    v_mfma_f32_16x16x32_bf16 v[32:35], a[116:119], a[44:47], v[32:35]
    ds_read_b64_tr_b16 a[102:103], v92 offset:28672
    buffer_load_dwordx4 a[12:15], v67, s[48:51], s8 offen offset:1024 sc1
    v_mfma_f32_16x16x32_bf16 v[4:7], a[120:123], a[32:35], v[4:7]
    ds_read_b64_tr_b16 a[104:105], v93 offset:16384
    s_waitcnt vmcnt(18)
    v_mfma_f32_16x16x32_bf16 v[4:7], a[124:127], a[40:43], v[4:7]
    ds_read_b64_tr_b16 a[106:107], v93 offset:20480
    v_cmp_ne_u64 vcc, s[62:63], v[64:65]
    v_mfma_f32_16x16x32_bf16 v[36:39], a[120:123], a[36:39], v[36:39]
    ds_read_b64_tr_b16 a[108:109], v93 offset:24576
    s_nop 4
    v_mfma_f32_16x16x32_bf16 v[36:39], a[124:127], a[44:47], v[36:39]
    ds_read_b64_tr_b16 a[110:111], v93 offset:28672
    s_waitcnt lgkmcnt(8)
    v_mfma_f32_16x16x32_bf16 v[8:11], a[80:83], a[32:35], v[8:11]
    ds_read_b64_tr_b16 a[112:113], v94 offset:16384
    s_and_b32 s3, vcc_lo, 0x3000
    v_mfma_f32_16x16x32_bf16 v[8:11], a[84:87], a[40:43], v[8:11]
    ds_read_b64_tr_b16 a[114:115], v94 offset:20480
    s_cbranch_scc1 L_fused_kernel_fs_41
L_fused_kernel_fb_42:
    v_mfma_f32_16x16x32_bf16 v[40:43], a[80:83], a[36:39], v[40:43]
    ds_read_b64_tr_b16 a[116:117], v94 offset:24576
    s_lshl1_add_u32 s8, s19, 0
    v_mfma_f32_16x16x32_bf16 v[40:43], a[84:87], a[44:47], v[40:43]
    ds_read_b64_tr_b16 a[118:119], v94 offset:28672
    buffer_load_dwordx4 a[16:19], v67, s[48:51], s8 offen offset:0 sc1
    v_mfma_f32_16x16x32_bf16 v[12:15], a[88:91], a[32:35], v[12:15]
    ds_read_b64_tr_b16 a[120:121], v95 offset:16384
    v_mfma_f32_16x16x32_bf16 v[12:15], a[92:95], a[40:43], v[12:15]
    ds_read_b64_tr_b16 a[122:123], v95 offset:20480
    buffer_load_dwordx4 a[20:23], v67, s[48:51], s8 offen offset:1024 sc1
    v_mfma_f32_16x16x32_bf16 v[44:47], a[88:91], a[36:39], v[44:47]
    ds_read_b64_tr_b16 a[124:125], v95 offset:24576
    s_add_u32 s60, s19, 229376
    v_mfma_f32_16x16x32_bf16 v[44:47], a[92:95], a[44:47], v[44:47]
    ds_read_b64_tr_b16 a[126:127], v95 offset:28672
    s_waitcnt lgkmcnt(8)
    s_barrier
    v_mfma_f32_16x16x32_bf16 v[16:19], a[96:99], a[32:35], v[16:19]
    ds_read_b64_tr_b16 a[80:81], v72 offset:0
    s_add_u32 m0, s14, 73728
    v_mfma_f32_16x16x32_bf16 v[16:19], a[100:103], a[40:43], v[16:19]
    ds_read_b64_tr_b16 a[82:83], v72 offset:4096
    buffer_load_dwordx4 v234, s[56:59], s60 offen offset:0  lds
    v_mfma_f32_16x16x32_bf16 v[48:51], a[96:99], a[36:39], v[48:51]
    ds_read_b64_tr_b16 a[84:85], v72 offset:8192
    v_mfma_f32_16x16x32_bf16 v[48:51], a[100:103], a[44:47], v[48:51]
    ds_read_b64_tr_b16 a[86:87], v72 offset:12288
    buffer_load_dwordx4 v235, s[56:59], s60 offen offset:1024  lds
    v_mfma_f32_16x16x32_bf16 v[20:23], a[104:107], a[32:35], v[20:23]
    ds_read_b64_tr_b16 a[88:89], v73 offset:0
    s_add_u32 s60, s19, 294912
    v_mfma_f32_16x16x32_bf16 v[20:23], a[108:111], a[40:43], v[20:23]
    ds_read_b64_tr_b16 a[90:91], v73 offset:4096
    s_add_u32 m0, s14, 81920
    v_mfma_f32_16x16x32_bf16 v[52:55], a[104:107], a[36:39], v[52:55]
    ds_read_b64_tr_b16 a[92:93], v73 offset:8192
    buffer_load_dwordx4 v234, s[56:59], s60 offen offset:0  lds
    v_mfma_f32_16x16x32_bf16 v[52:55], a[108:111], a[44:47], v[52:55]
    ds_read_b64_tr_b16 a[94:95], v73 offset:12288
    s_waitcnt lgkmcnt(8)
    v_mfma_f32_16x16x32_bf16 v[24:27], a[112:115], a[32:35], v[24:27]
    ds_read_b64_tr_b16 a[96:97], v74 offset:0
    buffer_load_dwordx4 v235, s[56:59], s60 offen offset:1024  lds
    v_mfma_f32_16x16x32_bf16 v[24:27], a[116:119], a[40:43], v[24:27]
    ds_read_b64_tr_b16 a[98:99], v74 offset:4096
    v_mfma_f32_16x16x32_bf16 v[56:59], a[112:115], a[36:39], v[56:59]
    ds_read_b64_tr_b16 a[100:101], v74 offset:8192
    v_mfma_f32_16x16x32_bf16 v[56:59], a[116:119], a[44:47], v[56:59]
    ds_read_b64_tr_b16 a[102:103], v74 offset:12288
    v_mfma_f32_16x16x32_bf16 v[28:31], a[120:123], a[32:35], v[28:31]
    ds_read_b64_tr_b16 a[104:105], v75 offset:0
    v_mfma_f32_16x16x32_bf16 v[28:31], a[124:127], a[40:43], v[28:31]
    ds_read_b64_tr_b16 a[106:107], v75 offset:4096
    v_mfma_f32_16x16x32_bf16 v[60:63], a[120:123], a[36:39], v[60:63]
    ds_read_b64_tr_b16 a[108:109], v75 offset:8192
    v_mfma_f32_16x16x32_bf16 v[60:63], a[124:127], a[44:47], v[60:63]
    ds_read_b64_tr_b16 a[110:111], v75 offset:12288
    s_waitcnt vmcnt(22) lgkmcnt(8)
    v_mfma_f32_16x16x32_bf16 v[0:3], a[80:83], a[48:51], v[0:3]
    ds_read_b64_tr_b16 a[112:113], v76 offset:0
    buffer_load_dwordx2 v[64:65], v66, s[36:39], 0 offen sc1
    v_mfma_f32_16x16x32_bf16 v[0:3], a[84:87], a[56:59], v[0:3]
    ds_read_b64_tr_b16 a[114:115], v76 offset:4096
    s_lshl1_add_u32 s8, s19, 131072
    v_mfma_f32_16x16x32_bf16 v[32:35], a[80:83], a[52:55], v[32:35]
    ds_read_b64_tr_b16 a[116:117], v76 offset:8192
    buffer_load_dwordx4 a[24:27], v67, s[48:51], s8 offen offset:0 sc1
    v_mfma_f32_16x16x32_bf16 v[32:35], a[84:87], a[60:63], v[32:35]
    ds_read_b64_tr_b16 a[118:119], v76 offset:12288
    v_mfma_f32_16x16x32_bf16 v[4:7], a[88:91], a[48:51], v[4:7]
    ds_read_b64_tr_b16 a[120:121], v77 offset:0
    buffer_load_dwordx4 a[28:31], v67, s[48:51], s8 offen offset:1024 sc1
    v_mfma_f32_16x16x32_bf16 v[4:7], a[92:95], a[56:59], v[4:7]
    ds_read_b64_tr_b16 a[122:123], v77 offset:4096
    s_lshl1_add_u32 s8, s19, 262144
    v_mfma_f32_16x16x32_bf16 v[36:39], a[88:91], a[52:55], v[36:39]
    ds_read_b64_tr_b16 a[124:125], v77 offset:8192
    buffer_load_dwordx4 a[32:35], v67, s[48:51], s8 offen offset:0 sc1
    v_mfma_f32_16x16x32_bf16 v[36:39], a[92:95], a[60:63], v[36:39]
    ds_read_b64_tr_b16 a[126:127], v77 offset:12288
    s_waitcnt lgkmcnt(8)
    v_mfma_f32_16x16x32_bf16 v[8:11], a[96:99], a[48:51], v[8:11]
    ds_read_b64_tr_b16 a[80:81], v78 offset:0
    buffer_load_dwordx4 a[36:39], v67, s[48:51], s8 offen offset:1024 sc1
    v_mfma_f32_16x16x32_bf16 v[8:11], a[100:103], a[56:59], v[8:11]
    ds_read_b64_tr_b16 a[82:83], v78 offset:4096
    s_add_u32 s60, s19, 360448
    v_mfma_f32_16x16x32_bf16 v[40:43], a[96:99], a[52:55], v[40:43]
    ds_read_b64_tr_b16 a[84:85], v78 offset:8192
    s_add_u32 m0, s14, 90112
    v_mfma_f32_16x16x32_bf16 v[40:43], a[100:103], a[60:63], v[40:43]
    ds_read_b64_tr_b16 a[86:87], v78 offset:12288
    buffer_load_dwordx4 v234, s[56:59], s60 offen offset:0  lds
    v_mfma_f32_16x16x32_bf16 v[12:15], a[104:107], a[48:51], v[12:15]
    ds_read_b64_tr_b16 a[88:89], v79 offset:0
    v_mfma_f32_16x16x32_bf16 v[12:15], a[108:111], a[56:59], v[12:15]
    ds_read_b64_tr_b16 a[90:91], v79 offset:4096
    buffer_load_dwordx4 v235, s[56:59], s60 offen offset:1024  lds
    v_mfma_f32_16x16x32_bf16 v[44:47], a[104:107], a[52:55], v[44:47]
    ds_read_b64_tr_b16 a[92:93], v79 offset:8192
    s_add_u32 s60, s17, s19
    v_mfma_f32_16x16x32_bf16 v[44:47], a[108:111], a[60:63], v[44:47]
    ds_read_b64_tr_b16 a[94:95], v79 offset:12288
    s_waitcnt lgkmcnt(8)
    s_barrier
    v_mfma_f32_16x16x32_bf16 v[16:19], a[112:115], a[48:51], v[16:19]
    ds_read_b64_tr_b16 a[96:97], v72 offset:16384
    s_add_u32 m0, s14, 131072
    v_mfma_f32_16x16x32_bf16 v[16:19], a[116:119], a[56:59], v[16:19]
    ds_read_b64_tr_b16 a[98:99], v72 offset:20480
    buffer_load_dwordx4 v234, s[56:59], s60 offen offset:0  lds
    v_mfma_f32_16x16x32_bf16 v[48:51], a[112:115], a[52:55], v[48:51]
    ds_read_b64_tr_b16 a[100:101], v72 offset:24576
    v_mfma_f32_16x16x32_bf16 v[48:51], a[116:119], a[60:63], v[48:51]
    ds_read_b64_tr_b16 a[102:103], v72 offset:28672
    buffer_load_dwordx4 v235, s[56:59], s60 offen offset:1024  lds
    v_mfma_f32_16x16x32_bf16 v[20:23], a[120:123], a[48:51], v[20:23]
    ds_read_b64_tr_b16 a[104:105], v73 offset:16384
    v_mfma_f32_16x16x32_bf16 v[20:23], a[124:127], a[56:59], v[20:23]
    ds_read_b64_tr_b16 a[106:107], v73 offset:20480
    v_mfma_f32_16x16x32_bf16 v[52:55], a[120:123], a[52:55], v[52:55]
    ds_read_b64_tr_b16 a[108:109], v73 offset:24576
    v_mfma_f32_16x16x32_bf16 v[52:55], a[124:127], a[60:63], v[52:55]
    ds_read_b64_tr_b16 a[110:111], v73 offset:28672
    s_waitcnt lgkmcnt(8)
    v_mfma_f32_16x16x32_bf16 v[24:27], a[80:83], a[48:51], v[24:27]
    ds_read_b64_tr_b16 a[112:113], v74 offset:16384
    v_mfma_f32_16x16x32_bf16 v[24:27], a[84:87], a[56:59], v[24:27]
    ds_read_b64_tr_b16 a[114:115], v74 offset:20480
    v_mfma_f32_16x16x32_bf16 v[56:59], a[80:83], a[52:55], v[56:59]
    ds_read_b64_tr_b16 a[116:117], v74 offset:24576
    v_mfma_f32_16x16x32_bf16 v[56:59], a[84:87], a[60:63], v[56:59]
    ds_read_b64_tr_b16 a[118:119], v74 offset:28672
    v_mfma_f32_16x16x32_bf16 v[28:31], a[88:91], a[48:51], v[28:31]
    ds_read_b64_tr_b16 a[120:121], v75 offset:16384
    v_mfma_f32_16x16x32_bf16 v[28:31], a[92:95], a[56:59], v[28:31]
    ds_read_b64_tr_b16 a[122:123], v75 offset:20480
    v_mfma_f32_16x16x32_bf16 v[60:63], a[88:91], a[52:55], v[60:63]
    ds_read_b64_tr_b16 a[124:125], v75 offset:24576
    v_mfma_f32_16x16x32_bf16 v[60:63], a[92:95], a[60:63], v[60:63]
    ds_read_b64_tr_b16 a[126:127], v75 offset:28672
    s_waitcnt vmcnt(23) lgkmcnt(8)
    v_mfma_f32_16x16x32_bf16 v[0:3], a[96:99], a[64:67], v[0:3]
    ds_read_b64_tr_b16 a[80:81], v76 offset:16384
    s_lshl1_add_u32 s8, s19, 393216
    v_mfma_f32_16x16x32_bf16 v[0:3], a[100:103], a[72:75], v[0:3]
    ds_read_b64_tr_b16 a[82:83], v76 offset:20480
    buffer_load_dwordx4 a[40:43], v67, s[48:51], s8 offen offset:0 sc1
    v_mfma_f32_16x16x32_bf16 v[32:35], a[96:99], a[68:71], v[32:35]
    ds_read_b64_tr_b16 a[84:85], v76 offset:24576
    v_mfma_f32_16x16x32_bf16 v[32:35], a[100:103], a[76:79], v[32:35]
    ds_read_b64_tr_b16 a[86:87], v76 offset:28672
    buffer_load_dwordx4 a[44:47], v67, s[48:51], s8 offen offset:1024 sc1
    v_mfma_f32_16x16x32_bf16 v[4:7], a[104:107], a[64:67], v[4:7]
    ds_read_b64_tr_b16 a[88:89], v77 offset:16384
    s_lshl1_add_u32 s8, s19, 524288
    v_mfma_f32_16x16x32_bf16 v[4:7], a[108:111], a[72:75], v[4:7]
    ds_read_b64_tr_b16 a[90:91], v77 offset:20480
    buffer_load_dwordx4 a[48:51], v67, s[48:51], s8 offen offset:0 sc1
    v_mfma_f32_16x16x32_bf16 v[36:39], a[104:107], a[68:71], v[36:39]
    ds_read_b64_tr_b16 a[92:93], v77 offset:24576
    v_mfma_f32_16x16x32_bf16 v[36:39], a[108:111], a[76:79], v[36:39]
    ds_read_b64_tr_b16 a[94:95], v77 offset:28672
    s_waitcnt lgkmcnt(8)
    v_mfma_f32_16x16x32_bf16 v[8:11], a[112:115], a[64:67], v[8:11]
    ds_read_b64_tr_b16 a[96:97], v78 offset:16384
    buffer_load_dwordx4 a[52:55], v67, s[48:51], s8 offen offset:1024 sc1
    s_branch L_fused_kernel_pc13
L_fused_kernel_isl0_13:
    s_branch L_fused_kernel_warmback0
L_fused_kernel_pc13:
    v_mfma_f32_16x16x32_bf16 v[8:11], a[116:119], a[72:75], v[8:11]
    ds_read_b64_tr_b16 a[98:99], v78 offset:20480
    s_add_u32 s60, s20, 0
    v_mfma_f32_16x16x32_bf16 v[40:43], a[112:115], a[68:71], v[40:43]
    ds_read_b64_tr_b16 a[100:101], v78 offset:24576
    s_add_u32 m0, s14, 139264
    v_mfma_f32_16x16x32_bf16 v[40:43], a[116:119], a[76:79], v[40:43]
    ds_read_b64_tr_b16 a[102:103], v78 offset:28672
    buffer_load_dwordx4 v234, s[56:59], s60 offen offset:0  lds
    v_mfma_f32_16x16x32_bf16 v[12:15], a[120:123], a[64:67], v[12:15]
    ds_read_b64_tr_b16 a[104:105], v79 offset:16384
    v_mfma_f32_16x16x32_bf16 v[12:15], a[124:127], a[72:75], v[12:15]
    ds_read_b64_tr_b16 a[106:107], v79 offset:20480
    buffer_load_dwordx4 v235, s[56:59], s60 offen offset:1024  lds
    v_mfma_f32_16x16x32_bf16 v[44:47], a[120:123], a[68:71], v[44:47]
    ds_read_b64_tr_b16 a[108:109], v79 offset:24576
    s_add_u32 s60, s20, 65536
    v_mfma_f32_16x16x32_bf16 v[44:47], a[124:127], a[76:79], v[44:47]
    ds_read_b64_tr_b16 a[110:111], v79 offset:28672
    s_waitcnt lgkmcnt(8)
    s_barrier
    v_mfma_f32_16x16x32_bf16 v[16:19], a[80:83], a[64:67], v[16:19]
    ds_read_b64_tr_b16 a[112:113], v72 offset:32768
    s_add_u32 m0, s14, 147456
    v_mfma_f32_16x16x32_bf16 v[16:19], a[84:87], a[72:75], v[16:19]
    ds_read_b64_tr_b16 a[114:115], v72 offset:36864
    buffer_load_dwordx4 v234, s[56:59], s60 offen offset:0  lds
    v_mfma_f32_16x16x32_bf16 v[48:51], a[80:83], a[68:71], v[48:51]
    ds_read_b64_tr_b16 a[116:117], v72 offset:40960
    v_mfma_f32_16x16x32_bf16 v[48:51], a[84:87], a[76:79], v[48:51]
    ds_read_b64_tr_b16 a[118:119], v72 offset:45056
    buffer_load_dwordx4 v235, s[56:59], s60 offen offset:1024  lds
    v_mfma_f32_16x16x32_bf16 v[20:23], a[88:91], a[64:67], v[20:23]
    ds_read_b64_tr_b16 a[120:121], v73 offset:32768
    v_mfma_f32_16x16x32_bf16 v[20:23], a[92:95], a[72:75], v[20:23]
    ds_read_b64_tr_b16 a[122:123], v73 offset:36864
    v_mfma_f32_16x16x32_bf16 v[52:55], a[88:91], a[68:71], v[52:55]
    ds_read_b64_tr_b16 a[124:125], v73 offset:40960
    v_mfma_f32_16x16x32_bf16 v[52:55], a[92:95], a[76:79], v[52:55]
    ds_read_b64_tr_b16 a[126:127], v73 offset:45056
    s_waitcnt lgkmcnt(8)
    v_mfma_f32_16x16x32_bf16 v[24:27], a[96:99], a[64:67], v[24:27]
    ds_read_b64_tr_b16 a[80:81], v74 offset:32768
    v_mfma_f32_16x16x32_bf16 v[24:27], a[100:103], a[72:75], v[24:27]
    ds_read_b64_tr_b16 a[82:83], v74 offset:36864
    v_mfma_f32_16x16x32_bf16 v[56:59], a[96:99], a[68:71], v[56:59]
    ds_read_b64_tr_b16 a[84:85], v74 offset:40960
    v_mfma_f32_16x16x32_bf16 v[56:59], a[100:103], a[76:79], v[56:59]
    ds_read_b64_tr_b16 a[86:87], v74 offset:45056
    v_mfma_f32_16x16x32_bf16 v[28:31], a[104:107], a[64:67], v[28:31]
    ds_read_b64_tr_b16 a[88:89], v75 offset:32768
    v_mfma_f32_16x16x32_bf16 v[28:31], a[108:111], a[72:75], v[28:31]
    ds_read_b64_tr_b16 a[90:91], v75 offset:36864
    v_mfma_f32_16x16x32_bf16 v[60:63], a[104:107], a[68:71], v[60:63]
    ds_read_b64_tr_b16 a[92:93], v75 offset:40960
    v_mfma_f32_16x16x32_bf16 v[60:63], a[108:111], a[76:79], v[60:63]
    ds_read_b64_tr_b16 a[94:95], v75 offset:45056
    s_waitcnt vmcnt(23) lgkmcnt(8)
    v_mfma_f32_16x16x32_bf16 v[0:3], a[112:115], a[0:3], v[0:3]
    ds_read_b64_tr_b16 a[96:97], v76 offset:32768
    s_lshl1_add_u32 s8, s19, 655360
    v_mfma_f32_16x16x32_bf16 v[0:3], a[116:119], a[8:11], v[0:3]
    ds_read_b64_tr_b16 a[98:99], v76 offset:36864
    buffer_load_dwordx4 a[56:59], v67, s[48:51], s8 offen offset:0 sc1
    v_mfma_f32_16x16x32_bf16 v[32:35], a[112:115], a[4:7], v[32:35]
    ds_read_b64_tr_b16 a[100:101], v76 offset:40960
    v_mfma_f32_16x16x32_bf16 v[32:35], a[116:119], a[12:15], v[32:35]
    ds_read_b64_tr_b16 a[102:103], v76 offset:45056
    buffer_load_dwordx4 a[60:63], v67, s[48:51], s8 offen offset:1024 sc1
    v_mfma_f32_16x16x32_bf16 v[4:7], a[120:123], a[0:3], v[4:7]
    ds_read_b64_tr_b16 a[104:105], v77 offset:32768
    s_lshl1_add_u32 s8, s19, 786432
    v_mfma_f32_16x16x32_bf16 v[4:7], a[124:127], a[8:11], v[4:7]
    ds_read_b64_tr_b16 a[106:107], v77 offset:36864
    buffer_load_dwordx4 a[64:67], v67, s[48:51], s8 offen offset:0 sc1
    v_mfma_f32_16x16x32_bf16 v[36:39], a[120:123], a[4:7], v[36:39]
    ds_read_b64_tr_b16 a[108:109], v77 offset:40960
    v_mfma_f32_16x16x32_bf16 v[36:39], a[124:127], a[12:15], v[36:39]
    ds_read_b64_tr_b16 a[110:111], v77 offset:45056
    s_waitcnt lgkmcnt(8)
    v_mfma_f32_16x16x32_bf16 v[8:11], a[80:83], a[0:3], v[8:11]
    ds_read_b64_tr_b16 a[112:113], v78 offset:32768
    buffer_load_dwordx4 a[68:71], v67, s[48:51], s8 offen offset:1024 sc1
    v_mfma_f32_16x16x32_bf16 v[8:11], a[84:87], a[8:11], v[8:11]
    ds_read_b64_tr_b16 a[114:115], v78 offset:36864
    s_add_u32 s60, s20, 131072
    v_mfma_f32_16x16x32_bf16 v[40:43], a[80:83], a[4:7], v[40:43]
    ds_read_b64_tr_b16 a[116:117], v78 offset:40960
    s_add_u32 m0, s14, 155648
    v_mfma_f32_16x16x32_bf16 v[40:43], a[84:87], a[12:15], v[40:43]
    ds_read_b64_tr_b16 a[118:119], v78 offset:45056
    buffer_load_dwordx4 v234, s[56:59], s60 offen offset:0  lds
    v_mfma_f32_16x16x32_bf16 v[12:15], a[88:91], a[0:3], v[12:15]
    ds_read_b64_tr_b16 a[120:121], v79 offset:32768
    v_mfma_f32_16x16x32_bf16 v[12:15], a[92:95], a[8:11], v[12:15]
    ds_read_b64_tr_b16 a[122:123], v79 offset:36864
    buffer_load_dwordx4 v235, s[56:59], s60 offen offset:1024  lds
    v_mfma_f32_16x16x32_bf16 v[44:47], a[88:91], a[4:7], v[44:47]
    ds_read_b64_tr_b16 a[124:125], v79 offset:40960
    s_add_u32 s60, s20, 229376
    v_mfma_f32_16x16x32_bf16 v[44:47], a[92:95], a[12:15], v[44:47]
    ds_read_b64_tr_b16 a[126:127], v79 offset:45056
    s_waitcnt lgkmcnt(8)
    s_barrier
    v_mfma_f32_16x16x32_bf16 v[16:19], a[96:99], a[0:3], v[16:19]
    ds_read_b64_tr_b16 a[80:81], v72 offset:49152
    s_add_u32 m0, s14, 0
    v_mfma_f32_16x16x32_bf16 v[16:19], a[100:103], a[8:11], v[16:19]
    ds_read_b64_tr_b16 a[82:83], v72 offset:53248
    buffer_load_dwordx4 v234, s[56:59], s60 offen offset:0  lds
    v_mfma_f32_16x16x32_bf16 v[48:51], a[96:99], a[4:7], v[48:51]
    ds_read_b64_tr_b16 a[84:85], v72 offset:57344
    v_mfma_f32_16x16x32_bf16 v[48:51], a[100:103], a[12:15], v[48:51]
    ds_read_b64_tr_b16 a[86:87], v72 offset:61440
    buffer_load_dwordx4 v235, s[56:59], s60 offen offset:1024  lds
    v_mfma_f32_16x16x32_bf16 v[20:23], a[104:107], a[0:3], v[20:23]
    ds_read_b64_tr_b16 a[88:89], v73 offset:49152
    v_mfma_f32_16x16x32_bf16 v[20:23], a[108:111], a[8:11], v[20:23]
    ds_read_b64_tr_b16 a[90:91], v73 offset:53248
    v_mfma_f32_16x16x32_bf16 v[52:55], a[104:107], a[4:7], v[52:55]
    ds_read_b64_tr_b16 a[92:93], v73 offset:57344
    v_mfma_f32_16x16x32_bf16 v[52:55], a[108:111], a[12:15], v[52:55]
    ds_read_b64_tr_b16 a[94:95], v73 offset:61440
    s_waitcnt lgkmcnt(8)
    v_mfma_f32_16x16x32_bf16 v[24:27], a[112:115], a[0:3], v[24:27]
    ds_read_b64_tr_b16 a[96:97], v74 offset:49152
    v_mfma_f32_16x16x32_bf16 v[24:27], a[116:119], a[8:11], v[24:27]
    ds_read_b64_tr_b16 a[98:99], v74 offset:53248
    v_mfma_f32_16x16x32_bf16 v[56:59], a[112:115], a[4:7], v[56:59]
    ds_read_b64_tr_b16 a[100:101], v74 offset:57344
    v_mfma_f32_16x16x32_bf16 v[56:59], a[116:119], a[12:15], v[56:59]
    ds_read_b64_tr_b16 a[102:103], v74 offset:61440
    v_mfma_f32_16x16x32_bf16 v[28:31], a[120:123], a[0:3], v[28:31]
    ds_read_b64_tr_b16 a[104:105], v75 offset:49152
    v_mfma_f32_16x16x32_bf16 v[28:31], a[124:127], a[8:11], v[28:31]
    ds_read_b64_tr_b16 a[106:107], v75 offset:53248
    v_mfma_f32_16x16x32_bf16 v[60:63], a[120:123], a[4:7], v[60:63]
    ds_read_b64_tr_b16 a[108:109], v75 offset:57344
    v_mfma_f32_16x16x32_bf16 v[60:63], a[124:127], a[12:15], v[60:63]
    ds_read_b64_tr_b16 a[110:111], v75 offset:61440
    s_waitcnt vmcnt(22) lgkmcnt(8)
    v_mfma_f32_16x16x32_bf16 v[0:3], a[80:83], a[16:19], v[0:3]
    ds_read_b64_tr_b16 a[112:113], v76 offset:49152
    v_mfma_f32_16x16x32_bf16 v[0:3], a[84:87], a[24:27], v[0:3]
    ds_read_b64_tr_b16 a[114:115], v76 offset:53248
    v_cmp_ne_u64 vcc, s[62:63], v[64:65]
    v_mfma_f32_16x16x32_bf16 v[32:35], a[80:83], a[20:23], v[32:35]
    ds_read_b64_tr_b16 a[116:117], v76 offset:57344
    s_nop 4
    v_mfma_f32_16x16x32_bf16 v[32:35], a[84:87], a[28:31], v[32:35]
    ds_read_b64_tr_b16 a[118:119], v76 offset:61440
    s_and_b32 s3, vcc_lo, 0xc000
    v_mfma_f32_16x16x32_bf16 v[4:7], a[88:91], a[16:19], v[4:7]
    ds_read_b64_tr_b16 a[120:121], v77 offset:49152
    s_cbranch_scc1 L_fused_kernel_fs_44
L_fused_kernel_fb_45:
    v_mfma_f32_16x16x32_bf16 v[4:7], a[92:95], a[24:27], v[4:7]
    ds_read_b64_tr_b16 a[122:123], v77 offset:53248
    s_lshl1_add_u32 s8, s20, 0
    v_mfma_f32_16x16x32_bf16 v[36:39], a[88:91], a[20:23], v[36:39]
    ds_read_b64_tr_b16 a[124:125], v77 offset:57344
    buffer_load_dwordx4 a[72:75], v67, s[48:51], s8 offen offset:0 sc1
    v_mfma_f32_16x16x32_bf16 v[36:39], a[92:95], a[28:31], v[36:39]
    ds_read_b64_tr_b16 a[126:127], v77 offset:61440
    s_waitcnt lgkmcnt(8)
    v_mfma_f32_16x16x32_bf16 v[8:11], a[96:99], a[16:19], v[8:11]
    ds_read_b64_tr_b16 a[80:81], v78 offset:49152
    buffer_load_dwordx4 a[76:79], v67, s[48:51], s8 offen offset:1024 sc1
    v_mfma_f32_16x16x32_bf16 v[8:11], a[100:103], a[24:27], v[8:11]
    ds_read_b64_tr_b16 a[82:83], v78 offset:53248
    s_lshl1_add_u32 s8, s20, 131072
    v_mfma_f32_16x16x32_bf16 v[40:43], a[96:99], a[20:23], v[40:43]
    ds_read_b64_tr_b16 a[84:85], v78 offset:57344
    buffer_load_dwordx4 a[0:3], v67, s[48:51], s8 offen offset:0 sc1
    v_mfma_f32_16x16x32_bf16 v[40:43], a[100:103], a[28:31], v[40:43]
    ds_read_b64_tr_b16 a[86:87], v78 offset:61440
    v_mfma_f32_16x16x32_bf16 v[12:15], a[104:107], a[16:19], v[12:15]
    ds_read_b64_tr_b16 a[88:89], v79 offset:49152
    buffer_load_dwordx4 a[4:7], v67, s[48:51], s8 offen offset:1024 sc1
    v_mfma_f32_16x16x32_bf16 v[12:15], a[108:111], a[24:27], v[12:15]
    ds_read_b64_tr_b16 a[90:91], v79 offset:53248
    s_add_u32 s60, s20, 294912
    v_mfma_f32_16x16x32_bf16 v[44:47], a[104:107], a[20:23], v[44:47]
    ds_read_b64_tr_b16 a[92:93], v79 offset:57344
    s_add_u32 m0, s14, 8192
    v_mfma_f32_16x16x32_bf16 v[44:47], a[108:111], a[28:31], v[44:47]
    ds_read_b64_tr_b16 a[94:95], v79 offset:61440
    s_waitcnt lgkmcnt(8)
    s_barrier
    v_mfma_f32_16x16x32_bf16 v[16:19], a[112:115], a[16:19], v[16:19]
    ds_read_b64_tr_b16 a[96:97], v80 offset:0
    buffer_load_dwordx4 v234, s[56:59], s60 offen offset:0  lds
    v_mfma_f32_16x16x32_bf16 v[16:19], a[116:119], a[24:27], v[16:19]
    ds_read_b64_tr_b16 a[98:99], v80 offset:4096
    v_mfma_f32_16x16x32_bf16 v[48:51], a[112:115], a[20:23], v[48:51]
    ds_read_b64_tr_b16 a[100:101], v80 offset:8192
    buffer_load_dwordx4 v235, s[56:59], s60 offen offset:1024  lds
    v_mfma_f32_16x16x32_bf16 v[48:51], a[116:119], a[28:31], v[48:51]
    ds_read_b64_tr_b16 a[102:103], v80 offset:12288
    s_add_u32 s60, s20, 360448
    v_mfma_f32_16x16x32_bf16 v[20:23], a[120:123], a[16:19], v[20:23]
    ds_read_b64_tr_b16 a[104:105], v81 offset:0
    s_add_u32 m0, s14, 16384
    v_mfma_f32_16x16x32_bf16 v[20:23], a[124:127], a[24:27], v[20:23]
    ds_read_b64_tr_b16 a[106:107], v81 offset:4096
    buffer_load_dwordx4 v234, s[56:59], s60 offen offset:0  lds
    v_mfma_f32_16x16x32_bf16 v[52:55], a[120:123], a[20:23], v[52:55]
    ds_read_b64_tr_b16 a[108:109], v81 offset:8192
    v_mfma_f32_16x16x32_bf16 v[52:55], a[124:127], a[28:31], v[52:55]
    ds_read_b64_tr_b16 a[110:111], v81 offset:12288
    s_waitcnt lgkmcnt(8)
    v_mfma_f32_16x16x32_bf16 v[24:27], a[80:83], a[16:19], v[24:27]
    ds_read_b64_tr_b16 a[112:113], v82 offset:0
    buffer_load_dwordx4 v235, s[56:59], s60 offen offset:1024  lds
    v_mfma_f32_16x16x32_bf16 v[24:27], a[84:87], a[24:27], v[24:27]
    ds_read_b64_tr_b16 a[114:115], v82 offset:4096
    v_mfma_f32_16x16x32_bf16 v[56:59], a[80:83], a[20:23], v[56:59]
    ds_read_b64_tr_b16 a[116:117], v82 offset:8192
    v_mfma_f32_16x16x32_bf16 v[56:59], a[84:87], a[28:31], v[56:59]
    ds_read_b64_tr_b16 a[118:119], v82 offset:12288
    v_mfma_f32_16x16x32_bf16 v[28:31], a[88:91], a[16:19], v[28:31]
    ds_read_b64_tr_b16 a[120:121], v83 offset:0
    v_mfma_f32_16x16x32_bf16 v[28:31], a[92:95], a[24:27], v[28:31]
    ds_read_b64_tr_b16 a[122:123], v83 offset:4096
    v_mfma_f32_16x16x32_bf16 v[60:63], a[88:91], a[20:23], v[60:63]
    ds_read_b64_tr_b16 a[124:125], v83 offset:8192
    v_mfma_f32_16x16x32_bf16 v[60:63], a[92:95], a[28:31], v[60:63]
    ds_read_b64_tr_b16 a[126:127], v83 offset:12288
    s_waitcnt vmcnt(22) lgkmcnt(8)
    v_mfma_f32_16x16x32_bf16 v[0:3], a[96:99], a[32:35], v[0:3]
    ds_read_b64_tr_b16 a[80:81], v84 offset:0
    s_lshl1_add_u32 s8, s20, 262144
    v_mfma_f32_16x16x32_bf16 v[0:3], a[100:103], a[40:43], v[0:3]
    ds_read_b64_tr_b16 a[82:83], v84 offset:4096
    buffer_load_dwordx4 a[8:11], v67, s[48:51], s8 offen offset:0 sc1
    v_mfma_f32_16x16x32_bf16 v[32:35], a[96:99], a[36:39], v[32:35]
    ds_read_b64_tr_b16 a[84:85], v84 offset:8192
    v_mfma_f32_16x16x32_bf16 v[32:35], a[100:103], a[44:47], v[32:35]
    ds_read_b64_tr_b16 a[86:87], v84 offset:12288
    buffer_load_dwordx4 a[12:15], v67, s[48:51], s8 offen offset:1024 sc1
    v_mfma_f32_16x16x32_bf16 v[4:7], a[104:107], a[32:35], v[4:7]
    ds_read_b64_tr_b16 a[88:89], v85 offset:0
    s_lshl1_add_u32 s8, s20, 393216
    v_mfma_f32_16x16x32_bf16 v[4:7], a[108:111], a[40:43], v[4:7]
    ds_read_b64_tr_b16 a[90:91], v85 offset:4096
    buffer_load_dwordx4 a[16:19], v67, s[48:51], s8 offen offset:0 sc1
    v_mfma_f32_16x16x32_bf16 v[36:39], a[104:107], a[36:39], v[36:39]
    ds_read_b64_tr_b16 a[92:93], v85 offset:8192
    v_mfma_f32_16x16x32_bf16 v[36:39], a[108:111], a[44:47], v[36:39]
    ds_read_b64_tr_b16 a[94:95], v85 offset:12288
    s_waitcnt lgkmcnt(8)
    v_mfma_f32_16x16x32_bf16 v[8:11], a[112:115], a[32:35], v[8:11]
    ds_read_b64_tr_b16 a[96:97], v86 offset:0
    buffer_load_dwordx4 a[20:23], v67, s[48:51], s8 offen offset:1024 sc1
    v_mfma_f32_16x16x32_bf16 v[8:11], a[116:119], a[40:43], v[8:11]
    ds_read_b64_tr_b16 a[98:99], v86 offset:4096
    s_add_u32 s60, s17, s20
    v_mfma_f32_16x16x32_bf16 v[40:43], a[112:115], a[36:39], v[40:43]
    ds_read_b64_tr_b16 a[100:101], v86 offset:8192
    s_add_u32 m0, s14, 24576
    v_mfma_f32_16x16x32_bf16 v[40:43], a[116:119], a[44:47], v[40:43]
    ds_read_b64_tr_b16 a[102:103], v86 offset:12288
    buffer_load_dwordx4 v234, s[56:59], s60 offen offset:0  lds
    v_mfma_f32_16x16x32_bf16 v[12:15], a[120:123], a[32:35], v[12:15]
    ds_read_b64_tr_b16 a[104:105], v87 offset:0
    v_mfma_f32_16x16x32_bf16 v[12:15], a[124:127], a[40:43], v[12:15]
    ds_read_b64_tr_b16 a[106:107], v87 offset:4096
    buffer_load_dwordx4 v235, s[56:59], s60 offen offset:1024  lds
    v_mfma_f32_16x16x32_bf16 v[44:47], a[120:123], a[36:39], v[44:47]
    ds_read_b64_tr_b16 a[108:109], v87 offset:8192
    v_mfma_f32_16x16x32_bf16 v[44:47], a[124:127], a[44:47], v[44:47]
    ds_read_b64_tr_b16 a[110:111], v87 offset:12288
    s_waitcnt lgkmcnt(8)
    s_barrier
    v_mfma_f32_16x16x32_bf16 v[16:19], a[80:83], a[32:35], v[16:19]
    ds_read_b64_tr_b16 a[112:113], v80 offset:16384
    v_mfma_f32_16x16x32_bf16 v[16:19], a[84:87], a[40:43], v[16:19]
    ds_read_b64_tr_b16 a[114:115], v80 offset:20480
    v_mfma_f32_16x16x32_bf16 v[48:51], a[80:83], a[36:39], v[48:51]
    ds_read_b64_tr_b16 a[116:117], v80 offset:24576
    v_mfma_f32_16x16x32_bf16 v[48:51], a[84:87], a[44:47], v[48:51]
    ds_read_b64_tr_b16 a[118:119], v80 offset:28672
    v_mfma_f32_16x16x32_bf16 v[20:23], a[88:91], a[32:35], v[20:23]
    ds_read_b64_tr_b16 a[120:121], v81 offset:16384
    v_mfma_f32_16x16x32_bf16 v[20:23], a[92:95], a[40:43], v[20:23]
    ds_read_b64_tr_b16 a[122:123], v81 offset:20480
    v_mfma_f32_16x16x32_bf16 v[52:55], a[88:91], a[36:39], v[52:55]
    ds_read_b64_tr_b16 a[124:125], v81 offset:24576
    v_mfma_f32_16x16x32_bf16 v[52:55], a[92:95], a[44:47], v[52:55]
    ds_read_b64_tr_b16 a[126:127], v81 offset:28672
    s_waitcnt lgkmcnt(8)
    v_mfma_f32_16x16x32_bf16 v[24:27], a[96:99], a[32:35], v[24:27]
    ds_read_b64_tr_b16 a[80:81], v82 offset:16384
    v_mfma_f32_16x16x32_bf16 v[24:27], a[100:103], a[40:43], v[24:27]
    ds_read_b64_tr_b16 a[82:83], v82 offset:20480
    v_mfma_f32_16x16x32_bf16 v[56:59], a[96:99], a[36:39], v[56:59]
    ds_read_b64_tr_b16 a[84:85], v82 offset:24576
    v_mfma_f32_16x16x32_bf16 v[56:59], a[100:103], a[44:47], v[56:59]
    ds_read_b64_tr_b16 a[86:87], v82 offset:28672
    v_mfma_f32_16x16x32_bf16 v[28:31], a[104:107], a[32:35], v[28:31]
    ds_read_b64_tr_b16 a[88:89], v83 offset:16384
    v_mfma_f32_16x16x32_bf16 v[28:31], a[108:111], a[40:43], v[28:31]
    ds_read_b64_tr_b16 a[90:91], v83 offset:20480
    v_mfma_f32_16x16x32_bf16 v[60:63], a[104:107], a[36:39], v[60:63]
    ds_read_b64_tr_b16 a[92:93], v83 offset:24576
    v_mfma_f32_16x16x32_bf16 v[60:63], a[108:111], a[44:47], v[60:63]
    ds_read_b64_tr_b16 a[94:95], v83 offset:28672
    s_waitcnt vmcnt(20) lgkmcnt(8)
    v_mfma_f32_16x16x32_bf16 v[0:3], a[112:115], a[48:51], v[0:3]
    ds_read_b64_tr_b16 a[96:97], v84 offset:16384
    s_lshl1_add_u32 s8, s20, 524288
    v_mfma_f32_16x16x32_bf16 v[0:3], a[116:119], a[56:59], v[0:3]
    ds_read_b64_tr_b16 a[98:99], v84 offset:20480
    buffer_load_dwordx4 a[24:27], v67, s[48:51], s8 offen offset:0 sc1
    v_mfma_f32_16x16x32_bf16 v[32:35], a[112:115], a[52:55], v[32:35]
    ds_read_b64_tr_b16 a[100:101], v84 offset:24576
    v_mfma_f32_16x16x32_bf16 v[32:35], a[116:119], a[60:63], v[32:35]
    ds_read_b64_tr_b16 a[102:103], v84 offset:28672
    buffer_load_dwordx4 a[28:31], v67, s[48:51], s8 offen offset:1024 sc1
    v_mfma_f32_16x16x32_bf16 v[4:7], a[120:123], a[48:51], v[4:7]
    ds_read_b64_tr_b16 a[104:105], v85 offset:16384
    s_lshl1_add_u32 s8, s20, 655360
    v_mfma_f32_16x16x32_bf16 v[4:7], a[124:127], a[56:59], v[4:7]
    ds_read_b64_tr_b16 a[106:107], v85 offset:20480
    buffer_load_dwordx4 a[32:35], v67, s[48:51], s8 offen offset:0 sc1
    v_mfma_f32_16x16x32_bf16 v[36:39], a[120:123], a[52:55], v[36:39]
    ds_read_b64_tr_b16 a[108:109], v85 offset:24576
    v_mfma_f32_16x16x32_bf16 v[36:39], a[124:127], a[60:63], v[36:39]
    ds_read_b64_tr_b16 a[110:111], v85 offset:28672
    s_waitcnt lgkmcnt(8)
    v_mfma_f32_16x16x32_bf16 v[8:11], a[80:83], a[48:51], v[8:11]
    ds_read_b64_tr_b16 a[112:113], v86 offset:16384
    buffer_load_dwordx4 a[36:39], v67, s[48:51], s8 offen offset:1024 sc1
    v_mfma_f32_16x16x32_bf16 v[8:11], a[84:87], a[56:59], v[8:11]
    ds_read_b64_tr_b16 a[114:115], v86 offset:20480
    v_mfma_f32_16x16x32_bf16 v[40:43], a[80:83], a[52:55], v[40:43]
    ds_read_b64_tr_b16 a[116:117], v86 offset:24576
    v_mfma_f32_16x16x32_bf16 v[40:43], a[84:87], a[60:63], v[40:43]
    ds_read_b64_tr_b16 a[118:119], v86 offset:28672
    v_mfma_f32_16x16x32_bf16 v[12:15], a[88:91], a[48:51], v[12:15]
    ds_read_b64_tr_b16 a[120:121], v87 offset:16384
    v_mfma_f32_16x16x32_bf16 v[12:15], a[92:95], a[56:59], v[12:15]
    ds_read_b64_tr_b16 a[122:123], v87 offset:20480
    v_mfma_f32_16x16x32_bf16 v[44:47], a[88:91], a[52:55], v[44:47]
    ds_read_b64_tr_b16 a[124:125], v87 offset:24576
    v_mfma_f32_16x16x32_bf16 v[44:47], a[92:95], a[60:63], v[44:47]
    ds_read_b64_tr_b16 a[126:127], v87 offset:28672
    s_waitcnt lgkmcnt(8)
    s_barrier
    v_mfma_f32_16x16x32_bf16 v[16:19], a[96:99], a[48:51], v[16:19]
    ds_read_b64_tr_b16 a[80:81], v92 offset:0
    v_mfma_f32_16x16x32_bf16 v[16:19], a[100:103], a[56:59], v[16:19]
    ds_read_b64_tr_b16 a[82:83], v92 offset:4096
    v_mfma_f32_16x16x32_bf16 v[48:51], a[96:99], a[52:55], v[48:51]
    ds_read_b64_tr_b16 a[84:85], v92 offset:8192
    v_mfma_f32_16x16x32_bf16 v[48:51], a[100:103], a[60:63], v[48:51]
    ds_read_b64_tr_b16 a[86:87], v92 offset:12288
    v_mfma_f32_16x16x32_bf16 v[20:23], a[104:107], a[48:51], v[20:23]
    ds_read_b64_tr_b16 a[88:89], v93 offset:0
    v_mfma_f32_16x16x32_bf16 v[20:23], a[108:111], a[56:59], v[20:23]
    ds_read_b64_tr_b16 a[90:91], v93 offset:4096
    v_mfma_f32_16x16x32_bf16 v[52:55], a[104:107], a[52:55], v[52:55]
    ds_read_b64_tr_b16 a[92:93], v93 offset:8192
    v_mfma_f32_16x16x32_bf16 v[52:55], a[108:111], a[60:63], v[52:55]
    ds_read_b64_tr_b16 a[94:95], v93 offset:12288
    s_waitcnt vmcnt(20) lgkmcnt(8)
    s_barrier
    v_mfma_f32_16x16x32_bf16 v[24:27], a[112:115], a[48:51], v[24:27]
    ds_read_b64_tr_b16 a[96:97], v92 offset:16384
    v_mfma_f32_16x16x32_bf16 v[24:27], a[116:119], a[56:59], v[24:27]
    ds_read_b64_tr_b16 a[98:99], v92 offset:20480
    v_mfma_f32_16x16x32_bf16 v[56:59], a[112:115], a[52:55], v[56:59]
    ds_read_b64_tr_b16 a[100:101], v92 offset:24576
    v_mfma_f32_16x16x32_bf16 v[56:59], a[116:119], a[60:63], v[56:59]
    ds_read_b64_tr_b16 a[102:103], v92 offset:28672
    v_mfma_f32_16x16x32_bf16 v[28:31], a[120:123], a[48:51], v[28:31]
    ds_read_b64_tr_b16 a[104:105], v93 offset:16384
    v_mfma_f32_16x16x32_bf16 v[28:31], a[124:127], a[56:59], v[28:31]
    ds_read_b64_tr_b16 a[106:107], v93 offset:20480
    v_mfma_f32_16x16x32_bf16 v[60:63], a[120:123], a[52:55], v[60:63]
    ds_read_b64_tr_b16 a[108:109], v93 offset:24576
    v_mfma_f32_16x16x32_bf16 v[60:63], a[124:127], a[60:63], v[60:63]
    ds_read_b64_tr_b16 a[110:111], v93 offset:28672
    s_waitcnt vmcnt(12) lgkmcnt(8)
    s_barrier
    v_mfma_f32_16x16x32_bf16 v[16:19], a[80:83], a[64:67], v[16:19]
    ds_read_b64_tr_b16 a[112:113], v76 offset:0
    s_lshl1_add_u32 s8, s20, 786432
    v_mfma_f32_16x16x32_bf16 v[16:19], a[84:87], a[72:75], v[16:19]
    ds_read_b64_tr_b16 a[114:115], v76 offset:4096
    buffer_load_dwordx4 a[40:43], v67, s[48:51], s8 offen offset:0 sc1
    v_mfma_f32_16x16x32_bf16 v[48:51], a[80:83], a[68:71], v[48:51]
    ds_read_b64_tr_b16 a[116:117], v76 offset:8192
    v_mfma_f32_16x16x32_bf16 v[48:51], a[84:87], a[76:79], v[48:51]
    ds_read_b64_tr_b16 a[118:119], v76 offset:12288
    buffer_load_dwordx4 a[44:47], v67, s[48:51], s8 offen offset:1024 sc1
    v_mfma_f32_16x16x32_bf16 v[20:23], a[88:91], a[64:67], v[20:23]
    ds_read_b64_tr_b16 a[120:121], v77 offset:0
    s_mov_b32 s9, 0
    v_mfma_f32_16x16x32_bf16 v[20:23], a[92:95], a[72:75], v[20:23]
    ds_read_b64_tr_b16 a[122:123], v77 offset:4096
    buffer_load_dwordx4 v[104:107], v71, s[52:55], s9 offen offset:0 sc1
    v_mfma_f32_16x16x32_bf16 v[52:55], a[88:91], a[68:71], v[52:55]
    ds_read_b64_tr_b16 a[124:125], v77 offset:8192
    v_mfma_f32_16x16x32_bf16 v[52:55], a[92:95], a[76:79], v[52:55]
    ds_read_b64_tr_b16 a[126:127], v77 offset:12288
    s_waitcnt vmcnt(7) lgkmcnt(8)
    s_barrier
    v_mfma_f32_16x16x32_bf16 v[16:19], a[96:99], a[0:3], v[16:19]
    ds_read_b64_tr_b16 a[80:81], v76 offset:16384
    buffer_load_dwordx4 v[108:111], v71, s[52:55], s9 offen offset:64 sc1
    v_mfma_f32_16x16x32_bf16 v[16:19], a[100:103], a[8:11], v[16:19]
    ds_read_b64_tr_b16 a[82:83], v76 offset:20480
    s_mov_b32 s9, 32768
    v_mfma_f32_16x16x32_bf16 v[48:51], a[96:99], a[4:7], v[48:51]
    ds_read_b64_tr_b16 a[84:85], v76 offset:24576
    buffer_load_dwordx4 v[112:115], v71, s[52:55], s9 offen offset:0 sc1
    v_mfma_f32_16x16x32_bf16 v[48:51], a[100:103], a[12:15], v[48:51]
    ds_read_b64_tr_b16 a[86:87], v76 offset:28672
    v_mfma_f32_16x16x32_bf16 v[20:23], a[104:107], a[0:3], v[20:23]
    ds_read_b64_tr_b16 a[88:89], v77 offset:16384
    buffer_load_dwordx4 v[116:119], v71, s[52:55], s9 offen offset:64 sc1
    v_mfma_f32_16x16x32_bf16 v[20:23], a[108:111], a[8:11], v[20:23]
    ds_read_b64_tr_b16 a[90:91], v77 offset:20480
    v_mfma_f32_16x16x32_bf16 v[52:55], a[104:107], a[4:7], v[52:55]
    ds_read_b64_tr_b16 a[92:93], v77 offset:24576
    v_mfma_f32_16x16x32_bf16 v[52:55], a[108:111], a[12:15], v[52:55]
    ds_read_b64_tr_b16 a[94:95], v77 offset:28672
    s_waitcnt vmcnt(8) lgkmcnt(8)
    v_mfma_f32_16x16x32_bf16 v[16:19], a[112:115], a[16:19], v[16:19]
    ds_read_b64_tr_b16 a[96:97], v94 offset:0
    v_mfma_f32_16x16x32_bf16 v[16:19], a[116:119], a[24:27], v[16:19]
    ds_read_b64_tr_b16 a[98:99], v94 offset:4096
    v_mfma_f32_16x16x32_bf16 v[48:51], a[112:115], a[20:23], v[48:51]
    ds_read_b64_tr_b16 a[100:101], v94 offset:8192
    v_mfma_f32_16x16x32_bf16 v[48:51], a[116:119], a[28:31], v[48:51]
    ds_read_b64_tr_b16 a[102:103], v94 offset:12288
    v_mfma_f32_16x16x32_bf16 v[20:23], a[120:123], a[16:19], v[20:23]
    ds_read_b64_tr_b16 a[104:105], v95 offset:0
    v_mfma_f32_16x16x32_bf16 v[20:23], a[124:127], a[24:27], v[20:23]
    ds_read_b64_tr_b16 a[106:107], v95 offset:4096
    v_mfma_f32_16x16x32_bf16 v[52:55], a[120:123], a[20:23], v[52:55]
    ds_read_b64_tr_b16 a[108:109], v95 offset:8192
    v_mfma_f32_16x16x32_bf16 v[52:55], a[124:127], a[28:31], v[52:55]
    ds_read_b64_tr_b16 a[110:111], v95 offset:12288
    s_waitcnt vmcnt(4) lgkmcnt(8)
    v_mfma_f32_16x16x32_bf16 v[16:19], a[80:83], a[32:35], v[16:19]
    ds_read_b64_tr_b16 a[112:113], v94 offset:16384
    v_mfma_f32_16x16x32_bf16 v[16:19], a[84:87], a[40:43], v[16:19]
    ds_read_b64_tr_b16 a[114:115], v94 offset:20480
    v_mfma_f32_16x16x32_bf16 v[48:51], a[80:83], a[36:39], v[48:51]
    ds_read_b64_tr_b16 a[116:117], v94 offset:24576
    v_mfma_f32_16x16x32_bf16 v[48:51], a[84:87], a[44:47], v[48:51]
    ds_read_b64_tr_b16 a[118:119], v94 offset:28672
    v_mfma_f32_16x16x32_bf16 v[20:23], a[88:91], a[32:35], v[20:23]
    ds_read_b64_tr_b16 a[120:121], v95 offset:16384
    v_mfma_f32_16x16x32_bf16 v[20:23], a[92:95], a[40:43], v[20:23]
    ds_read_b64_tr_b16 a[122:123], v95 offset:20480
    v_mfma_f32_16x16x32_bf16 v[52:55], a[88:91], a[36:39], v[52:55]
    ds_read_b64_tr_b16 a[124:125], v95 offset:24576
    v_mfma_f32_16x16x32_bf16 v[52:55], a[92:95], a[44:47], v[52:55]
    ds_read_b64_tr_b16 a[126:127], v95 offset:28672
    s_waitcnt lgkmcnt(8)
    v_mfma_f32_16x16x32_bf16 v[24:27], a[96:99], a[64:67], v[24:27]
    ds_read_b64_tr_b16 a[80:81], v78 offset:0
    v_mfma_f32_16x16x32_bf16 v[24:27], a[100:103], a[72:75], v[24:27]
    ds_read_b64_tr_b16 a[82:83], v78 offset:4096
    v_mfma_f32_16x16x32_bf16 v[56:59], a[96:99], a[68:71], v[56:59]
    ds_read_b64_tr_b16 a[84:85], v78 offset:8192
    v_mfma_f32_16x16x32_bf16 v[56:59], a[100:103], a[76:79], v[56:59]
    ds_read_b64_tr_b16 a[86:87], v78 offset:12288
    v_cvt_pk_bf16_f32 v152, v16, v17
    v_mfma_f32_16x16x32_bf16 v[28:31], a[104:107], a[64:67], v[28:31]
    ds_read_b64_tr_b16 a[88:89], v79 offset:0
    v_cvt_pk_bf16_f32 v153, v18, v19
    v_mfma_f32_16x16x32_bf16 v[28:31], a[108:111], a[72:75], v[28:31]
    ds_read_b64_tr_b16 a[90:91], v79 offset:4096
    v_cvt_pk_bf16_f32 v154, v20, v21
    v_mfma_f32_16x16x32_bf16 v[60:63], a[104:107], a[68:71], v[60:63]
    ds_read_b64_tr_b16 a[92:93], v79 offset:8192
    v_cvt_pk_bf16_f32 v155, v22, v23
    v_mfma_f32_16x16x32_bf16 v[60:63], a[108:111], a[76:79], v[60:63]
    ds_read_b64_tr_b16 a[94:95], v79 offset:12288
    s_waitcnt lgkmcnt(8)
    v_mfma_f32_16x16x32_bf16 v[24:27], a[112:115], a[0:3], v[24:27]
    ds_read_b64_tr_b16 a[96:97], v78 offset:16384
    s_mov_b32 s61, 0
    v_mfma_f32_16x16x32_bf16 v[24:27], a[116:119], a[8:11], v[24:27]
    ds_read_b64_tr_b16 a[98:99], v78 offset:20480
    buffer_store_dwordx4 v[152:155], v69, s[40:43], s61 offen sc1
    v_mfma_f32_16x16x32_bf16 v[56:59], a[112:115], a[4:7], v[56:59]
    ds_read_b64_tr_b16 a[100:101], v78 offset:24576
    v_cvt_pk_bf16_f32 v160, v48, v49
    v_mfma_f32_16x16x32_bf16 v[56:59], a[116:119], a[12:15], v[56:59]
    ds_read_b64_tr_b16 a[102:103], v78 offset:28672
    v_cvt_pk_bf16_f32 v161, v50, v51
    v_mfma_f32_16x16x32_bf16 v[28:31], a[120:123], a[0:3], v[28:31]
    ds_read_b64_tr_b16 a[104:105], v79 offset:16384
    v_cvt_pk_bf16_f32 v162, v52, v53
    v_mfma_f32_16x16x32_bf16 v[28:31], a[124:127], a[8:11], v[28:31]
    ds_read_b64_tr_b16 a[106:107], v79 offset:20480
    v_cvt_pk_bf16_f32 v163, v54, v55
    v_mfma_f32_16x16x32_bf16 v[60:63], a[120:123], a[4:7], v[60:63]
    ds_read_b64_tr_b16 a[108:109], v79 offset:24576
    s_mov_b32 s61, 2048
    v_mfma_f32_16x16x32_bf16 v[60:63], a[124:127], a[12:15], v[60:63]
    ds_read_b64_tr_b16 a[110:111], v79 offset:28672
    s_waitcnt lgkmcnt(8)
    v_mfma_f32_16x16x32_bf16 v[24:27], a[80:83], a[16:19], v[24:27]
    ds_read_b64_tr_b16 a[112:113], v88 offset:0
    buffer_store_dwordx4 v[160:163], v69, s[40:43], s61 offen sc1
    v_mfma_f32_16x16x32_bf16 v[24:27], a[84:87], a[24:27], v[24:27]
    ds_read_b64_tr_b16 a[114:115], v88 offset:4096
    v_mfma_f32_16x16x32_bf16 v[56:59], a[80:83], a[20:23], v[56:59]
    ds_read_b64_tr_b16 a[116:117], v88 offset:8192
    v_mfma_f32_16x16x32_bf16 v[56:59], a[84:87], a[28:31], v[56:59]
    ds_read_b64_tr_b16 a[118:119], v88 offset:12288
    v_mfma_f32_16x16x32_bf16 v[28:31], a[88:91], a[16:19], v[28:31]
    ds_read_b64_tr_b16 a[120:121], v89 offset:0
    v_mfma_f32_16x16x32_bf16 v[28:31], a[92:95], a[24:27], v[28:31]
    ds_read_b64_tr_b16 a[122:123], v89 offset:4096
    v_mfma_f32_16x16x32_bf16 v[60:63], a[88:91], a[20:23], v[60:63]
    ds_read_b64_tr_b16 a[124:125], v89 offset:8192
    v_mfma_f32_16x16x32_bf16 v[60:63], a[92:95], a[28:31], v[60:63]
    ds_read_b64_tr_b16 a[126:127], v89 offset:12288
    s_waitcnt lgkmcnt(8)
    v_mfma_f32_16x16x32_bf16 v[24:27], a[96:99], a[32:35], v[24:27]
    ds_read_b64_tr_b16 a[80:81], v88 offset:16384
    v_mfma_f32_16x16x32_bf16 v[24:27], a[100:103], a[40:43], v[24:27]
    ds_read_b64_tr_b16 a[82:83], v88 offset:20480
    v_mfma_f32_16x16x32_bf16 v[56:59], a[96:99], a[36:39], v[56:59]
    ds_read_b64_tr_b16 a[84:85], v88 offset:24576
    v_mfma_f32_16x16x32_bf16 v[56:59], a[100:103], a[44:47], v[56:59]
    ds_read_b64_tr_b16 a[86:87], v88 offset:28672
    s_branch L_fused_kernel_pc14
L_fused_kernel_isl0_14:
    s_branch L_fused_kernel_warmback0
L_fused_kernel_pc14:
    v_mfma_f32_16x16x32_bf16 v[28:31], a[104:107], a[32:35], v[28:31]
    ds_read_b64_tr_b16 a[88:89], v89 offset:16384
    v_mfma_f32_16x16x32_bf16 v[28:31], a[108:111], a[40:43], v[28:31]
    ds_read_b64_tr_b16 a[90:91], v89 offset:20480
    v_mfma_f32_16x16x32_bf16 v[60:63], a[104:107], a[36:39], v[60:63]
    ds_read_b64_tr_b16 a[92:93], v89 offset:24576
    v_mfma_f32_16x16x32_bf16 v[60:63], a[108:111], a[44:47], v[60:63]
    ds_read_b64_tr_b16 a[94:95], v89 offset:28672
    s_waitcnt lgkmcnt(8)
    v_mfma_f32_16x16x32_bf16 v[0:3], a[112:115], a[64:67], v[0:3]
    ds_read_b64_tr_b16 a[96:97], v72 offset:0
    v_mfma_f32_16x16x32_bf16 v[0:3], a[116:119], a[72:75], v[0:3]
    ds_read_b64_tr_b16 a[98:99], v72 offset:4096
    v_mfma_f32_16x16x32_bf16 v[32:35], a[112:115], a[68:71], v[32:35]
    ds_read_b64_tr_b16 a[100:101], v72 offset:8192
    v_mfma_f32_16x16x32_bf16 v[32:35], a[116:119], a[76:79], v[32:35]
    ds_read_b64_tr_b16 a[102:103], v72 offset:12288
    v_cvt_pk_bf16_f32 v156, v24, v25
    v_mfma_f32_16x16x32_bf16 v[4:7], a[120:123], a[64:67], v[4:7]
    ds_read_b64_tr_b16 a[104:105], v73 offset:0
    v_cvt_pk_bf16_f32 v157, v26, v27
    v_mfma_f32_16x16x32_bf16 v[4:7], a[124:127], a[72:75], v[4:7]
    ds_read_b64_tr_b16 a[106:107], v73 offset:4096
    v_cvt_pk_bf16_f32 v158, v28, v29
    v_mfma_f32_16x16x32_bf16 v[36:39], a[120:123], a[68:71], v[36:39]
    ds_read_b64_tr_b16 a[108:109], v73 offset:8192
    v_cvt_pk_bf16_f32 v159, v30, v31
    v_mfma_f32_16x16x32_bf16 v[36:39], a[124:127], a[76:79], v[36:39]
    ds_read_b64_tr_b16 a[110:111], v73 offset:12288
    s_waitcnt lgkmcnt(8)
    v_mfma_f32_16x16x32_bf16 v[0:3], a[80:83], a[0:3], v[0:3]
    ds_read_b64_tr_b16 a[112:113], v72 offset:16384
    s_mov_b32 s61, 1024
    v_mfma_f32_16x16x32_bf16 v[0:3], a[84:87], a[8:11], v[0:3]
    ds_read_b64_tr_b16 a[114:115], v72 offset:20480
    buffer_store_dwordx4 v[156:159], v69, s[40:43], s61 offen sc1
    v_mfma_f32_16x16x32_bf16 v[32:35], a[80:83], a[4:7], v[32:35]
    ds_read_b64_tr_b16 a[116:117], v72 offset:24576
    v_cvt_pk_bf16_f32 v164, v56, v57
    v_mfma_f32_16x16x32_bf16 v[32:35], a[84:87], a[12:15], v[32:35]
    ds_read_b64_tr_b16 a[118:119], v72 offset:28672
    v_cvt_pk_bf16_f32 v165, v58, v59
    v_mfma_f32_16x16x32_bf16 v[4:7], a[88:91], a[0:3], v[4:7]
    ds_read_b64_tr_b16 a[120:121], v73 offset:16384
    v_cvt_pk_bf16_f32 v166, v60, v61
    v_mfma_f32_16x16x32_bf16 v[4:7], a[92:95], a[8:11], v[4:7]
    ds_read_b64_tr_b16 a[122:123], v73 offset:20480
    v_cvt_pk_bf16_f32 v167, v62, v63
    v_mfma_f32_16x16x32_bf16 v[36:39], a[88:91], a[4:7], v[36:39]
    ds_read_b64_tr_b16 a[124:125], v73 offset:24576
    s_mov_b32 s61, 3072
    v_mfma_f32_16x16x32_bf16 v[36:39], a[92:95], a[12:15], v[36:39]
    ds_read_b64_tr_b16 a[126:127], v73 offset:28672
    s_waitcnt lgkmcnt(8)
    v_mfma_f32_16x16x32_bf16 v[0:3], a[96:99], a[16:19], v[0:3]
    ds_read_b64_tr_b16 a[80:81], v90 offset:0
    buffer_store_dwordx4 v[164:167], v69, s[40:43], s61 offen sc1
    v_mfma_f32_16x16x32_bf16 v[0:3], a[100:103], a[24:27], v[0:3]
    ds_read_b64_tr_b16 a[82:83], v90 offset:4096
    v_mfma_f32_16x16x32_bf16 v[32:35], a[96:99], a[20:23], v[32:35]
    ds_read_b64_tr_b16 a[84:85], v90 offset:8192
    v_mfma_f32_16x16x32_bf16 v[32:35], a[100:103], a[28:31], v[32:35]
    ds_read_b64_tr_b16 a[86:87], v90 offset:12288
    v_mfma_f32_16x16x32_bf16 v[4:7], a[104:107], a[16:19], v[4:7]
    ds_read_b64_tr_b16 a[88:89], v91 offset:0
    v_mfma_f32_16x16x32_bf16 v[4:7], a[108:111], a[24:27], v[4:7]
    ds_read_b64_tr_b16 a[90:91], v91 offset:4096
    v_mfma_f32_16x16x32_bf16 v[36:39], a[104:107], a[20:23], v[36:39]
    ds_read_b64_tr_b16 a[92:93], v91 offset:8192
    v_mfma_f32_16x16x32_bf16 v[36:39], a[108:111], a[28:31], v[36:39]
    ds_read_b64_tr_b16 a[94:95], v91 offset:12288
    s_waitcnt lgkmcnt(8)
    v_mfma_f32_16x16x32_bf16 v[0:3], a[112:115], a[32:35], v[0:3]
    ds_read_b64_tr_b16 a[96:97], v90 offset:16384
    v_mfma_f32_16x16x32_bf16 v[0:3], a[116:119], a[40:43], v[0:3]
    ds_read_b64_tr_b16 a[98:99], v90 offset:20480
    v_mfma_f32_16x16x32_bf16 v[32:35], a[112:115], a[36:39], v[32:35]
    ds_read_b64_tr_b16 a[100:101], v90 offset:24576
    v_mfma_f32_16x16x32_bf16 v[32:35], a[116:119], a[44:47], v[32:35]
    ds_read_b64_tr_b16 a[102:103], v90 offset:28672
    v_mfma_f32_16x16x32_bf16 v[4:7], a[120:123], a[32:35], v[4:7]
    ds_read_b64_tr_b16 a[104:105], v91 offset:16384
    v_mfma_f32_16x16x32_bf16 v[4:7], a[124:127], a[40:43], v[4:7]
    ds_read_b64_tr_b16 a[106:107], v91 offset:20480
    v_mfma_f32_16x16x32_bf16 v[36:39], a[120:123], a[36:39], v[36:39]
    ds_read_b64_tr_b16 a[108:109], v91 offset:24576
    v_mfma_f32_16x16x32_bf16 v[36:39], a[124:127], a[44:47], v[36:39]
    ds_read_b64_tr_b16 a[110:111], v91 offset:28672
    s_waitcnt lgkmcnt(8)
    v_mfma_f32_16x16x32_bf16 v[8:11], a[80:83], a[64:67], v[8:11]
    ds_read_b64_tr_b16 a[112:113], v74 offset:0
    v_mfma_f32_16x16x32_bf16 v[8:11], a[84:87], a[72:75], v[8:11]
    ds_read_b64_tr_b16 a[114:115], v74 offset:4096
    v_mfma_f32_16x16x32_bf16 v[40:43], a[80:83], a[68:71], v[40:43]
    ds_read_b64_tr_b16 a[116:117], v74 offset:8192
    v_mfma_f32_16x16x32_bf16 v[40:43], a[84:87], a[76:79], v[40:43]
    ds_read_b64_tr_b16 a[118:119], v74 offset:12288
    v_mfma_f32_16x16x32_bf16 v[12:15], a[88:91], a[64:67], v[12:15]
    ds_read_b64_tr_b16 a[120:121], v75 offset:0
    v_mfma_f32_16x16x32_bf16 v[12:15], a[92:95], a[72:75], v[12:15]
    ds_read_b64_tr_b16 a[122:123], v75 offset:4096
    v_mfma_f32_16x16x32_bf16 v[44:47], a[88:91], a[68:71], v[44:47]
    ds_read_b64_tr_b16 a[124:125], v75 offset:8192
    v_mfma_f32_16x16x32_bf16 v[44:47], a[92:95], a[76:79], v[44:47]
    ds_read_b64_tr_b16 a[126:127], v75 offset:12288
    s_waitcnt lgkmcnt(8)
    v_mfma_f32_16x16x32_bf16 v[8:11], a[96:99], a[0:3], v[8:11]
    ds_read_b64_tr_b16 a[80:81], v74 offset:16384
    v_mfma_f32_16x16x32_bf16 v[8:11], a[100:103], a[8:11], v[8:11]
    ds_read_b64_tr_b16 a[82:83], v74 offset:20480
    v_mfma_f32_16x16x32_bf16 v[40:43], a[96:99], a[4:7], v[40:43]
    ds_read_b64_tr_b16 a[84:85], v74 offset:24576
    v_mfma_f32_16x16x32_bf16 v[40:43], a[100:103], a[12:15], v[40:43]
    ds_read_b64_tr_b16 a[86:87], v74 offset:28672
    v_mfma_f32_16x16x32_bf16 v[12:15], a[104:107], a[0:3], v[12:15]
    ds_read_b64_tr_b16 a[88:89], v75 offset:16384
    v_mfma_f32_16x16x32_bf16 v[12:15], a[108:111], a[8:11], v[12:15]
    ds_read_b64_tr_b16 a[90:91], v75 offset:20480
    v_mfma_f32_16x16x32_bf16 v[44:47], a[104:107], a[4:7], v[44:47]
    ds_read_b64_tr_b16 a[92:93], v75 offset:24576
    v_mfma_f32_16x16x32_bf16 v[44:47], a[108:111], a[12:15], v[44:47]
    ds_read_b64_tr_b16 a[94:95], v75 offset:28672
    s_waitcnt lgkmcnt(8)
    v_mfma_f32_16x16x32_bf16 v[8:11], a[112:115], a[16:19], v[8:11]
    v_mfma_f32_16x16x32_bf16 v[8:11], a[116:119], a[24:27], v[8:11]
    v_mfma_f32_16x16x32_bf16 v[40:43], a[112:115], a[20:23], v[40:43]
    v_mfma_f32_16x16x32_bf16 v[40:43], a[116:119], a[28:31], v[40:43]
    v_mfma_f32_16x16x32_bf16 v[12:15], a[120:123], a[16:19], v[12:15]
    v_mfma_f32_16x16x32_bf16 v[12:15], a[124:127], a[24:27], v[12:15]
    v_mfma_f32_16x16x32_bf16 v[44:47], a[120:123], a[20:23], v[44:47]
    v_mfma_f32_16x16x32_bf16 v[44:47], a[124:127], a[28:31], v[44:47]
    s_waitcnt lgkmcnt(0)
    v_mfma_f32_16x16x32_bf16 v[8:11], a[80:83], a[32:35], v[8:11]
    v_mfma_f32_16x16x32_bf16 v[8:11], a[84:87], a[40:43], v[8:11]
    v_mfma_f32_16x16x32_bf16 v[40:43], a[80:83], a[36:39], v[40:43]
    v_mfma_f32_16x16x32_bf16 v[40:43], a[84:87], a[44:47], v[40:43]
    v_mfma_f32_16x16x32_bf16 v[12:15], a[88:91], a[32:35], v[12:15]
    v_mfma_f32_16x16x32_bf16 v[12:15], a[92:95], a[40:43], v[12:15]
    v_mfma_f32_16x16x32_bf16 v[44:47], a[88:91], a[36:39], v[44:47]
    v_mfma_f32_16x16x32_bf16 v[44:47], a[92:95], a[44:47], v[44:47]
    s_nop 7
    v_cmp_ne_u64 vcc, s[62:63], v[64:65]
    s_nop 4
    s_and_b32 s3, vcc_lo, 0x10000
    s_cbranch_scc1 L_fused_kernel_fs_47
L_fused_kernel_fb_48:
    s_mov_b32 s35, 400000
    s_mov_b32 s9, 0
    buffer_load_dwordx4 v[120:123], v70, s[40:43], s9 offen sc1
    s_mov_b32 s9, 1024
    buffer_load_dwordx4 v[124:127], v70, s[40:43], s9 offen sc1
    s_mov_b32 s9, 2048
    buffer_load_dwordx4 v[128:131], v70, s[40:43], s9 offen sc1
    s_mov_b32 s9, 3072
    buffer_load_dwordx4 v[132:135], v70, s[40:43], s9 offen sc1
    s_waitcnt vmcnt(4)
    v_permlane16_swap_b32 v104, v106
    v_permlane16_swap_b32 v105, v107
    s_nop 1
    v_lshlrev_b32 v96, 16, v104
    v_and_b32 v97, 0xffff0000, v104
    v_pk_add_f32 v[0:1], v[0:1], v[96:97]
    v_lshlrev_b32 v96, 16, v105
    v_and_b32 v97, 0xffff0000, v105
    v_pk_add_f32 v[2:3], v[2:3], v[96:97]
    v_lshlrev_b32 v96, 16, v106
    v_and_b32 v97, 0xffff0000, v106
    v_pk_add_f32 v[4:5], v[4:5], v[96:97]
    v_lshlrev_b32 v96, 16, v107
    v_and_b32 v97, 0xffff0000, v107
    v_pk_add_f32 v[6:7], v[6:7], v[96:97]
    v_permlane16_swap_b32 v108, v110
    v_permlane16_swap_b32 v109, v111
    s_nop 1
    v_lshlrev_b32 v96, 16, v108
    v_and_b32 v97, 0xffff0000, v108
    v_pk_add_f32 v[8:9], v[8:9], v[96:97]
    v_lshlrev_b32 v96, 16, v109
    v_and_b32 v97, 0xffff0000, v109
    v_pk_add_f32 v[10:11], v[10:11], v[96:97]
    v_lshlrev_b32 v96, 16, v110
    v_and_b32 v97, 0xffff0000, v110
    v_pk_add_f32 v[12:13], v[12:13], v[96:97]
    v_lshlrev_b32 v96, 16, v111
    v_and_b32 v97, 0xffff0000, v111
    v_pk_add_f32 v[14:15], v[14:15], v[96:97]
    v_permlane16_swap_b32 v112, v114
    v_permlane16_swap_b32 v113, v115
    s_nop 1
    v_lshlrev_b32 v96, 16, v112
    v_and_b32 v97, 0xffff0000, v112
    v_pk_add_f32 v[32:33], v[32:33], v[96:97]
    v_lshlrev_b32 v96, 16, v113
    v_and_b32 v97, 0xffff0000, v113
    v_pk_add_f32 v[34:35], v[34:35], v[96:97]
    v_lshlrev_b32 v96, 16, v114
    v_and_b32 v97, 0xffff0000, v114
    v_pk_add_f32 v[36:37], v[36:37], v[96:97]
    v_lshlrev_b32 v96, 16, v115
    v_and_b32 v97, 0xffff0000, v115
    v_pk_add_f32 v[38:39], v[38:39], v[96:97]
    v_permlane16_swap_b32 v116, v118
    v_permlane16_swap_b32 v117, v119
    s_nop 1
    v_lshlrev_b32 v96, 16, v116
    v_and_b32 v97, 0xffff0000, v116
    v_pk_add_f32 v[40:41], v[40:41], v[96:97]
    v_lshlrev_b32 v96, 16, v117
    v_and_b32 v97, 0xffff0000, v117
    v_pk_add_f32 v[42:43], v[42:43], v[96:97]
    v_lshlrev_b32 v96, 16, v118
    v_and_b32 v97, 0xffff0000, v118
    v_pk_add_f32 v[44:45], v[44:45], v[96:97]
    v_lshlrev_b32 v96, 16, v119
    v_and_b32 v97, 0xffff0000, v119
    v_pk_add_f32 v[46:47], v[46:47], v[96:97]
    s_branch L_fused_kernel_xwait_52
L_fused_kernel_xpoll_50:
    s_mov_b32 s9, 0
    buffer_load_dwordx4 v[120:123], v70, s[40:43], s9 offen sc1
    s_mov_b32 s9, 1024
    buffer_load_dwordx4 v[124:127], v70, s[40:43], s9 offen sc1
    s_mov_b32 s9, 2048
    buffer_load_dwordx4 v[128:131], v70, s[40:43], s9 offen sc1
    s_mov_b32 s9, 3072
    buffer_load_dwordx4 v[132:135], v70, s[40:43], s9 offen sc1
    s_sub_u32 s35, s35, 1
    s_cbranch_scc1 L_fused_kernel_xdone_51
L_fused_kernel_xwait_52:
    s_waitcnt vmcnt(0)
    v_max3_u32 v96, v120, v121, v122
    v_max3_u32 v97, v123, v124, v125
    v_max3_u32 v96, v96, v126, v127
    v_max3_u32 v97, v97, v128, v129
    v_max3_u32 v96, v96, v130, v131
    v_max3_u32 v97, v97, v132, v133
    v_max3_u32 v96, v96, v134, v135
    v_max_u32 v96, v96, v97
    v_cmp_eq_u32 vcc, -1, v96
    s_nop 4
    s_cbranch_vccnz L_fused_kernel_xpoll_50
L_fused_kernel_xdone_51:
    s_waitcnt vmcnt(0)
    v_lshlrev_b32 v136, 16, v120
    v_and_b32 v137, 0xffff0000, v120
    v_lshlrev_b32 v138, 16, v121
    v_and_b32 v139, 0xffff0000, v121
    v_lshlrev_b32 v140, 16, v122
    v_and_b32 v141, 0xffff0000, v122
    v_lshlrev_b32 v142, 16, v123
    v_and_b32 v143, 0xffff0000, v123
    v_pk_add_f32 v[0:1], v[0:1], v[136:137]
    v_pk_add_f32 v[2:3], v[2:3], v[138:139]
    v_pk_add_f32 v[4:5], v[4:5], v[140:141]
    v_pk_add_f32 v[6:7], v[6:7], v[142:143]
    v_lshlrev_b32 v136, 16, v124
    v_and_b32 v137, 0xffff0000, v124
    v_lshlrev_b32 v138, 16, v125
    v_and_b32 v139, 0xffff0000, v125
    v_lshlrev_b32 v140, 16, v126
    v_and_b32 v141, 0xffff0000, v126
    v_lshlrev_b32 v142, 16, v127
    v_and_b32 v143, 0xffff0000, v127
    v_pk_add_f32 v[8:9], v[8:9], v[136:137]
    v_pk_add_f32 v[10:11], v[10:11], v[138:139]
    v_pk_add_f32 v[12:13], v[12:13], v[140:141]
    v_pk_add_f32 v[14:15], v[14:15], v[142:143]
    v_lshlrev_b32 v136, 16, v128
    v_and_b32 v137, 0xffff0000, v128
    v_lshlrev_b32 v138, 16, v129
    v_and_b32 v139, 0xffff0000, v129
    v_lshlrev_b32 v140, 16, v130
    v_and_b32 v141, 0xffff0000, v130
    v_lshlrev_b32 v142, 16, v131
    v_and_b32 v143, 0xffff0000, v131
    v_pk_add_f32 v[32:33], v[32:33], v[136:137]
    v_pk_add_f32 v[34:35], v[34:35], v[138:139]
    v_pk_add_f32 v[36:37], v[36:37], v[140:141]
    v_pk_add_f32 v[38:39], v[38:39], v[142:143]
    v_lshlrev_b32 v136, 16, v132
    v_and_b32 v137, 0xffff0000, v132
    v_lshlrev_b32 v138, 16, v133
    v_and_b32 v139, 0xffff0000, v133
    v_lshlrev_b32 v140, 16, v134
    v_and_b32 v141, 0xffff0000, v134
    v_lshlrev_b32 v142, 16, v135
    v_and_b32 v143, 0xffff0000, v135
    v_pk_add_f32 v[40:41], v[40:41], v[136:137]
    v_pk_add_f32 v[42:43], v[42:43], v[138:139]
    v_pk_add_f32 v[44:45], v[44:45], v[140:141]
    v_pk_add_f32 v[46:47], v[46:47], v[142:143]
    v_cvt_pk_bf16_f32 v104, v0, v1
    v_cvt_pk_bf16_f32 v105, v2, v3
    v_cvt_pk_bf16_f32 v106, v4, v5
    v_cvt_pk_bf16_f32 v107, v6, v7
    s_nop 1
    v_permlane16_swap_b32 v104, v106
    v_permlane16_swap_b32 v105, v107
    s_mov_b32 s9, 0
    buffer_store_dwordx4 v[104:107], v68, s[44:47], s9 offen offset:0 nt
    v_cvt_pk_bf16_f32 v108, v8, v9
    v_cvt_pk_bf16_f32 v109, v10, v11
    v_cvt_pk_bf16_f32 v110, v12, v13
    v_cvt_pk_bf16_f32 v111, v14, v15
    s_nop 1
    v_permlane16_swap_b32 v108, v110
    v_permlane16_swap_b32 v109, v111
    s_mov_b32 s9, 0
    buffer_store_dwordx4 v[108:111], v68, s[44:47], s9 offen offset:64 nt
    v_cvt_pk_bf16_f32 v112, v32, v33
    v_cvt_pk_bf16_f32 v113, v34, v35
    v_cvt_pk_bf16_f32 v114, v36, v37
    v_cvt_pk_bf16_f32 v115, v38, v39
    s_nop 1
    v_permlane16_swap_b32 v112, v114
    v_permlane16_swap_b32 v113, v115
    s_mov_b32 s9, 32768
    buffer_store_dwordx4 v[112:115], v68, s[44:47], s9 offen offset:0 nt
    v_cvt_pk_bf16_f32 v116, v40, v41
    v_cvt_pk_bf16_f32 v117, v42, v43
    v_cvt_pk_bf16_f32 v118, v44, v45
    v_cvt_pk_bf16_f32 v119, v46, v47
    s_nop 1
    v_permlane16_swap_b32 v116, v118
    v_permlane16_swap_b32 v117, v119
    s_mov_b32 s9, 32768
    buffer_store_dwordx4 v[116:119], v68, s[44:47], s9 offen offset:64 nt
    s_cmp_lg_u32 s2, 0
    s_cbranch_scc1 L_fused_kernel_ep_53
    s_add_u32 s62, s30, 16
    s_addc_u32 s63, s31, 0
    v_mov_b32 v96, s62
    v_mov_b32 v97, s63
    v_mov_b32 v98, 0
    buffer_store_dwordx2 v[96:97], v98, s[36:39], 0 offen offset:0
L_fused_kernel_ep_53:
L_fused_kernel_end:
    s_endpgm
L_fused_kernel_fs_23:
    s_mov_b32 s35, 400000
L_fused_kernel_fp_25:
    buffer_load_dwordx2 v[64:65], v66, s[36:39], 0 offen sc1
    s_sub_u32 s35, s35, 1
    s_cbranch_scc1 L_fused_kernel_fb_24_w
    s_waitcnt vmcnt(0)
    v_cmp_ne_u64 vcc, s[62:63], v[64:65]
    s_nop 4
    s_and_b32 s3, vcc_lo, 0x3
    s_cbranch_scc1 L_fused_kernel_fp_25
L_fused_kernel_fb_24_w:
    s_waitcnt vmcnt(0)
    s_branch L_fused_kernel_fb_24
L_fused_kernel_fs_26:
    s_mov_b32 s35, 400000
L_fused_kernel_fp_28:
    buffer_load_dwordx2 v[64:65], v66, s[36:39], 0 offen sc1
    s_sub_u32 s35, s35, 1
    s_cbranch_scc1 L_fused_kernel_fb_27_w
    s_waitcnt vmcnt(0)
    v_cmp_ne_u64 vcc, s[62:63], v[64:65]
    s_nop 4
    s_and_b32 s3, vcc_lo, 0xc
    s_cbranch_scc1 L_fused_kernel_fp_28
L_fused_kernel_fb_27_w:
    s_waitcnt vmcnt(0)
    s_branch L_fused_kernel_fb_27
L_fused_kernel_fs_29:
    s_mov_b32 s35, 400000
L_fused_kernel_fp_31:
    buffer_load_dwordx2 v[64:65], v66, s[36:39], 0 offen sc1
    s_sub_u32 s35, s35, 1
    s_cbranch_scc1 L_fused_kernel_fb_30_w
    s_waitcnt vmcnt(0)
    v_cmp_ne_u64 vcc, s[62:63], v[64:65]
    s_nop 4
    s_and_b32 s3, vcc_lo, 0x30
    s_cbranch_scc1 L_fused_kernel_fp_31
L_fused_kernel_fb_30_w:
    s_waitcnt vmcnt(0)
    s_branch L_fused_kernel_fb_30
L_fused_kernel_fs_32:
    s_mov_b32 s35, 400000
L_fused_kernel_fp_34:
    buffer_load_dwordx2 v[64:65], v66, s[36:39], 0 offen sc1
    s_sub_u32 s35, s35, 1
    s_cbranch_scc1 L_fused_kernel_fb_33_w
    s_waitcnt vmcnt(0)
    v_cmp_ne_u64 vcc, s[62:63], v[64:65]
    s_nop 4
    s_and_b32 s3, vcc_lo, 0xc0
    s_cbranch_scc1 L_fused_kernel_fp_34
L_fused_kernel_fb_33_w:
    s_waitcnt vmcnt(0)
    s_branch L_fused_kernel_fb_33
L_fused_kernel_fs_35:
    s_mov_b32 s35, 400000
L_fused_kernel_fp_37:
    buffer_load_dwordx2 v[64:65], v66, s[36:39], 0 offen sc1
    s_sub_u32 s35, s35, 1
    s_cbranch_scc1 L_fused_kernel_fb_36_w
    s_waitcnt vmcnt(0)
    v_cmp_ne_u64 vcc, s[62:63], v[64:65]
    s_nop 4
    s_and_b32 s3, vcc_lo, 0x300
    s_cbranch_scc1 L_fused_kernel_fp_37
L_fused_kernel_fb_36_w:
    s_waitcnt vmcnt(0)
    s_branch L_fused_kernel_fb_36
L_fused_kernel_fs_38:
    s_mov_b32 s35, 400000
L_fused_kernel_fp_40:
    buffer_load_dwordx2 v[64:65], v66, s[36:39], 0 offen sc1
    s_sub_u32 s35, s35, 1
    s_cbranch_scc1 L_fused_kernel_fb_39_w
    s_waitcnt vmcnt(0)
    v_cmp_ne_u64 vcc, s[62:63], v[64:65]
    s_nop 4
    s_and_b32 s3, vcc_lo, 0xc00
    s_cbranch_scc1 L_fused_kernel_fp_40
L_fused_kernel_fb_39_w:
    s_waitcnt vmcnt(0)
    s_branch L_fused_kernel_fb_39
L_fused_kernel_fs_41:
    s_mov_b32 s35, 400000
L_fused_kernel_fp_43:
    buffer_load_dwordx2 v[64:65], v66, s[36:39], 0 offen sc1
    s_sub_u32 s35, s35, 1
    s_cbranch_scc1 L_fused_kernel_fb_42_w
    s_waitcnt vmcnt(0)
    v_cmp_ne_u64 vcc, s[62:63], v[64:65]
    s_nop 4
    s_and_b32 s3, vcc_lo, 0x3000
    s_cbranch_scc1 L_fused_kernel_fp_43
L_fused_kernel_fb_42_w:
    s_waitcnt vmcnt(0)
    s_branch L_fused_kernel_fb_42
L_fused_kernel_fs_44:
    s_mov_b32 s35, 400000
L_fused_kernel_fp_46:
    buffer_load_dwordx2 v[64:65], v66, s[36:39], 0 offen sc1
    s_sub_u32 s35, s35, 1
    s_cbranch_scc1 L_fused_kernel_fb_45_w
    s_waitcnt vmcnt(0)
    v_cmp_ne_u64 vcc, s[62:63], v[64:65]
    s_nop 4
    s_and_b32 s3, vcc_lo, 0xc000
    s_cbranch_scc1 L_fused_kernel_fp_46
L_fused_kernel_fb_45_w:
    s_waitcnt vmcnt(0)
    s_branch L_fused_kernel_fb_45
L_fused_kernel_fs_47:
    s_mov_b32 s35, 400000
L_fused_kernel_fp_49:
    buffer_load_dwordx2 v[64:65], v66, s[36:39], 0 offen sc1
    s_sub_u32 s35, s35, 1
    s_cbranch_scc1 L_fused_kernel_fb_48_w
    s_waitcnt vmcnt(0)
    v_cmp_ne_u64 vcc, s[62:63], v[64:65]
    s_nop 4
    s_and_b32 s3, vcc_lo, 0x10000
    s_cbranch_scc1 L_fused_kernel_fp_49
L_fused_kernel_fb_48_w:
    s_waitcnt vmcnt(0)
    s_branch L_fused_kernel_fb_48

.section .rodata,"a"
.p2align 6
.amdhsa_kernel fused_kernel
  .amdhsa_next_free_vgpr 512
  .amdhsa_next_free_sgpr 102
  .amdhsa_accum_offset 256
  .amdhsa_group_segment_fixed_size 0
  .amdhsa_kernarg_size 104
  .amdhsa_user_sgpr_count 2
  .amdhsa_user_sgpr_kernarg_segment_ptr 1
  .amdhsa_system_sgpr_workgroup_id_x 1
  .amdhsa_float_denorm_mode_32 3
.end_amdhsa_kernel
```
